```python
import torch

def _softmax(x, axis=-1):
    return torch.softmax(x, dim=axis)
def _gelu(x):
    return torch.nn.functional.gelu(x, approximate="tanh")
def _silu(x):
    return torch.nn.functional.silu(x)
def _sigmoid(x):
    return torch.sigmoid(x)
def _layernorm(x, axis=-1, eps=1e-5):
    m = x.mean(dim=axis, keepdim=True)
    v = x.var(dim=axis, keepdim=True, unbiased=False)
    return (x - m) / torch.sqrt(v + eps)
def _scatter_add(tgt, idx, src, axis=0):
    return tgt.clone().index_add_(axis, idx, src)
def _segment_sum(src, seg, n):
    out = torch.zeros((n,) + src.shape[1:], dtype=src.dtype)
    return out.index_add_(0, seg, src)
def _pad(x, pw):
    flat = tuple(v for pair in reversed(pw) for v in pair)
    return torch.nn.functional.pad(x, flat)

kernel_name = 'concat_heads__gqa_block_cached__gqa_block_cached__near_ridge'

def setup_inputs():

    _w = (lambda a: (lambda t: t.to(torch.bfloat16) if t.is_floating_point() else t)(torch.as_tensor(a)))
    def _A_setup():
        B, Sq, D = 8, 128, 448
        Hq, Hkv, Sk, Dh = 16, 8, 2048, 256
        assert Hq % Hkv == 0, (Hq, Hkv)
        return {
            "x": _w((lambda *s: torch.randn(*s, dtype=torch.bfloat16) * 0.8)(B, Sq, D)),
            "k_cache": _w((lambda *s: torch.randn(*s, dtype=torch.bfloat16) * 0.8)(B, Hkv, Sk, Dh)),
            "v_cache": _w((lambda *s: torch.randn(*s, dtype=torch.bfloat16) * 0.05)(B, Hkv, Sk, Dh)),
            "wq": _w((lambda *s: torch.randn(*s, dtype=torch.bfloat16) * 0.8)(D, Hq * Dh) * (D ** -0.5)),
            "wo": _w((lambda *s: torch.randn(*s, dtype=torch.bfloat16) * 0.05)(Hq * Dh, D) * ((Hq * Dh) ** -0.5)),
        }
    _A_in = _A_setup()

    def _B_setup():
        B, Sq, D = 8, 128, 448
        Hq, Hkv, Sk, Dh = 16, 8, 2048, 256
        assert Hq % Hkv == 0, (Hq, Hkv)
        return {
            "x": _w((lambda *s: torch.randn(*s, dtype=torch.bfloat16) * 0.8)(B, Sq, D)),
            "k_cache": _w((lambda *s: torch.randn(*s, dtype=torch.bfloat16) * 0.8)(B, Hkv, Sk, Dh)),
            "v_cache": _w((lambda *s: torch.randn(*s, dtype=torch.bfloat16) * 0.05)(B, Hkv, Sk, Dh)),
            "wq": _w((lambda *s: torch.randn(*s, dtype=torch.bfloat16) * 0.8)(D, Hq * Dh) * (D ** -0.5)),
            "wo": _w((lambda *s: torch.randn(*s, dtype=torch.bfloat16) * 0.05)(Hq * Dh, D) * ((Hq * Dh) ** -0.5)),
        }
    _B_in = _B_setup()

    return {
        "A_x": _A_in["x"],
        "A_k_cache": _A_in["k_cache"],
        "A_v_cache": _A_in["v_cache"],
        "A_wq": _A_in["wq"],
        "A_wo": _A_in["wo"],
        "B_x": _B_in["x"],
        "B_k_cache": _B_in["k_cache"],
        "B_v_cache": _B_in["v_cache"],
        "B_wq": _B_in["wq"],
        "B_wo": _B_in["wo"],
    }

def reference(A_x, A_k_cache, A_v_cache, A_wq, A_wo, B_x, B_k_cache, B_v_cache, B_wq, B_wo):
    def _A_ref(x, k_cache, v_cache, wq, wo):
        B, Sq, D = x.shape
        Hq, Dh = 16, 256
        Hkv = k_cache.shape[1]
        rep = Hq // Hkv
        q = (lambda x, *d: x.permute(*d))((x @ wq).reshape(B, Sq, Hq, Dh), 0, 2, 1, 3)
        k = (lambda x, n, axis: torch.repeat_interleave(x, n, dim=axis))(k_cache, rep, axis=1)
        v = (lambda x, n, axis: torch.repeat_interleave(x, n, dim=axis))(v_cache, rep, axis=1)
        scores = torch.einsum("bhqd,bhkd->bhqk", q, k) * (Dh ** -0.5)
        p = _softmax(scores, axis=-1)
        o = torch.einsum("bhqk,bhkd->bhqd", p, v)
        return (lambda x, *d: x.permute(*d))(o, 0, 2, 1, 3).reshape(B, Sq, Hq * Dh) @ wo

    def _B_ref(x, k_cache, v_cache, wq, wo):
        B, Sq, D = x.shape
        Hq, Dh = 16, 256
        Hkv = k_cache.shape[1]
        rep = Hq // Hkv
        q = (lambda x, *d: x.permute(*d))((x @ wq).reshape(B, Sq, Hq, Dh), 0, 2, 1, 3)
        k = (lambda x, n, axis: torch.repeat_interleave(x, n, dim=axis))(k_cache, rep, axis=1)
        v = (lambda x, n, axis: torch.repeat_interleave(x, n, dim=axis))(v_cache, rep, axis=1)
        scores = torch.einsum("bhqd,bhkd->bhqk", q, k) * (Dh ** -0.5)
        p = _softmax(scores, axis=-1)
        o = torch.einsum("bhqk,bhkd->bhqd", p, v)
        return (lambda x, *d: x.permute(*d))(o, 0, 2, 1, 3).reshape(B, Sq, Hq * Dh) @ wo

    a = _A_ref(A_x, A_k_cache, A_v_cache, A_wq, A_wo)
    b = _B_ref(B_x, B_k_cache, B_v_cache, B_wq, B_wo)
    return torch.concatenate([a, b], axis=-1)
```

```asm
; @launch grid=(256,1,1) block=(256,1,1) lds=163840
.amdgcn_target "amdgcn-amd-amdhsa--gfx950"
.text
.globl concat_heads__gqa_block_cached__gqa_block_cached__near_ridge_kernel
.p2align 8
.type concat_heads__gqa_block_cached__gqa_block_cached__near_ridge_kernel,@function
concat_heads__gqa_block_cached__gqa_block_cached__near_ridge_kernel:
    s_cmp_ge_u32 s2, 256
    s_cbranch_scc1 L_end
    s_mov_b32 s100, s2
    s_mov_b32 s101, 0
L_again:
    s_load_dwordx8 s[52:59], s[0:1], 0
    s_load_dwordx8 s[64:71], s[0:1], 40
    s_load_dwordx2 s[60:61], s[0:1], 32
    s_load_dwordx2 s[72:73], s[0:1], 72
    s_load_dwordx2 s[74:75], s[0:1], 96
    s_load_dwordx2 s[76:77], s[0:1], 88
    s_load_dwordx2 s[78:79], s[0:1], 80
    s_memrealtime s[6:7]
    v_lshrrev_b32 v1, 6, v0
    v_and_b32 v0, 63, v0
    s_and_b32 s47, s2, 3
    s_lshl_b32 s47, s47, 1
    s_bfe_u32 s48, s2, 0x10004
    s_or_b32 s47, s47, s48
    s_and_b32 s48, s2, 8
    s_or_b32 s47, s47, s48
    s_bfe_u32 s48, s2, 0x10002
    s_lshl_b32 s48, s48, 7
    s_or_b32 s47, s47, s48
    s_lshr_b32 s48, s2, 5
    s_lshl_b32 s48, s48, 4
    s_or_b32 s2, s47, s48
    s_nop 0
    s_and_b32 s47, s2, 7
    v_readfirstlane_b32 s3, v1
    s_getpc_b64 s[8:9]
L_pc:
    v_lshlrev_b32 v16, 7, v0
    v_lshl_add_u32 v16, v1, 13, v16
    v_min_u32 v17, L_codeend-L_pc-4, v16
    v_add_u32 v16, 32768, v16
    v_min_u32 v18, L_codeend-L_pc-4, v16
    global_load_dword v60, v17, s[8:9]
    global_load_dword v61, v18, s[8:9]
    s_nop 0
    s_bfe_u32 s48, s2, 0x10003
    s_bfe_u32 s49, s2, 0x30004
    s_lshr_b32 s50, s2, 7
    v_lshrrev_b32 v24, 3, v0
    v_and_b32 v25, 7, v0
    v_lshrrev_b32 v28, 1, v24
    v_xor_b32 v28, v25, v28
    v_lshlrev_b32 v28, 4, v28
    v_and_b32 v29, 6, v24
    v_xor_b32 v29, v25, v29
    v_lshlrev_b32 v29, 4, v29
    v_mul_u32_u24 v30, 896, v24
    v_add_u32 v48, v30, v28
    v_xor_b32 v49, 64, v28
    v_add_u32 v49, v49, v30
    v_add_u32 v49, 7168, v49
    v_and_b32 v30, 3, v24
    v_lshrrev_b32 v50, 2, v24
    v_lshl_add_u32 v30, v50, 3, v30
    v_lshl_add_u32 v50, v30, 13, v29
    s_bfe_u32 s36, s2, 0x40003
    s_lshl_b32 s37, s36, 2
    s_add_u32 s37, s37, s3
    s_mul_i32 s33, s37, 14336
    s_lshl_b32 s37, s47, 2
    s_add_u32 s37, s37, s3
    s_lshl_b32 s34, s37, 8
    s_mul_i32 s38, s3, 16384
    s_lshl_b32 s39, s3, 11
    s_cmp_ge_u32 s49, 7
    s_cselect_b32 s35, 7, 0
    s_sub_u32 s37, s49, s35
    s_cmp_ge_u32 s37, 7
    s_cselect_b32 s35, 7, 0
    s_sub_u32 s40, s37, s35
    s_add_u32 s41, s40, 1
    s_cmp_eq_u32 s41, 7
    s_cselect_b32 s41, 0, s41
    s_add_u32 s42, s41, 1
    s_cmp_eq_u32 s42, 7
    s_cselect_b32 s42, 0, s42
    s_add_u32 s43, s42, 1
    s_cmp_eq_u32 s43, 7
    s_cselect_b32 s43, 0, s43
    s_add_u32 s44, s43, 1
    s_cmp_eq_u32 s44, 7
    s_cselect_b32 s44, 0, s44
    s_add_u32 s45, s44, 1
    s_cmp_eq_u32 s45, 7
    s_cselect_b32 s45, 0, s45
    s_add_u32 s46, s45, 1
    s_cmp_eq_u32 s46, 7
    s_cselect_b32 s46, 0, s46
    s_cmp_eq_u32 s50, 0
    s_waitcnt lgkmcnt(0)
    s_cselect_b64 s[52:53], s[52:53], s[64:65]
    s_cselect_b64 s[58:59], s[58:59], s[70:71]
    s_cselect_b64 s[54:55], s[54:55], s[66:67]
    s_cselect_b64 s[56:57], s[56:57], s[68:69]
    s_cselect_b64 s[60:61], s[60:61], s[72:73]
    s_add_u32 s16, s52, s33
    s_addc_u32 s17, s53, 0
    s_mov_b32 s18, 14336
    s_mov_b32 s19, 0x00020000
    s_add_u32 s20, s58, s34
    s_addc_u32 s21, s59, 0
    s_sub_u32 s22, 3670016, s34
    s_mov_b32 s23, 0x00020000
    s_lshl_b32 s62, s40, 19
    s_lshl_b32 s63, s41, 19
    s_lshl_b32 s64, s42, 19
    s_lshl_b32 s65, s43, 19
    s_lshl_b32 s66, s44, 19
    s_lshl_b32 s67, s45, 19
    s_lshl_b32 s68, s46, 19
    s_add_u32 m0, s39, 98304
    s_lshl_b32 s37, s40, 7
    buffer_load_dwordx4 v48, s[16:19], s37 offen lds
    s_add_u32 m0, s39, 99328
    s_lshl_b32 s37, s40, 7
    buffer_load_dwordx4 v49, s[16:19], s37 offen lds
    s_add_u32 m0, s38, 0
    s_add_u32 s37, s62, 0
    buffer_load_dwordx4 v50, s[20:23], s37 offen offset:0 lds
    s_add_u32 s37, s62, 130048
    buffer_load_dwordx4 v50, s[20:23], s37 offen offset:1024 lds
    s_add_u32 s37, s62, 30720
    buffer_load_dwordx4 v50, s[20:23], s37 offen offset:2048 lds
    s_add_u32 s37, s62, 160768
    buffer_load_dwordx4 v50, s[20:23], s37 offen offset:3072 lds
    s_add_u32 m0, s38, 4096
    s_add_u32 s37, s62, 262144
    buffer_load_dwordx4 v50, s[20:23], s37 offen offset:0 lds
    s_add_u32 s37, s62, 392192
    buffer_load_dwordx4 v50, s[20:23], s37 offen offset:1024 lds
    s_add_u32 s37, s62, 292864
    buffer_load_dwordx4 v50, s[20:23], s37 offen offset:2048 lds
    s_add_u32 s37, s62, 422912
    buffer_load_dwordx4 v50, s[20:23], s37 offen offset:3072 lds
    s_add_u32 m0, s39, 106496
    s_lshl_b32 s37, s41, 7
    buffer_load_dwordx4 v48, s[16:19], s37 offen lds
    s_add_u32 m0, s39, 107520
    s_lshl_b32 s37, s41, 7
    buffer_load_dwordx4 v49, s[16:19], s37 offen lds
    s_add_u32 m0, s39, 114688
    s_lshl_b32 s37, s42, 7
    buffer_load_dwordx4 v48, s[16:19], s37 offen lds
    s_add_u32 m0, s39, 115712
    s_lshl_b32 s37, s42, 7
    buffer_load_dwordx4 v49, s[16:19], s37 offen lds
    s_add_u32 m0, s39, 122880
    s_lshl_b32 s37, s43, 7
    buffer_load_dwordx4 v48, s[16:19], s37 offen lds
    s_add_u32 m0, s39, 123904
    s_lshl_b32 s37, s43, 7
    buffer_load_dwordx4 v49, s[16:19], s37 offen lds
    s_add_u32 m0, s39, 131072
    s_lshl_b32 s37, s44, 7
    buffer_load_dwordx4 v48, s[16:19], s37 offen lds
    s_add_u32 m0, s39, 132096
    s_lshl_b32 s37, s44, 7
    buffer_load_dwordx4 v49, s[16:19], s37 offen lds
    s_add_u32 m0, s39, 139264
    s_lshl_b32 s37, s45, 7
    buffer_load_dwordx4 v48, s[16:19], s37 offen lds
    s_add_u32 m0, s39, 140288
    s_lshl_b32 s37, s45, 7
    buffer_load_dwordx4 v49, s[16:19], s37 offen lds
    s_add_u32 m0, s39, 147456
    s_lshl_b32 s37, s46, 7
    buffer_load_dwordx4 v48, s[16:19], s37 offen lds
    s_add_u32 m0, s39, 148480
    s_lshl_b32 s37, s46, 7
    buffer_load_dwordx4 v49, s[16:19], s37 offen lds
    s_mov_b32 s37, s2
    s_or_b32 s37, s37, s3
    s_or_b32 s37, s37, s101
    s_cbranch_scc1 L_nonon
    s_mul_i32 s7, s7, 2654435761
    s_xor_b32 s6, s6, s7
    s_or_b32 s6, s6, 1
    v_mov_b32 v32, s6
    v_mov_b32 v33, 0
    s_mov_b64 exec, 1
    global_store_dword v33, v32, s[76:77] sc1
    s_mov_b64 exec, -1
L_nonon:
    s_lshr_b32 s4, s3, 1
    s_and_b32 s5, s3, 1
    s_lshl_b32 s32, s3, 13
    v_and_b32 v26, 15, v0
    v_lshrrev_b32 v27, 4, v0
    v_lshl_add_u32 v8, v24, 9, v28
    v_xor_b32 v9, 64, v8
    v_add_u32 v9, 4096, v9
    v_lshl_add_u32 v10, v24, 9, v29
    v_lshrrev_b32 v28, 1, v26
    v_xor_b32 v28, v27, v28
    v_lshlrev_b32 v28, 4, v28
    v_and_b32 v29, 7, v26
    v_lshl_add_u32 v28, v29, 7, v28
    v_lshrrev_b32 v29, 3, v26
    v_lshl_add_u32 v51, v29, 10, v28
    v_add_u32 v51, 98304, v51
    v_xor_b32 v52, 64, v51
    v_lshl_add_u32 v2, v29, 12, v28
    s_lshl_b32 s37, s5, 14
    v_add_u32 v2, s37, v2
    v_xor_b32 v3, 64, v2
    v_bfe_u32 v31, v0, 2, 3
    v_lshrrev_b32 v30, 1, v31
    v_and_b32 v28, 3, v0
    v_lshlrev_b32 v28, 3, v28
    v_lshl_add_u32 v28, v31, 7, v28
    v_lshl_add_u32 v28, v30, 5, v28
    v_lshrrev_b32 v29, 5, v0
    v_lshl_add_u32 v53, v29, 10, v28
    v_add_u32 v53, s38, v53
    v_lshl_add_u32 v4, v29, 12, v28
    s_add_u32 s37, s37, 65536
    v_add_u32 v4, s37, v4
    v_xor_b32 v54, 32, v53
    v_xor_b32 v5, 32, v4
    v_xor_b32 v55, 64, v53
    v_xor_b32 v6, 64, v4
    v_xor_b32 v56, 96, v53
    v_xor_b32 v7, 96, v4
    s_lshl_b32 s37, s4, 14
    s_add_u32 s37, s37, 65536
    s_lshl_b32 s69, s5, 11
    s_add_u32 s69, s69, s37
    v_lshlrev_b32 v28, 4, v26
    v_lshl_add_u32 v28, v29, 8, v28
    v_and_b32 v29, 1, v27
    v_lshl_add_u32 v28, v29, 3, v28
    v_add_u32 v57, s69, v28
    s_lshl_b32 s69, s5, 13
    s_add_u32 s69, s69, s37
    v_lshlrev_b32 v28, 4, v0
    v_add_u32 v58, s69, v28
    v_xor_b32 v59, 8192, v58
    s_add_u32 m0, s38, 8192
    s_add_u32 s37, s63, 0
    buffer_load_dwordx4 v50, s[20:23], s37 offen offset:0 lds
    s_add_u32 s37, s63, 130048
    buffer_load_dwordx4 v50, s[20:23], s37 offen offset:1024 lds
    s_add_u32 s37, s63, 30720
    buffer_load_dwordx4 v50, s[20:23], s37 offen offset:2048 lds
    s_add_u32 s37, s63, 160768
    buffer_load_dwordx4 v50, s[20:23], s37 offen offset:3072 lds
    s_add_u32 m0, s38, 12288
    s_add_u32 s37, s63, 262144
    buffer_load_dwordx4 v50, s[20:23], s37 offen offset:0 lds
    s_add_u32 s37, s63, 392192
    buffer_load_dwordx4 v50, s[20:23], s37 offen offset:1024 lds
    s_add_u32 s37, s63, 292864
    buffer_load_dwordx4 v50, s[20:23], s37 offen offset:2048 lds
    s_add_u32 s37, s63, 422912
    buffer_load_dwordx4 v50, s[20:23], s37 offen offset:3072 lds
    s_waitcnt vmcnt(24)
    ds_read_b64_tr_b16 a[128:129], v53 offset:0
    ds_read_b64_tr_b16 a[130:131], v53 offset:2048
    ds_read_b64_tr_b16 a[132:133], v54 offset:0
    ds_read_b64_tr_b16 a[134:135], v54 offset:2048
    ds_read_b64_tr_b16 a[136:137], v55 offset:0
    ds_read_b64_tr_b16 a[138:139], v55 offset:2048
    ds_read_b64_tr_b16 a[140:141], v56 offset:0
    ds_read_b64_tr_b16 a[142:143], v56 offset:2048
    s_lshl_b32 s70, s49, 23
    s_lshl_b32 s71, s47, 20
    s_add_u32 s70, s70, s71
    s_lshl_b32 s71, s3, 18
    s_add_u32 s70, s70, s71
    s_add_u32 s8, s54, s70
    s_addc_u32 s9, s55, 0
    s_mov_b32 s10, 0x40000
    s_mov_b32 s11, 0x00020000
    s_waitcnt vmcnt(20)
    ds_read_b64_tr_b16 a[144:145], v53 offset:4096
    ds_read_b64_tr_b16 a[146:147], v53 offset:6144
    ds_read_b64_tr_b16 a[148:149], v54 offset:4096
    ds_read_b64_tr_b16 a[150:151], v54 offset:6144
    ds_read_b64_tr_b16 a[152:153], v55 offset:4096
    ds_read_b64_tr_b16 a[154:155], v55 offset:6144
    ds_read_b64_tr_b16 a[156:157], v56 offset:4096
    ds_read_b64_tr_b16 a[158:159], v56 offset:6144
    s_waitcnt lgkmcnt(8)
    s_add_u32 m0, s38, 0
    s_add_u32 s37, s64, 0
    buffer_load_dwordx4 v50, s[20:23], s37 offen offset:0 lds
    s_add_u32 s37, s64, 130048
    buffer_load_dwordx4 v50, s[20:23], s37 offen offset:1024 lds
    s_add_u32 s37, s64, 30720
    buffer_load_dwordx4 v50, s[20:23], s37 offen offset:2048 lds
    s_add_u32 s37, s64, 160768
    buffer_load_dwordx4 v50, s[20:23], s37 offen offset:3072 lds
    s_add_u32 s12, s56, s70
    s_addc_u32 s13, s57, 0
    s_mov_b32 s14, 0x40000
    s_mov_b32 s15, 0x00020000
    s_lshl_b32 s70, s47, 3
    s_add_u32 s70, s70, s3
    s_mul_i32 s70, s70, 57344
    s_waitcnt vmcnt(8)
    ds_read_b64_tr_b16 a[160:161], v53 offset:8192
    ds_read_b64_tr_b16 a[162:163], v53 offset:10240
    ds_read_b64_tr_b16 a[164:165], v54 offset:8192
    ds_read_b64_tr_b16 a[166:167], v54 offset:10240
    ds_read_b64_tr_b16 a[168:169], v55 offset:8192
    ds_read_b64_tr_b16 a[170:171], v55 offset:10240
    ds_read_b64_tr_b16 a[172:173], v56 offset:8192
    ds_read_b64_tr_b16 a[174:175], v56 offset:10240
    s_waitcnt lgkmcnt(8)
    s_add_u32 m0, s38, 4096
    s_add_u32 s37, s64, 262144
    buffer_load_dwordx4 v50, s[20:23], s37 offen offset:0 lds
    s_add_u32 s37, s64, 392192
    buffer_load_dwordx4 v50, s[20:23], s37 offen offset:1024 lds
    s_add_u32 s37, s64, 292864
    buffer_load_dwordx4 v50, s[20:23], s37 offen offset:2048 lds
    s_add_u32 s37, s64, 422912
    buffer_load_dwordx4 v50, s[20:23], s37 offen offset:3072 lds
    s_add_u32 s24, s60, s70
    s_addc_u32 s25, s61, 0
    s_sub_u32 s26, 3670016, s70
    s_mov_b32 s27, 0x00020000
    s_mul_i32 s70, s2, 57344
    s_lshl_b32 s71, s3, 11
    s_add_u32 s70, s70, s71
    s_waitcnt vmcnt(8)
    ds_read_b64_tr_b16 a[176:177], v53 offset:12288
    ds_read_b64_tr_b16 a[178:179], v53 offset:14336
    ds_read_b64_tr_b16 a[180:181], v54 offset:12288
    ds_read_b64_tr_b16 a[182:183], v54 offset:14336
    ds_read_b64_tr_b16 a[184:185], v55 offset:12288
    ds_read_b64_tr_b16 a[186:187], v55 offset:14336
    ds_read_b64_tr_b16 a[188:189], v56 offset:12288
    ds_read_b64_tr_b16 a[190:191], v56 offset:14336
    s_waitcnt lgkmcnt(8)
    s_add_u32 m0, s38, 8192
    s_add_u32 s37, s65, 0
    buffer_load_dwordx4 v50, s[20:23], s37 offen offset:0 lds
    s_add_u32 s37, s65, 130048
    buffer_load_dwordx4 v50, s[20:23], s37 offen offset:1024 lds
    s_add_u32 s37, s65, 30720
    buffer_load_dwordx4 v50, s[20:23], s37 offen offset:2048 lds
    s_add_u32 s37, s65, 160768
    buffer_load_dwordx4 v50, s[20:23], s37 offen offset:3072 lds
    s_add_u32 s28, s74, s70
    s_addc_u32 s29, s75, 0
    s_sub_u32 s30, 57344, s71
    s_mov_b32 s31, 0x00020000
    s_mov_b32 s6, 0x3db8aa3b
    v_mov_b32 v12, 0
    v_mov_b32 v13, 0
    v_mov_b32 v14, 0
    v_mov_b32 v15, 0
    s_waitcnt vmcnt(8)
    ds_read_b64_tr_b16 a[192:193], v53 offset:0
    ds_read_b64_tr_b16 a[194:195], v53 offset:2048
    ds_read_b64_tr_b16 a[196:197], v54 offset:0
    ds_read_b64_tr_b16 a[198:199], v54 offset:2048
    ds_read_b64_tr_b16 a[200:201], v55 offset:0
    ds_read_b64_tr_b16 a[202:203], v55 offset:2048
    ds_read_b64_tr_b16 a[204:205], v56 offset:0
    ds_read_b64_tr_b16 a[206:207], v56 offset:2048
    s_waitcnt lgkmcnt(8)
    s_add_u32 m0, s38, 12288
    s_add_u32 s37, s65, 262144
    buffer_load_dwordx4 v50, s[20:23], s37 offen offset:0 lds
    s_add_u32 s37, s65, 392192
    buffer_load_dwordx4 v50, s[20:23], s37 offen offset:1024 lds
    s_add_u32 s37, s65, 292864
    buffer_load_dwordx4 v50, s[20:23], s37 offen offset:2048 lds
    s_add_u32 s37, s65, 422912
    buffer_load_dwordx4 v50, s[20:23], s37 offen offset:3072 lds
    s_waitcnt vmcnt(8)
    ds_read_b64_tr_b16 a[208:209], v53 offset:4096
    ds_read_b64_tr_b16 a[210:211], v53 offset:6144
    ds_read_b64_tr_b16 a[212:213], v54 offset:4096
    ds_read_b64_tr_b16 a[214:215], v54 offset:6144
    ds_read_b64_tr_b16 a[216:217], v55 offset:4096
    ds_read_b64_tr_b16 a[218:219], v55 offset:6144
    ds_read_b64_tr_b16 a[220:221], v56 offset:4096
    ds_read_b64_tr_b16 a[222:223], v56 offset:6144
    s_waitcnt lgkmcnt(8)
    s_add_u32 m0, s38, 0
    s_add_u32 s37, s66, 0
    buffer_load_dwordx4 v50, s[20:23], s37 offen offset:0 lds
    s_add_u32 s37, s66, 130048
    buffer_load_dwordx4 v50, s[20:23], s37 offen offset:1024 lds
    s_add_u32 s37, s66, 30720
    buffer_load_dwordx4 v50, s[20:23], s37 offen offset:2048 lds
    s_add_u32 s37, s66, 160768
    buffer_load_dwordx4 v50, s[20:23], s37 offen offset:3072 lds
    s_waitcnt vmcnt(8)
    ds_read_b64_tr_b16 a[224:225], v53 offset:8192
    ds_read_b64_tr_b16 a[226:227], v53 offset:10240
    ds_read_b64_tr_b16 a[228:229], v54 offset:8192
    ds_read_b64_tr_b16 a[230:231], v54 offset:10240
    ds_read_b64_tr_b16 a[232:233], v55 offset:8192
    ds_read_b64_tr_b16 a[234:235], v55 offset:10240
    ds_read_b64_tr_b16 a[236:237], v56 offset:8192
    ds_read_b64_tr_b16 a[238:239], v56 offset:10240
    s_waitcnt lgkmcnt(8)
    s_add_u32 m0, s38, 4096
    s_add_u32 s37, s66, 262144
    buffer_load_dwordx4 v50, s[20:23], s37 offen offset:0 lds
    s_add_u32 s37, s66, 392192
    buffer_load_dwordx4 v50, s[20:23], s37 offen offset:1024 lds
    s_add_u32 s37, s66, 292864
    buffer_load_dwordx4 v50, s[20:23], s37 offen offset:2048 lds
    s_add_u32 s37, s66, 422912
    buffer_load_dwordx4 v50, s[20:23], s37 offen offset:3072 lds
    s_barrier
    ds_read_b128 v[96:99], v51 offset:0
    ds_read_b128 v[100:103], v51 offset:2048
    ds_read_b128 v[104:107], v51 offset:4096
    ds_read_b128 v[108:111], v51 offset:6144
    s_waitcnt lgkmcnt(4)
    s_add_u32 m0, s38, 8192
    s_add_u32 s37, s67, 0
    buffer_load_dwordx4 v50, s[20:23], s37 offen offset:0 lds
    s_add_u32 s37, s67, 130048
    buffer_load_dwordx4 v50, s[20:23], s37 offen offset:1024 lds
    s_add_u32 s37, s67, 30720
    buffer_load_dwordx4 v50, s[20:23], s37 offen offset:2048 lds
    s_add_u32 s37, s67, 160768
    buffer_load_dwordx4 v50, s[20:23], s37 offen offset:3072 lds
    s_waitcnt lgkmcnt(0)
    v_mfma_f32_16x16x32_bf16 v[160:163], a[136:139], v[96:99], 0
    s_waitcnt vmcnt(12)
    ds_read_b64_tr_b16 a[240:241], v53 offset:12288
    ds_read_b64_tr_b16 a[242:243], v53 offset:14336
    v_mfma_f32_16x16x32_bf16 v[176:179], a[140:143], v[96:99], 0
    ds_read_b64_tr_b16 a[244:245], v54 offset:12288
    ds_read_b64_tr_b16 a[246:247], v54 offset:14336
    v_mfma_f32_16x16x32_bf16 v[180:183], a[140:143], v[100:103], 0
    ds_read_b64_tr_b16 a[248:249], v55 offset:12288
    ds_read_b64_tr_b16 a[250:251], v55 offset:14336
    v_mfma_f32_16x16x32_bf16 v[164:167], a[136:139], v[100:103], 0
    v_mfma_f32_16x16x32_bf16 v[168:171], a[136:139], v[104:107], 0
    ds_read_b64_tr_b16 a[252:253], v56 offset:12288
    ds_read_b64_tr_b16 a[254:255], v56 offset:14336
    v_mfma_f32_16x16x32_bf16 v[184:187], a[140:143], v[104:107], 0
    ds_read_b128 v[112:115], v52 offset:0
    ds_read_b128 v[116:119], v52 offset:2048
    v_mfma_f32_16x16x32_bf16 v[188:191], a[140:143], v[108:111], 0
    ds_read_b128 v[120:123], v52 offset:4096
    ds_read_b128 v[124:127], v52 offset:6144
    v_mfma_f32_16x16x32_bf16 v[172:175], a[136:139], v[108:111], 0
    v_mfma_f32_16x16x32_bf16 v[140:143], a[128:131], v[108:111], 0
    v_mfma_f32_16x16x32_bf16 v[156:159], a[132:135], v[108:111], 0
    v_mfma_f32_16x16x32_bf16 v[152:155], a[132:135], v[104:107], 0
    s_add_u32 m0, s38, 12288
    s_add_u32 s37, s67, 262144
    v_mfma_f32_16x16x32_bf16 v[136:139], a[128:131], v[104:107], 0
    s_waitcnt lgkmcnt(4)
    buffer_load_dwordx4 v50, s[20:23], s37 offen offset:0 lds
    v_mfma_f32_16x16x32_bf16 v[132:135], a[128:131], v[100:103], 0
    v_mfma_f32_16x16x32_bf16 v[148:151], a[132:135], v[100:103], 0
    v_mfma_f32_16x16x32_bf16 v[144:147], a[132:135], v[96:99], 0
    s_add_u32 s37, s67, 392192
    v_mfma_f32_16x16x32_bf16 v[128:131], a[128:131], v[96:99], 0
    s_waitcnt lgkmcnt(0)
    buffer_load_dwordx4 v50, s[20:23], s37 offen offset:1024 lds
    v_mfma_f32_16x16x32_bf16 v[128:131], a[144:147], v[112:115], v[128:131]
    s_waitcnt vmcnt(10)
    ds_read_b64_tr_b16 a[128:129], v53 offset:0
    ds_read_b64_tr_b16 a[130:131], v53 offset:2048
    v_mfma_f32_16x16x32_bf16 v[144:147], a[148:151], v[112:115], v[144:147]
    ds_read_b64_tr_b16 a[132:133], v54 offset:0
    ds_read_b64_tr_b16 a[134:135], v54 offset:2048
    v_mfma_f32_16x16x32_bf16 v[148:151], a[148:151], v[116:119], v[148:151]
    ds_read_b64_tr_b16 a[136:137], v55 offset:0
    ds_read_b64_tr_b16 a[138:139], v55 offset:2048
    v_mfma_f32_16x16x32_bf16 v[132:135], a[144:147], v[116:119], v[132:135]
    s_add_u32 s37, s67, 292864
    buffer_load_dwordx4 v50, s[20:23], s37 offen offset:2048 lds
    v_mfma_f32_16x16x32_bf16 v[136:139], a[144:147], v[120:123], v[136:139]
    ds_read_b64_tr_b16 a[140:141], v56 offset:0
    ds_read_b64_tr_b16 a[142:143], v56 offset:2048
    v_mfma_f32_16x16x32_bf16 v[152:155], a[148:151], v[120:123], v[152:155]
    ds_read_b128 v[96:99], v51 offset:8192
    ds_read_b128 v[100:103], v51 offset:10240
    v_mfma_f32_16x16x32_bf16 v[156:159], a[148:151], v[124:127], v[156:159]
    ds_read_b128 v[104:107], v51 offset:12288
    ds_read_b128 v[108:111], v51 offset:14336
    v_mfma_f32_16x16x32_bf16 v[140:143], a[144:147], v[124:127], v[140:143]
    s_add_u32 s37, s67, 422912
    buffer_load_dwordx4 v50, s[20:23], s37 offen offset:3072 lds
    v_mfma_f32_16x16x32_bf16 v[172:175], a[152:155], v[124:127], v[172:175]
    v_mfma_f32_16x16x32_bf16 v[188:191], a[156:159], v[124:127], v[188:191]
    v_mfma_f32_16x16x32_bf16 v[184:187], a[156:159], v[120:123], v[184:187]
    s_add_u32 m0, s38, 0
    s_add_u32 s37, s68, 0
    v_mfma_f32_16x16x32_bf16 v[168:171], a[152:155], v[120:123], v[168:171]
    s_waitcnt lgkmcnt(4)
    buffer_load_dwordx4 v50, s[20:23], s37 offen offset:0 lds
    v_mfma_f32_16x16x32_bf16 v[164:167], a[152:155], v[116:119], v[164:167]
    v_mfma_f32_16x16x32_bf16 v[180:183], a[156:159], v[116:119], v[180:183]
    v_mfma_f32_16x16x32_bf16 v[176:179], a[156:159], v[112:115], v[176:179]
    s_add_u32 s37, s68, 130048
    v_mfma_f32_16x16x32_bf16 v[160:163], a[152:155], v[112:115], v[160:163]
    s_waitcnt lgkmcnt(0)
    buffer_load_dwordx4 v50, s[20:23], s37 offen offset:1024 lds
    v_mfma_f32_16x16x32_bf16 v[160:163], a[168:171], v[96:99], v[160:163]
    s_waitcnt vmcnt(10)
    ds_read_b64_tr_b16 a[144:145], v53 offset:4096
    ds_read_b64_tr_b16 a[146:147], v53 offset:6144
    v_mfma_f32_16x16x32_bf16 v[176:179], a[172:175], v[96:99], v[176:179]
    ds_read_b64_tr_b16 a[148:149], v54 offset:4096
    ds_read_b64_tr_b16 a[150:151], v54 offset:6144
    v_mfma_f32_16x16x32_bf16 v[180:183], a[172:175], v[100:103], v[180:183]
    ds_read_b64_tr_b16 a[152:153], v55 offset:4096
    ds_read_b64_tr_b16 a[154:155], v55 offset:6144
    v_mfma_f32_16x16x32_bf16 v[164:167], a[168:171], v[100:103], v[164:167]
    s_add_u32 s37, s68, 30720
    buffer_load_dwordx4 v50, s[20:23], s37 offen offset:2048 lds
    v_mfma_f32_16x16x32_bf16 v[168:171], a[168:171], v[104:107], v[168:171]
    ds_read_b64_tr_b16 a[156:157], v56 offset:4096
    ds_read_b64_tr_b16 a[158:159], v56 offset:6144
    v_mfma_f32_16x16x32_bf16 v[184:187], a[172:175], v[104:107], v[184:187]
    ds_read_b128 v[112:115], v52 offset:8192
    ds_read_b128 v[116:119], v52 offset:10240
    v_mfma_f32_16x16x32_bf16 v[188:191], a[172:175], v[108:111], v[188:191]
    ds_read_b128 v[120:123], v52 offset:12288
    ds_read_b128 v[124:127], v52 offset:14336
    v_mfma_f32_16x16x32_bf16 v[172:175], a[168:171], v[108:111], v[172:175]
    s_add_u32 s37, s68, 160768
    buffer_load_dwordx4 v50, s[20:23], s37 offen offset:3072 lds
    v_mfma_f32_16x16x32_bf16 v[140:143], a[160:163], v[108:111], v[140:143]
    v_mfma_f32_16x16x32_bf16 v[156:159], a[164:167], v[108:111], v[156:159]
    v_mfma_f32_16x16x32_bf16 v[152:155], a[164:167], v[104:107], v[152:155]
    s_add_u32 m0, s38, 4096
    s_add_u32 s37, s68, 262144
    v_mfma_f32_16x16x32_bf16 v[136:139], a[160:163], v[104:107], v[136:139]
    s_waitcnt lgkmcnt(4)
    buffer_load_dwordx4 v50, s[20:23], s37 offen offset:0 lds
    v_mfma_f32_16x16x32_bf16 v[132:135], a[160:163], v[100:103], v[132:135]
    v_mfma_f32_16x16x32_bf16 v[148:151], a[164:167], v[100:103], v[148:151]
    v_mfma_f32_16x16x32_bf16 v[144:147], a[164:167], v[96:99], v[144:147]
    s_add_u32 s37, s68, 392192
    v_mfma_f32_16x16x32_bf16 v[128:131], a[160:163], v[96:99], v[128:131]
    s_waitcnt lgkmcnt(0)
    buffer_load_dwordx4 v50, s[20:23], s37 offen offset:1024 lds
    v_mfma_f32_16x16x32_bf16 v[128:131], a[176:179], v[112:115], v[128:131]
    s_waitcnt vmcnt(10)
    ds_read_b64_tr_b16 a[160:161], v53 offset:8192
    ds_read_b64_tr_b16 a[162:163], v53 offset:10240
    v_mfma_f32_16x16x32_bf16 v[144:147], a[180:183], v[112:115], v[144:147]
    ds_read_b64_tr_b16 a[164:165], v54 offset:8192
    ds_read_b64_tr_b16 a[166:167], v54 offset:10240
    v_mfma_f32_16x16x32_bf16 v[148:151], a[180:183], v[116:119], v[148:151]
    ds_read_b64_tr_b16 a[168:169], v55 offset:8192
    ds_read_b64_tr_b16 a[170:171], v55 offset:10240
    v_mfma_f32_16x16x32_bf16 v[132:135], a[176:179], v[116:119], v[132:135]
    s_add_u32 s37, s68, 292864
    buffer_load_dwordx4 v50, s[20:23], s37 offen offset:2048 lds
    v_mfma_f32_16x16x32_bf16 v[136:139], a[176:179], v[120:123], v[136:139]
    ds_read_b64_tr_b16 a[172:173], v56 offset:8192
    ds_read_b64_tr_b16 a[174:175], v56 offset:10240
    v_mfma_f32_16x16x32_bf16 v[152:155], a[180:183], v[120:123], v[152:155]
    ds_read_b128 v[96:99], v51 offset:16384
    ds_read_b128 v[100:103], v51 offset:18432
    v_mfma_f32_16x16x32_bf16 v[156:159], a[180:183], v[124:127], v[156:159]
    ds_read_b128 v[104:107], v51 offset:20480
    ds_read_b128 v[108:111], v51 offset:22528
    v_mfma_f32_16x16x32_bf16 v[140:143], a[176:179], v[124:127], v[140:143]
    s_add_u32 s37, s68, 422912
    buffer_load_dwordx4 v50, s[20:23], s37 offen offset:3072 lds
    v_mfma_f32_16x16x32_bf16 v[172:175], a[184:187], v[124:127], v[172:175]
    v_mfma_f32_16x16x32_bf16 v[188:191], a[188:191], v[124:127], v[188:191]
    v_mfma_f32_16x16x32_bf16 v[184:187], a[188:191], v[120:123], v[184:187]
    s_add_u32 m0, s38, 8192
    s_add_u32 s37, s62, 128
    v_mfma_f32_16x16x32_bf16 v[168:171], a[184:187], v[120:123], v[168:171]
    s_waitcnt lgkmcnt(4)
    buffer_load_dwordx4 v50, s[20:23], s37 offen offset:0 lds
    v_mfma_f32_16x16x32_bf16 v[164:167], a[184:187], v[116:119], v[164:167]
    v_mfma_f32_16x16x32_bf16 v[180:183], a[188:191], v[116:119], v[180:183]
    v_mfma_f32_16x16x32_bf16 v[176:179], a[188:191], v[112:115], v[176:179]
    s_add_u32 s37, s62, 130176
    v_mfma_f32_16x16x32_bf16 v[160:163], a[184:187], v[112:115], v[160:163]
    s_waitcnt lgkmcnt(0)
    buffer_load_dwordx4 v50, s[20:23], s37 offen offset:1024 lds
    v_mfma_f32_16x16x32_bf16 v[160:163], a[200:203], v[96:99], v[160:163]
    s_waitcnt vmcnt(10)
    ds_read_b64_tr_b16 a[176:177], v53 offset:12288
    ds_read_b64_tr_b16 a[178:179], v53 offset:14336
    v_mfma_f32_16x16x32_bf16 v[176:179], a[204:207], v[96:99], v[176:179]
    ds_read_b64_tr_b16 a[180:181], v54 offset:12288
    ds_read_b64_tr_b16 a[182:183], v54 offset:14336
    v_mfma_f32_16x16x32_bf16 v[180:183], a[204:207], v[100:103], v[180:183]
    ds_read_b64_tr_b16 a[184:185], v55 offset:12288
    ds_read_b64_tr_b16 a[186:187], v55 offset:14336
    v_mfma_f32_16x16x32_bf16 v[164:167], a[200:203], v[100:103], v[164:167]
    s_add_u32 s37, s62, 30848
    buffer_load_dwordx4 v50, s[20:23], s37 offen offset:2048 lds
    v_mfma_f32_16x16x32_bf16 v[168:171], a[200:203], v[104:107], v[168:171]
    ds_read_b64_tr_b16 a[188:189], v56 offset:12288
    ds_read_b64_tr_b16 a[190:191], v56 offset:14336
    v_mfma_f32_16x16x32_bf16 v[184:187], a[204:207], v[104:107], v[184:187]
    ds_read_b128 v[112:115], v52 offset:16384
    ds_read_b128 v[116:119], v52 offset:18432
    v_mfma_f32_16x16x32_bf16 v[188:191], a[204:207], v[108:111], v[188:191]
    ds_read_b128 v[120:123], v52 offset:20480
    ds_read_b128 v[124:127], v52 offset:22528
    v_mfma_f32_16x16x32_bf16 v[172:175], a[200:203], v[108:111], v[172:175]
    s_add_u32 s37, s62, 160896
    buffer_load_dwordx4 v50, s[20:23], s37 offen offset:3072 lds
    v_mfma_f32_16x16x32_bf16 v[140:143], a[192:195], v[108:111], v[140:143]
    v_mfma_f32_16x16x32_bf16 v[156:159], a[196:199], v[108:111], v[156:159]
    v_mfma_f32_16x16x32_bf16 v[152:155], a[196:199], v[104:107], v[152:155]
    s_add_u32 m0, s38, 12288
    s_add_u32 s37, s62, 262272
    v_mfma_f32_16x16x32_bf16 v[136:139], a[192:195], v[104:107], v[136:139]
    s_waitcnt lgkmcnt(4)
    buffer_load_dwordx4 v50, s[20:23], s37 offen offset:0 lds
    v_mfma_f32_16x16x32_bf16 v[132:135], a[192:195], v[100:103], v[132:135]
    v_mfma_f32_16x16x32_bf16 v[148:151], a[196:199], v[100:103], v[148:151]
    v_mfma_f32_16x16x32_bf16 v[144:147], a[196:199], v[96:99], v[144:147]
    s_add_u32 s37, s62, 392320
    v_mfma_f32_16x16x32_bf16 v[128:131], a[192:195], v[96:99], v[128:131]
    s_waitcnt lgkmcnt(0)
    buffer_load_dwordx4 v50, s[20:23], s37 offen offset:1024 lds
    v_mfma_f32_16x16x32_bf16 v[128:131], a[208:211], v[112:115], v[128:131]
    s_waitcnt vmcnt(10)
    ds_read_b64_tr_b16 a[192:193], v53 offset:0
    ds_read_b64_tr_b16 a[194:195], v53 offset:2048
    v_mfma_f32_16x16x32_bf16 v[144:147], a[212:215], v[112:115], v[144:147]
    ds_read_b64_tr_b16 a[196:197], v54 offset:0
    ds_read_b64_tr_b16 a[198:199], v54 offset:2048
    v_mfma_f32_16x16x32_bf16 v[148:151], a[212:215], v[116:119], v[148:151]
    ds_read_b64_tr_b16 a[200:201], v55 offset:0
    ds_read_b64_tr_b16 a[202:203], v55 offset:2048
    v_mfma_f32_16x16x32_bf16 v[132:135], a[208:211], v[116:119], v[132:135]
    s_add_u32 s37, s62, 292992
    buffer_load_dwordx4 v50, s[20:23], s37 offen offset:2048 lds
    v_mfma_f32_16x16x32_bf16 v[136:139], a[208:211], v[120:123], v[136:139]
    ds_read_b64_tr_b16 a[204:205], v56 offset:0
    ds_read_b64_tr_b16 a[206:207], v56 offset:2048
    v_mfma_f32_16x16x32_bf16 v[152:155], a[212:215], v[120:123], v[152:155]
    ds_read_b128 v[96:99], v51 offset:24576
    ds_read_b128 v[100:103], v51 offset:26624
    v_mfma_f32_16x16x32_bf16 v[156:159], a[212:215], v[124:127], v[156:159]
    ds_read_b128 v[104:107], v51 offset:28672
    ds_read_b128 v[108:111], v51 offset:30720
    v_mfma_f32_16x16x32_bf16 v[140:143], a[208:211], v[124:127], v[140:143]
    s_add_u32 s37, s62, 423040
    buffer_load_dwordx4 v50, s[20:23], s37 offen offset:3072 lds
    v_mfma_f32_16x16x32_bf16 v[172:175], a[216:219], v[124:127], v[172:175]
    v_mfma_f32_16x16x32_bf16 v[188:191], a[220:223], v[124:127], v[188:191]
    v_mfma_f32_16x16x32_bf16 v[184:187], a[220:223], v[120:123], v[184:187]
    s_add_u32 m0, s38, 0
    s_add_u32 s37, s63, 128
    v_mfma_f32_16x16x32_bf16 v[168:171], a[216:219], v[120:123], v[168:171]
    s_waitcnt lgkmcnt(4)
    buffer_load_dwordx4 v50, s[20:23], s37 offen offset:0 lds
    v_mfma_f32_16x16x32_bf16 v[164:167], a[216:219], v[116:119], v[164:167]
    v_mfma_f32_16x16x32_bf16 v[180:183], a[220:223], v[116:119], v[180:183]
    v_mfma_f32_16x16x32_bf16 v[176:179], a[220:223], v[112:115], v[176:179]
    s_add_u32 s37, s63, 130176
    v_mfma_f32_16x16x32_bf16 v[160:163], a[216:219], v[112:115], v[160:163]
    s_waitcnt lgkmcnt(0)
    buffer_load_dwordx4 v50, s[20:23], s37 offen offset:1024 lds
    v_mfma_f32_16x16x32_bf16 v[160:163], a[232:235], v[96:99], v[160:163]
    s_waitcnt vmcnt(10)
    ds_read_b64_tr_b16 a[208:209], v53 offset:4096
    ds_read_b64_tr_b16 a[210:211], v53 offset:6144
    v_mfma_f32_16x16x32_bf16 v[176:179], a[236:239], v[96:99], v[176:179]
    ds_read_b64_tr_b16 a[212:213], v54 offset:4096
    ds_read_b64_tr_b16 a[214:215], v54 offset:6144
    v_mfma_f32_16x16x32_bf16 v[180:183], a[236:239], v[100:103], v[180:183]
    ds_read_b64_tr_b16 a[216:217], v55 offset:4096
    ds_read_b64_tr_b16 a[218:219], v55 offset:6144
    v_mfma_f32_16x16x32_bf16 v[164:167], a[232:235], v[100:103], v[164:167]
    s_add_u32 s37, s63, 30848
    buffer_load_dwordx4 v50, s[20:23], s37 offen offset:2048 lds
    v_mfma_f32_16x16x32_bf16 v[168:171], a[232:235], v[104:107], v[168:171]
    ds_read_b64_tr_b16 a[220:221], v56 offset:4096
    ds_read_b64_tr_b16 a[222:223], v56 offset:6144
    v_mfma_f32_16x16x32_bf16 v[184:187], a[236:239], v[104:107], v[184:187]
    ds_read_b128 v[112:115], v52 offset:24576
    ds_read_b128 v[116:119], v52 offset:26624
    v_mfma_f32_16x16x32_bf16 v[188:191], a[236:239], v[108:111], v[188:191]
    ds_read_b128 v[120:123], v52 offset:28672
    ds_read_b128 v[124:127], v52 offset:30720
    v_mfma_f32_16x16x32_bf16 v[172:175], a[232:235], v[108:111], v[172:175]
    s_add_u32 s37, s63, 160896
    buffer_load_dwordx4 v50, s[20:23], s37 offen offset:3072 lds
    v_mfma_f32_16x16x32_bf16 v[140:143], a[224:227], v[108:111], v[140:143]
    v_mfma_f32_16x16x32_bf16 v[156:159], a[228:231], v[108:111], v[156:159]
    v_mfma_f32_16x16x32_bf16 v[152:155], a[228:231], v[104:107], v[152:155]
    s_add_u32 m0, s38, 4096
    s_add_u32 s37, s63, 262272
    v_mfma_f32_16x16x32_bf16 v[136:139], a[224:227], v[104:107], v[136:139]
    s_waitcnt lgkmcnt(4)
    buffer_load_dwordx4 v50, s[20:23], s37 offen offset:0 lds
    v_mfma_f32_16x16x32_bf16 v[132:135], a[224:227], v[100:103], v[132:135]
    v_mfma_f32_16x16x32_bf16 v[148:151], a[228:231], v[100:103], v[148:151]
    v_mfma_f32_16x16x32_bf16 v[144:147], a[228:231], v[96:99], v[144:147]
    s_add_u32 s37, s63, 392320
    v_mfma_f32_16x16x32_bf16 v[128:131], a[224:227], v[96:99], v[128:131]
    s_waitcnt lgkmcnt(0)
    buffer_load_dwordx4 v50, s[20:23], s37 offen offset:1024 lds
    v_mfma_f32_16x16x32_bf16 v[128:131], a[240:243], v[112:115], v[128:131]
    s_waitcnt vmcnt(10)
    ds_read_b64_tr_b16 a[224:225], v53 offset:8192
    ds_read_b64_tr_b16 a[226:227], v53 offset:10240
    v_mfma_f32_16x16x32_bf16 v[144:147], a[244:247], v[112:115], v[144:147]
    ds_read_b64_tr_b16 a[228:229], v54 offset:8192
    ds_read_b64_tr_b16 a[230:231], v54 offset:10240
    v_mfma_f32_16x16x32_bf16 v[148:151], a[244:247], v[116:119], v[148:151]
    ds_read_b64_tr_b16 a[232:233], v55 offset:8192
    ds_read_b64_tr_b16 a[234:235], v55 offset:10240
    v_mfma_f32_16x16x32_bf16 v[132:135], a[240:243], v[116:119], v[132:135]
    s_add_u32 s37, s63, 292992
    buffer_load_dwordx4 v50, s[20:23], s37 offen offset:2048 lds
    v_mfma_f32_16x16x32_bf16 v[136:139], a[240:243], v[120:123], v[136:139]
    ds_read_b64_tr_b16 a[236:237], v56 offset:8192
    ds_read_b64_tr_b16 a[238:239], v56 offset:10240
    v_mfma_f32_16x16x32_bf16 v[152:155], a[244:247], v[120:123], v[152:155]
    ds_read_b128 v[96:99], v51 offset:32768
    ds_read_b128 v[100:103], v51 offset:34816
    v_mfma_f32_16x16x32_bf16 v[156:159], a[244:247], v[124:127], v[156:159]
    ds_read_b128 v[104:107], v51 offset:36864
    ds_read_b128 v[108:111], v51 offset:38912
    v_mfma_f32_16x16x32_bf16 v[140:143], a[240:243], v[124:127], v[140:143]
    s_add_u32 s37, s63, 423040
    buffer_load_dwordx4 v50, s[20:23], s37 offen offset:3072 lds
    v_mfma_f32_16x16x32_bf16 v[172:175], a[248:251], v[124:127], v[172:175]
    v_mfma_f32_16x16x32_bf16 v[188:191], a[252:255], v[124:127], v[188:191]
    v_mfma_f32_16x16x32_bf16 v[184:187], a[252:255], v[120:123], v[184:187]
    s_add_u32 m0, s38, 8192
    s_add_u32 s37, s64, 128
    v_mfma_f32_16x16x32_bf16 v[168:171], a[248:251], v[120:123], v[168:171]
    s_waitcnt lgkmcnt(4)
    buffer_load_dwordx4 v50, s[20:23], s37 offen offset:0 lds
    v_mfma_f32_16x16x32_bf16 v[164:167], a[248:251], v[116:119], v[164:167]
    v_mfma_f32_16x16x32_bf16 v[180:183], a[252:255], v[116:119], v[180:183]
    v_mfma_f32_16x16x32_bf16 v[176:179], a[252:255], v[112:115], v[176:179]
    s_add_u32 s37, s64, 130176
    v_mfma_f32_16x16x32_bf16 v[160:163], a[248:251], v[112:115], v[160:163]
    s_waitcnt lgkmcnt(0)
    buffer_load_dwordx4 v50, s[20:23], s37 offen offset:1024 lds
    v_mfma_f32_16x16x32_bf16 v[160:163], a[136:139], v[96:99], v[160:163]
    s_waitcnt vmcnt(10)
    ds_read_b64_tr_b16 a[240:241], v53 offset:12288
    ds_read_b64_tr_b16 a[242:243], v53 offset:14336
    v_mfma_f32_16x16x32_bf16 v[176:179], a[140:143], v[96:99], v[176:179]
    ds_read_b64_tr_b16 a[244:245], v54 offset:12288
    ds_read_b64_tr_b16 a[246:247], v54 offset:14336
    v_mfma_f32_16x16x32_bf16 v[180:183], a[140:143], v[100:103], v[180:183]
    ds_read_b64_tr_b16 a[248:249], v55 offset:12288
    ds_read_b64_tr_b16 a[250:251], v55 offset:14336
    v_mfma_f32_16x16x32_bf16 v[164:167], a[136:139], v[100:103], v[164:167]
    s_add_u32 s37, s64, 30848
    buffer_load_dwordx4 v50, s[20:23], s37 offen offset:2048 lds
    v_mfma_f32_16x16x32_bf16 v[168:171], a[136:139], v[104:107], v[168:171]
    ds_read_b64_tr_b16 a[252:253], v56 offset:12288
    ds_read_b64_tr_b16 a[254:255], v56 offset:14336
    v_mfma_f32_16x16x32_bf16 v[184:187], a[140:143], v[104:107], v[184:187]
    ds_read_b128 v[112:115], v52 offset:32768
    ds_read_b128 v[116:119], v52 offset:34816
    v_mfma_f32_16x16x32_bf16 v[188:191], a[140:143], v[108:111], v[188:191]
    ds_read_b128 v[120:123], v52 offset:36864
    ds_read_b128 v[124:127], v52 offset:38912
    v_mfma_f32_16x16x32_bf16 v[172:175], a[136:139], v[108:111], v[172:175]
    s_add_u32 s37, s64, 160896
    buffer_load_dwordx4 v50, s[20:23], s37 offen offset:3072 lds
    v_mfma_f32_16x16x32_bf16 v[140:143], a[128:131], v[108:111], v[140:143]
    v_mfma_f32_16x16x32_bf16 v[156:159], a[132:135], v[108:111], v[156:159]
    v_mfma_f32_16x16x32_bf16 v[152:155], a[132:135], v[104:107], v[152:155]
    s_add_u32 m0, s38, 12288
    s_add_u32 s37, s64, 262272
    v_mfma_f32_16x16x32_bf16 v[136:139], a[128:131], v[104:107], v[136:139]
    s_waitcnt lgkmcnt(4)
    buffer_load_dwordx4 v50, s[20:23], s37 offen offset:0 lds
    v_mfma_f32_16x16x32_bf16 v[132:135], a[128:131], v[100:103], v[132:135]
    v_mfma_f32_16x16x32_bf16 v[148:151], a[132:135], v[100:103], v[148:151]
    v_mfma_f32_16x16x32_bf16 v[144:147], a[132:135], v[96:99], v[144:147]
    s_add_u32 s37, s64, 392320
    v_mfma_f32_16x16x32_bf16 v[128:131], a[128:131], v[96:99], v[128:131]
    s_waitcnt lgkmcnt(0)
    buffer_load_dwordx4 v50, s[20:23], s37 offen offset:1024 lds
    v_mfma_f32_16x16x32_bf16 v[128:131], a[144:147], v[112:115], v[128:131]
    s_waitcnt vmcnt(10)
    ds_read_b64_tr_b16 a[128:129], v53 offset:0
    ds_read_b64_tr_b16 a[130:131], v53 offset:2048
    v_mfma_f32_16x16x32_bf16 v[144:147], a[148:151], v[112:115], v[144:147]
    ds_read_b64_tr_b16 a[132:133], v54 offset:0
    ds_read_b64_tr_b16 a[134:135], v54 offset:2048
    v_mfma_f32_16x16x32_bf16 v[148:151], a[148:151], v[116:119], v[148:151]
    ds_read_b64_tr_b16 a[136:137], v55 offset:0
    ds_read_b64_tr_b16 a[138:139], v55 offset:2048
    v_mfma_f32_16x16x32_bf16 v[132:135], a[144:147], v[116:119], v[132:135]
    s_add_u32 s37, s64, 292992
    buffer_load_dwordx4 v50, s[20:23], s37 offen offset:2048 lds
    v_mfma_f32_16x16x32_bf16 v[136:139], a[144:147], v[120:123], v[136:139]
    ds_read_b64_tr_b16 a[140:141], v56 offset:0
    ds_read_b64_tr_b16 a[142:143], v56 offset:2048
    v_mfma_f32_16x16x32_bf16 v[152:155], a[148:151], v[120:123], v[152:155]
    ds_read_b128 v[96:99], v51 offset:40960
    ds_read_b128 v[100:103], v51 offset:43008
    v_mfma_f32_16x16x32_bf16 v[156:159], a[148:151], v[124:127], v[156:159]
    ds_read_b128 v[104:107], v51 offset:45056
    ds_read_b128 v[108:111], v51 offset:47104
    v_mfma_f32_16x16x32_bf16 v[140:143], a[144:147], v[124:127], v[140:143]
    s_add_u32 s37, s64, 423040
    buffer_load_dwordx4 v50, s[20:23], s37 offen offset:3072 lds
    v_mfma_f32_16x16x32_bf16 v[172:175], a[152:155], v[124:127], v[172:175]
    v_mfma_f32_16x16x32_bf16 v[188:191], a[156:159], v[124:127], v[188:191]
    v_mfma_f32_16x16x32_bf16 v[184:187], a[156:159], v[120:123], v[184:187]
    s_add_u32 m0, s38, 0
    s_add_u32 s37, s65, 128
    v_mfma_f32_16x16x32_bf16 v[168:171], a[152:155], v[120:123], v[168:171]
    s_waitcnt lgkmcnt(4)
    buffer_load_dwordx4 v50, s[20:23], s37 offen offset:0 lds
    v_mfma_f32_16x16x32_bf16 v[164:167], a[152:155], v[116:119], v[164:167]
    v_mfma_f32_16x16x32_bf16 v[180:183], a[156:159], v[116:119], v[180:183]
    v_mfma_f32_16x16x32_bf16 v[176:179], a[156:159], v[112:115], v[176:179]
    s_add_u32 s37, s65, 130176
    v_mfma_f32_16x16x32_bf16 v[160:163], a[152:155], v[112:115], v[160:163]
    s_waitcnt lgkmcnt(0)
    buffer_load_dwordx4 v50, s[20:23], s37 offen offset:1024 lds
    v_mfma_f32_16x16x32_bf16 v[160:163], a[168:171], v[96:99], v[160:163]
    s_waitcnt vmcnt(10)
    ds_read_b64_tr_b16 a[144:145], v53 offset:4096
    ds_read_b64_tr_b16 a[146:147], v53 offset:6144
    v_mfma_f32_16x16x32_bf16 v[176:179], a[172:175], v[96:99], v[176:179]
    ds_read_b64_tr_b16 a[148:149], v54 offset:4096
    ds_read_b64_tr_b16 a[150:151], v54 offset:6144
    v_mfma_f32_16x16x32_bf16 v[180:183], a[172:175], v[100:103], v[180:183]
    ds_read_b64_tr_b16 a[152:153], v55 offset:4096
    ds_read_b64_tr_b16 a[154:155], v55 offset:6144
    v_mfma_f32_16x16x32_bf16 v[164:167], a[168:171], v[100:103], v[164:167]
    s_add_u32 s37, s65, 30848
    buffer_load_dwordx4 v50, s[20:23], s37 offen offset:2048 lds
    v_mfma_f32_16x16x32_bf16 v[168:171], a[168:171], v[104:107], v[168:171]
    ds_read_b64_tr_b16 a[156:157], v56 offset:4096
    ds_read_b64_tr_b16 a[158:159], v56 offset:6144
    v_mfma_f32_16x16x32_bf16 v[184:187], a[172:175], v[104:107], v[184:187]
    ds_read_b128 v[112:115], v52 offset:40960
    ds_read_b128 v[116:119], v52 offset:43008
    v_mfma_f32_16x16x32_bf16 v[188:191], a[172:175], v[108:111], v[188:191]
    ds_read_b128 v[120:123], v52 offset:45056
    ds_read_b128 v[124:127], v52 offset:47104
    v_mfma_f32_16x16x32_bf16 v[172:175], a[168:171], v[108:111], v[172:175]
    s_add_u32 s37, s65, 160896
    buffer_load_dwordx4 v50, s[20:23], s37 offen offset:3072 lds
    v_mfma_f32_16x16x32_bf16 v[140:143], a[160:163], v[108:111], v[140:143]
    v_mfma_f32_16x16x32_bf16 v[156:159], a[164:167], v[108:111], v[156:159]
    v_mfma_f32_16x16x32_bf16 v[152:155], a[164:167], v[104:107], v[152:155]
    s_add_u32 m0, s38, 4096
    s_add_u32 s37, s65, 262272
    v_mfma_f32_16x16x32_bf16 v[136:139], a[160:163], v[104:107], v[136:139]
    s_waitcnt lgkmcnt(4)
    buffer_load_dwordx4 v50, s[20:23], s37 offen offset:0 lds
    v_mfma_f32_16x16x32_bf16 v[132:135], a[160:163], v[100:103], v[132:135]
    v_mfma_f32_16x16x32_bf16 v[148:151], a[164:167], v[100:103], v[148:151]
    v_mfma_f32_16x16x32_bf16 v[144:147], a[164:167], v[96:99], v[144:147]
    s_add_u32 s37, s65, 392320
    v_mfma_f32_16x16x32_bf16 v[128:131], a[160:163], v[96:99], v[128:131]
    s_waitcnt lgkmcnt(0)
    buffer_load_dwordx4 v50, s[20:23], s37 offen offset:1024 lds
    v_mfma_f32_16x16x32_bf16 v[128:131], a[176:179], v[112:115], v[128:131]
    s_waitcnt vmcnt(10)
    ds_read_b64_tr_b16 a[160:161], v53 offset:8192
    ds_read_b64_tr_b16 a[162:163], v53 offset:10240
    v_mfma_f32_16x16x32_bf16 v[144:147], a[180:183], v[112:115], v[144:147]
    ds_read_b64_tr_b16 a[164:165], v54 offset:8192
    ds_read_b64_tr_b16 a[166:167], v54 offset:10240
    v_mfma_f32_16x16x32_bf16 v[148:151], a[180:183], v[116:119], v[148:151]
    ds_read_b64_tr_b16 a[168:169], v55 offset:8192
    ds_read_b64_tr_b16 a[170:171], v55 offset:10240
    v_mfma_f32_16x16x32_bf16 v[132:135], a[176:179], v[116:119], v[132:135]
    s_add_u32 s37, s65, 292992
    buffer_load_dwordx4 v50, s[20:23], s37 offen offset:2048 lds
    v_mfma_f32_16x16x32_bf16 v[136:139], a[176:179], v[120:123], v[136:139]
    ds_read_b64_tr_b16 a[172:173], v56 offset:8192
    ds_read_b64_tr_b16 a[174:175], v56 offset:10240
    v_mfma_f32_16x16x32_bf16 v[152:155], a[180:183], v[120:123], v[152:155]
    ds_read_b128 v[96:99], v51 offset:49152
    ds_read_b128 v[100:103], v51 offset:51200
    v_mfma_f32_16x16x32_bf16 v[156:159], a[180:183], v[124:127], v[156:159]
    ds_read_b128 v[104:107], v51 offset:53248
    ds_read_b128 v[108:111], v51 offset:55296
    v_mfma_f32_16x16x32_bf16 v[140:143], a[176:179], v[124:127], v[140:143]
    s_add_u32 s37, s65, 423040
    buffer_load_dwordx4 v50, s[20:23], s37 offen offset:3072 lds
    v_mfma_f32_16x16x32_bf16 v[172:175], a[184:187], v[124:127], v[172:175]
    v_mfma_f32_16x16x32_bf16 v[188:191], a[188:191], v[124:127], v[188:191]
    v_mfma_f32_16x16x32_bf16 v[184:187], a[188:191], v[120:123], v[184:187]
    s_add_u32 m0, s38, 8192
    s_add_u32 s37, s66, 128
    v_mfma_f32_16x16x32_bf16 v[168:171], a[184:187], v[120:123], v[168:171]
    s_waitcnt lgkmcnt(4)
    buffer_load_dwordx4 v50, s[20:23], s37 offen offset:0 lds
    v_mfma_f32_16x16x32_bf16 v[164:167], a[184:187], v[116:119], v[164:167]
    v_mfma_f32_16x16x32_bf16 v[180:183], a[188:191], v[116:119], v[180:183]
    v_mfma_f32_16x16x32_bf16 v[176:179], a[188:191], v[112:115], v[176:179]
    s_add_u32 s37, s66, 130176
    v_mfma_f32_16x16x32_bf16 v[160:163], a[184:187], v[112:115], v[160:163]
    s_waitcnt lgkmcnt(0)
    buffer_load_dwordx4 v50, s[20:23], s37 offen offset:1024 lds
    v_mfma_f32_16x16x32_bf16 v[160:163], a[200:203], v[96:99], v[160:163]
    s_waitcnt vmcnt(10)
    ds_read_b64_tr_b16 a[176:177], v53 offset:12288
    ds_read_b64_tr_b16 a[178:179], v53 offset:14336
    v_mfma_f32_16x16x32_bf16 v[176:179], a[204:207], v[96:99], v[176:179]
    ds_read_b64_tr_b16 a[180:181], v54 offset:12288
    ds_read_b64_tr_b16 a[182:183], v54 offset:14336
    v_mfma_f32_16x16x32_bf16 v[180:183], a[204:207], v[100:103], v[180:183]
    ds_read_b64_tr_b16 a[184:185], v55 offset:12288
    ds_read_b64_tr_b16 a[186:187], v55 offset:14336
    v_mfma_f32_16x16x32_bf16 v[164:167], a[200:203], v[100:103], v[164:167]
    s_add_u32 s37, s66, 30848
    buffer_load_dwordx4 v50, s[20:23], s37 offen offset:2048 lds
    v_mfma_f32_16x16x32_bf16 v[168:171], a[200:203], v[104:107], v[168:171]
    ds_read_b64_tr_b16 a[188:189], v56 offset:12288
    ds_read_b64_tr_b16 a[190:191], v56 offset:14336
    v_mfma_f32_16x16x32_bf16 v[184:187], a[204:207], v[104:107], v[184:187]
    ds_read_b128 v[112:115], v52 offset:49152
    ds_read_b128 v[116:119], v52 offset:51200
    v_mfma_f32_16x16x32_bf16 v[188:191], a[204:207], v[108:111], v[188:191]
    ds_read_b128 v[120:123], v52 offset:53248
    ds_read_b128 v[124:127], v52 offset:55296
    v_mfma_f32_16x16x32_bf16 v[172:175], a[200:203], v[108:111], v[172:175]
    s_add_u32 s37, s66, 160896
    buffer_load_dwordx4 v50, s[20:23], s37 offen offset:3072 lds
    v_mfma_f32_16x16x32_bf16 v[140:143], a[192:195], v[108:111], v[140:143]
    v_mfma_f32_16x16x32_bf16 v[156:159], a[196:199], v[108:111], v[156:159]
    v_mfma_f32_16x16x32_bf16 v[152:155], a[196:199], v[104:107], v[152:155]
    s_add_u32 m0, s38, 12288
    s_add_u32 s37, s66, 262272
    v_mfma_f32_16x16x32_bf16 v[136:139], a[192:195], v[104:107], v[136:139]
    s_waitcnt lgkmcnt(4)
    buffer_load_dwordx4 v50, s[20:23], s37 offen offset:0 lds
    v_mfma_f32_16x16x32_bf16 v[132:135], a[192:195], v[100:103], v[132:135]
    v_mfma_f32_16x16x32_bf16 v[148:151], a[196:199], v[100:103], v[148:151]
    v_mfma_f32_16x16x32_bf16 v[144:147], a[196:199], v[96:99], v[144:147]
    s_add_u32 s37, s66, 392320
    v_mfma_f32_16x16x32_bf16 v[128:131], a[192:195], v[96:99], v[128:131]
    s_waitcnt lgkmcnt(0)
    buffer_load_dwordx4 v50, s[20:23], s37 offen offset:1024 lds
    v_mfma_f32_16x16x32_bf16 v[128:131], a[208:211], v[112:115], v[128:131]
    s_waitcnt vmcnt(10)
    ds_read_b64_tr_b16 a[192:193], v53 offset:0
    ds_read_b64_tr_b16 a[194:195], v53 offset:2048
    v_mfma_f32_16x16x32_bf16 v[144:147], a[212:215], v[112:115], v[144:147]
    ds_read_b64_tr_b16 a[196:197], v54 offset:0
    ds_read_b64_tr_b16 a[198:199], v54 offset:2048
    v_mfma_f32_16x16x32_bf16 v[148:151], a[212:215], v[116:119], v[148:151]
    ds_read_b64_tr_b16 a[200:201], v55 offset:0
    ds_read_b64_tr_b16 a[202:203], v55 offset:2048
    v_mfma_f32_16x16x32_bf16 v[132:135], a[208:211], v[116:119], v[132:135]
    s_add_u32 s37, s66, 292992
    buffer_load_dwordx4 v50, s[20:23], s37 offen offset:2048 lds
    v_mfma_f32_16x16x32_bf16 v[136:139], a[208:211], v[120:123], v[136:139]
    ds_read_b64_tr_b16 a[204:205], v56 offset:0
    ds_read_b64_tr_b16 a[206:207], v56 offset:2048
    v_mfma_f32_16x16x32_bf16 v[152:155], a[212:215], v[120:123], v[152:155]
    ds_read_b128 v[96:99], v51 offset:0
    ds_read_b128 v[100:103], v51 offset:2048
    v_mfma_f32_16x16x32_bf16 v[156:159], a[212:215], v[124:127], v[156:159]
    ds_read_b128 v[104:107], v51 offset:4096
    ds_read_b128 v[108:111], v51 offset:6144
    v_mfma_f32_16x16x32_bf16 v[140:143], a[208:211], v[124:127], v[140:143]
    s_add_u32 s37, s66, 423040
    buffer_load_dwordx4 v50, s[20:23], s37 offen offset:3072 lds
    v_mfma_f32_16x16x32_bf16 v[172:175], a[216:219], v[124:127], v[172:175]
    v_mfma_f32_16x16x32_bf16 v[188:191], a[220:223], v[124:127], v[188:191]
    v_mfma_f32_16x16x32_bf16 v[184:187], a[220:223], v[120:123], v[184:187]
    s_add_u32 m0, s38, 0
    s_add_u32 s37, s67, 128
    v_mfma_f32_16x16x32_bf16 v[168:171], a[216:219], v[120:123], v[168:171]
    s_waitcnt lgkmcnt(4)
    buffer_load_dwordx4 v50, s[20:23], s37 offen offset:0 lds
    v_mfma_f32_16x16x32_bf16 v[164:167], a[216:219], v[116:119], v[164:167]
    v_mfma_f32_16x16x32_bf16 v[180:183], a[220:223], v[116:119], v[180:183]
    v_mfma_f32_16x16x32_bf16 v[176:179], a[220:223], v[112:115], v[176:179]
    s_add_u32 s37, s67, 130176
    v_mfma_f32_16x16x32_bf16 v[160:163], a[216:219], v[112:115], v[160:163]
    s_waitcnt lgkmcnt(0)
    buffer_load_dwordx4 v50, s[20:23], s37 offen offset:1024 lds
    v_mfma_f32_16x16x32_bf16 v[224:227], a[232:235], v[96:99], 0
    s_waitcnt vmcnt(10)
    ds_read_b64_tr_b16 a[208:209], v53 offset:4096
    ds_read_b64_tr_b16 a[210:211], v53 offset:6144
    v_mfma_f32_16x16x32_bf16 v[240:243], a[236:239], v[96:99], 0
    ds_read_b64_tr_b16 a[212:213], v54 offset:4096
    ds_read_b64_tr_b16 a[214:215], v54 offset:6144
    v_mfma_f32_16x16x32_bf16 v[244:247], a[236:239], v[100:103], 0
    ds_read_b64_tr_b16 a[216:217], v55 offset:4096
    ds_read_b64_tr_b16 a[218:219], v55 offset:6144
    v_mfma_f32_16x16x32_bf16 v[228:231], a[232:235], v[100:103], 0
    s_add_u32 s37, s67, 30848
    buffer_load_dwordx4 v50, s[20:23], s37 offen offset:2048 lds
    v_mfma_f32_16x16x32_bf16 v[232:235], a[232:235], v[104:107], 0
    ds_read_b64_tr_b16 a[220:221], v56 offset:4096
    ds_read_b64_tr_b16 a[222:223], v56 offset:6144
    v_mfma_f32_16x16x32_bf16 v[248:251], a[236:239], v[104:107], 0
    ds_read_b128 v[112:115], v52 offset:0
    ds_read_b128 v[116:119], v52 offset:2048
    v_mfma_f32_16x16x32_bf16 v[252:255], a[236:239], v[108:111], 0
    ds_read_b128 v[120:123], v52 offset:4096
    ds_read_b128 v[124:127], v52 offset:6144
    v_mfma_f32_16x16x32_bf16 v[236:239], a[232:235], v[108:111], 0
    s_add_u32 s37, s67, 160896
    buffer_load_dwordx4 v50, s[20:23], s37 offen offset:3072 lds
    v_mfma_f32_16x16x32_bf16 v[204:207], a[224:227], v[108:111], 0
    v_mul_f32 v128, s6, v128
    v_mul_f32 v129, s6, v129
    v_mfma_f32_16x16x32_bf16 v[220:223], a[228:231], v[108:111], 0
    v_mul_f32 v130, s6, v130
    v_mul_f32 v131, s6, v131
    v_mfma_f32_16x16x32_bf16 v[216:219], a[228:231], v[104:107], 0
    s_add_u32 m0, s38, 4096
    s_add_u32 s37, s67, 262272
    v_cvt_pk_bf16_f32 v128, v128, v129
    v_mfma_f32_16x16x32_bf16 v[200:203], a[224:227], v[104:107], 0
    s_waitcnt lgkmcnt(4)
    buffer_load_dwordx4 v50, s[20:23], s37 offen offset:0 lds
    v_mfma_f32_16x16x32_bf16 v[196:199], a[224:227], v[100:103], 0
    v_cvt_pk_bf16_f32 v129, v130, v131
    v_mfma_f32_16x16x32_bf16 v[212:215], a[228:231], v[100:103], 0
    ds_write_b64 v57, v[128:129] offset:0
    v_mfma_f32_16x16x32_bf16 v[208:211], a[228:231], v[96:99], 0
    s_add_u32 s37, s67, 392320
    v_mul_f32 v132, s6, v132
    v_mul_f32 v133, s6, v133
    v_mfma_f32_16x16x32_bf16 v[192:195], a[224:227], v[96:99], 0
    s_waitcnt lgkmcnt(1)
    buffer_load_dwordx4 v50, s[20:23], s37 offen offset:1024 lds
    v_mfma_f32_16x16x32_bf16 v[192:195], a[240:243], v[112:115], v[192:195]
    s_waitcnt vmcnt(10)
    ds_read_b64_tr_b16 a[224:225], v53 offset:8192
    ds_read_b64_tr_b16 a[226:227], v53 offset:10240
    v_mfma_f32_16x16x32_bf16 v[208:211], a[244:247], v[112:115], v[208:211]
    ds_read_b64_tr_b16 a[228:229], v54 offset:8192
    ds_read_b64_tr_b16 a[230:231], v54 offset:10240
    v_mfma_f32_16x16x32_bf16 v[212:215], a[244:247], v[116:119], v[212:215]
    ds_read_b64_tr_b16 a[232:233], v55 offset:8192
    ds_read_b64_tr_b16 a[234:235], v55 offset:10240
    v_mfma_f32_16x16x32_bf16 v[196:199], a[240:243], v[116:119], v[196:199]
    s_add_u32 s37, s67, 292992
    buffer_load_dwordx4 v50, s[20:23], s37 offen offset:2048 lds
    v_mfma_f32_16x16x32_bf16 v[200:203], a[240:243], v[120:123], v[200:203]
    ds_read_b64_tr_b16 a[236:237], v56 offset:8192
    ds_read_b64_tr_b16 a[238:239], v56 offset:10240
    v_mfma_f32_16x16x32_bf16 v[216:219], a[244:247], v[120:123], v[216:219]
    ds_read_b128 v[96:99], v51 offset:8192
    ds_read_b128 v[100:103], v51 offset:10240
    v_mfma_f32_16x16x32_bf16 v[220:223], a[244:247], v[124:127], v[220:223]
    ds_read_b128 v[104:107], v51 offset:12288
    ds_read_b128 v[108:111], v51 offset:14336
    v_mfma_f32_16x16x32_bf16 v[204:207], a[240:243], v[124:127], v[204:207]
    s_add_u32 s37, s67, 423040
    buffer_load_dwordx4 v50, s[20:23], s37 offen offset:3072 lds
    v_mfma_f32_16x16x32_bf16 v[236:239], a[248:251], v[124:127], v[236:239]
    v_mul_f32 v134, s6, v134
    v_mul_f32 v135, s6, v135
    v_mfma_f32_16x16x32_bf16 v[252:255], a[252:255], v[124:127], v[252:255]
    v_cvt_pk_bf16_f32 v132, v132, v133
    v_cvt_pk_bf16_f32 v133, v134, v135
    v_mfma_f32_16x16x32_bf16 v[248:251], a[252:255], v[120:123], v[248:251]
    s_add_u32 m0, s38, 8192
    s_add_u32 s37, s68, 128
    v_mfma_f32_16x16x32_bf16 v[232:235], a[248:251], v[120:123], v[232:235]
    s_waitcnt lgkmcnt(4)
    buffer_load_dwordx4 v50, s[20:23], s37 offen offset:0 lds
    v_mfma_f32_16x16x32_bf16 v[228:231], a[248:251], v[116:119], v[228:231]
    ds_write_b64 v57, v[132:133] offset:4096
    v_mfma_f32_16x16x32_bf16 v[244:247], a[252:255], v[116:119], v[244:247]
    v_mul_f32 v136, s6, v136
    v_mul_f32 v137, s6, v137
    v_mfma_f32_16x16x32_bf16 v[240:243], a[252:255], v[112:115], v[240:243]
    s_add_u32 s37, s68, 130176
    v_mul_f32 v138, s6, v138
    v_mul_f32 v139, s6, v139
    v_mfma_f32_16x16x32_bf16 v[224:227], a[248:251], v[112:115], v[224:227]
    s_waitcnt lgkmcnt(1)
    buffer_load_dwordx4 v50, s[20:23], s37 offen offset:1024 lds
    v_mfma_f32_16x16x32_bf16 v[224:227], a[136:139], v[96:99], v[224:227]
    s_waitcnt vmcnt(10)
    ds_read_b64_tr_b16 a[240:241], v53 offset:12288
    ds_read_b64_tr_b16 a[242:243], v53 offset:14336
    v_mfma_f32_16x16x32_bf16 v[240:243], a[140:143], v[96:99], v[240:243]
    ds_read_b64_tr_b16 a[244:245], v54 offset:12288
    ds_read_b64_tr_b16 a[246:247], v54 offset:14336
    v_mfma_f32_16x16x32_bf16 v[244:247], a[140:143], v[100:103], v[244:247]
    ds_read_b64_tr_b16 a[248:249], v55 offset:12288
    ds_read_b64_tr_b16 a[250:251], v55 offset:14336
    v_mfma_f32_16x16x32_bf16 v[228:231], a[136:139], v[100:103], v[228:231]
    s_add_u32 s37, s68, 30848
    buffer_load_dwordx4 v50, s[20:23], s37 offen offset:2048 lds
    v_mfma_f32_16x16x32_bf16 v[232:235], a[136:139], v[104:107], v[232:235]
    ds_read_b64_tr_b16 a[252:253], v56 offset:12288
    ds_read_b64_tr_b16 a[254:255], v56 offset:14336
    v_mfma_f32_16x16x32_bf16 v[248:251], a[140:143], v[104:107], v[248:251]
    ds_read_b128 v[112:115], v52 offset:8192
    ds_read_b128 v[116:119], v52 offset:10240
    v_mfma_f32_16x16x32_bf16 v[252:255], a[140:143], v[108:111], v[252:255]
    ds_read_b128 v[120:123], v52 offset:12288
    ds_read_b128 v[124:127], v52 offset:14336
    v_mfma_f32_16x16x32_bf16 v[236:239], a[136:139], v[108:111], v[236:239]
    s_add_u32 s37, s68, 160896
    buffer_load_dwordx4 v50, s[20:23], s37 offen offset:3072 lds
    v_mfma_f32_16x16x32_bf16 v[204:207], a[128:131], v[108:111], v[204:207]
    v_cvt_pk_bf16_f32 v136, v136, v137
    v_cvt_pk_bf16_f32 v137, v138, v139
    v_mfma_f32_16x16x32_bf16 v[220:223], a[132:135], v[108:111], v[220:223]
    ds_write_b64 v57, v[136:137] offset:8192
    v_mfma_f32_16x16x32_bf16 v[216:219], a[132:135], v[104:107], v[216:219]
    s_add_u32 m0, s38, 12288
    s_add_u32 s37, s68, 262272
    v_mul_f32 v140, s6, v140
    v_mfma_f32_16x16x32_bf16 v[200:203], a[128:131], v[104:107], v[200:203]
    s_waitcnt lgkmcnt(5)
    buffer_load_dwordx4 v50, s[20:23], s37 offen offset:0 lds
    v_mfma_f32_16x16x32_bf16 v[196:199], a[128:131], v[100:103], v[196:199]
    v_mul_f32 v141, s6, v141
    v_mul_f32 v142, s6, v142
    v_mfma_f32_16x16x32_bf16 v[212:215], a[132:135], v[100:103], v[212:215]
    v_mul_f32 v143, s6, v143
    v_cvt_pk_bf16_f32 v140, v140, v141
    v_mfma_f32_16x16x32_bf16 v[208:211], a[132:135], v[96:99], v[208:211]
    s_add_u32 s37, s68, 392320
    v_cvt_pk_bf16_f32 v141, v142, v143
    v_mfma_f32_16x16x32_bf16 v[192:195], a[128:131], v[96:99], v[192:195]
    s_waitcnt lgkmcnt(1)
    buffer_load_dwordx4 v50, s[20:23], s37 offen offset:1024 lds
    v_mfma_f32_16x16x32_bf16 v[192:195], a[144:147], v[112:115], v[192:195]
    s_waitcnt vmcnt(10)
    ds_read_b64_tr_b16 a[128:129], v53 offset:0
    ds_read_b64_tr_b16 a[130:131], v53 offset:2048
    v_mfma_f32_16x16x32_bf16 v[208:211], a[148:151], v[112:115], v[208:211]
    ds_read_b64_tr_b16 a[132:133], v54 offset:0
    ds_read_b64_tr_b16 a[134:135], v54 offset:2048
    v_mfma_f32_16x16x32_bf16 v[212:215], a[148:151], v[116:119], v[212:215]
    ds_read_b64_tr_b16 a[136:137], v55 offset:0
    ds_read_b64_tr_b16 a[138:139], v55 offset:2048
    v_mfma_f32_16x16x32_bf16 v[196:199], a[144:147], v[116:119], v[196:199]
    s_add_u32 s37, s68, 292992
    buffer_load_dwordx4 v50, s[20:23], s37 offen offset:2048 lds
    v_mfma_f32_16x16x32_bf16 v[200:203], a[144:147], v[120:123], v[200:203]
    ds_read_b64_tr_b16 a[140:141], v56 offset:0
    ds_read_b64_tr_b16 a[142:143], v56 offset:2048
    v_mfma_f32_16x16x32_bf16 v[216:219], a[148:151], v[120:123], v[216:219]
    ds_read_b128 v[96:99], v51 offset:16384
    ds_read_b128 v[100:103], v51 offset:18432
    v_mfma_f32_16x16x32_bf16 v[220:223], a[148:151], v[124:127], v[220:223]
    ds_read_b128 v[104:107], v51 offset:20480
    ds_read_b128 v[108:111], v51 offset:22528
    v_mfma_f32_16x16x32_bf16 v[204:207], a[144:147], v[124:127], v[204:207]
    s_add_u32 s37, s68, 423040
    buffer_load_dwordx4 v50, s[20:23], s37 offen offset:3072 lds
    v_mfma_f32_16x16x32_bf16 v[236:239], a[152:155], v[124:127], v[236:239]
    ds_write_b64 v57, v[140:141] offset:12288
    v_mfma_f32_16x16x32_bf16 v[252:255], a[156:159], v[124:127], v[252:255]
    v_mul_f32 v144, s6, v144
    v_mul_f32 v145, s6, v145
    v_mfma_f32_16x16x32_bf16 v[248:251], a[156:159], v[120:123], v[248:251]
    v_mul_f32 v146, s6, v146
    v_mul_f32 v147, s6, v147
    v_mfma_f32_16x16x32_bf16 v[232:235], a[152:155], v[120:123], v[232:235]
    s_waitcnt lgkmcnt(5)
    v_cvt_pk_bf16_f32 v144, v144, v145
    v_cvt_pk_bf16_f32 v145, v146, v147
    v_mfma_f32_16x16x32_bf16 v[228:231], a[152:155], v[116:119], v[228:231]
    ds_write_b64 v57, v[144:145] offset:512
    v_mfma_f32_16x16x32_bf16 v[244:247], a[156:159], v[116:119], v[244:247]
    v_mul_f32 v148, s6, v148
    v_mul_f32 v149, s6, v149
    v_mfma_f32_16x16x32_bf16 v[240:243], a[156:159], v[112:115], v[240:243]
    v_mul_f32 v150, s6, v150
    v_mul_f32 v151, s6, v151
    v_mfma_f32_16x16x32_bf16 v[224:227], a[152:155], v[112:115], v[224:227]
    s_waitcnt lgkmcnt(2)
    v_cvt_pk_bf16_f32 v148, v148, v149
    v_cvt_pk_bf16_f32 v149, v150, v151
    v_mfma_f32_16x16x32_bf16 v[224:227], a[168:171], v[96:99], v[224:227]
    s_waitcnt vmcnt(8)
    ds_read_b64_tr_b16 a[144:145], v53 offset:4096
    ds_read_b64_tr_b16 a[146:147], v53 offset:6144
    v_mfma_f32_16x16x32_bf16 v[240:243], a[172:175], v[96:99], v[240:243]
    ds_read_b64_tr_b16 a[148:149], v54 offset:4096
    ds_read_b64_tr_b16 a[150:151], v54 offset:6144
    v_mfma_f32_16x16x32_bf16 v[244:247], a[172:175], v[100:103], v[244:247]
    ds_read_b64_tr_b16 a[152:153], v55 offset:4096
    ds_read_b64_tr_b16 a[154:155], v55 offset:6144
    v_mfma_f32_16x16x32_bf16 v[228:231], a[168:171], v[100:103], v[228:231]
    ds_write_b64 v57, v[148:149] offset:4608
    v_mfma_f32_16x16x32_bf16 v[232:235], a[168:171], v[104:107], v[232:235]
    ds_read_b64_tr_b16 a[156:157], v56 offset:4096
    ds_read_b64_tr_b16 a[158:159], v56 offset:6144
    v_mfma_f32_16x16x32_bf16 v[248:251], a[172:175], v[104:107], v[248:251]
    ds_read_b128 v[112:115], v52 offset:16384
    ds_read_b128 v[116:119], v52 offset:18432
    v_mfma_f32_16x16x32_bf16 v[252:255], a[172:175], v[108:111], v[252:255]
    ds_read_b128 v[120:123], v52 offset:20480
    ds_read_b128 v[124:127], v52 offset:22528
    v_mfma_f32_16x16x32_bf16 v[236:239], a[168:171], v[108:111], v[236:239]
    v_mul_f32 v152, s6, v152
    v_mul_f32 v153, s6, v153
    v_mfma_f32_16x16x32_bf16 v[204:207], a[160:163], v[108:111], v[204:207]
    v_mul_f32 v154, s6, v154
    v_mul_f32 v155, s6, v155
    v_mfma_f32_16x16x32_bf16 v[220:223], a[164:167], v[108:111], v[220:223]
    v_cvt_pk_bf16_f32 v152, v152, v153
    v_cvt_pk_bf16_f32 v153, v154, v155
    v_mfma_f32_16x16x32_bf16 v[216:219], a[164:167], v[104:107], v[216:219]
    ds_write_b64 v57, v[152:153] offset:8704
    v_mfma_f32_16x16x32_bf16 v[200:203], a[160:163], v[104:107], v[200:203]
    s_waitcnt lgkmcnt(5)
    v_mul_f32 v156, s6, v156
    v_mul_f32 v157, s6, v157
    v_mfma_f32_16x16x32_bf16 v[196:199], a[160:163], v[100:103], v[196:199]
    v_mul_f32 v158, s6, v158
    v_mul_f32 v159, s6, v159
    v_mfma_f32_16x16x32_bf16 v[212:215], a[164:167], v[100:103], v[212:215]
    v_cvt_pk_bf16_f32 v156, v156, v157
    v_cvt_pk_bf16_f32 v157, v158, v159
    v_mfma_f32_16x16x32_bf16 v[208:211], a[164:167], v[96:99], v[208:211]
    ds_write_b64 v57, v[156:157] offset:12800
    v_mfma_f32_16x16x32_bf16 v[192:195], a[160:163], v[96:99], v[192:195]
    s_waitcnt lgkmcnt(2)
    v_mul_f32 v160, s6, v160
    v_mul_f32 v161, s6, v161
    v_mfma_f32_16x16x32_bf16 v[192:195], a[176:179], v[112:115], v[192:195]
    s_waitcnt vmcnt(4)
    ds_read_b64_tr_b16 a[160:161], v53 offset:8192
    ds_read_b64_tr_b16 a[162:163], v53 offset:10240
    v_mfma_f32_16x16x32_bf16 v[208:211], a[180:183], v[112:115], v[208:211]
    ds_read_b64_tr_b16 a[164:165], v54 offset:8192
    ds_read_b64_tr_b16 a[166:167], v54 offset:10240
    v_mfma_f32_16x16x32_bf16 v[212:215], a[180:183], v[116:119], v[212:215]
    ds_read_b64_tr_b16 a[168:169], v55 offset:8192
    ds_read_b64_tr_b16 a[170:171], v55 offset:10240
    v_mfma_f32_16x16x32_bf16 v[196:199], a[176:179], v[116:119], v[196:199]
    v_mul_f32 v162, s6, v162
    v_mul_f32 v163, s6, v163
    v_mfma_f32_16x16x32_bf16 v[200:203], a[176:179], v[120:123], v[200:203]
    ds_read_b64_tr_b16 a[172:173], v56 offset:8192
    ds_read_b64_tr_b16 a[174:175], v56 offset:10240
    v_mfma_f32_16x16x32_bf16 v[216:219], a[180:183], v[120:123], v[216:219]
    ds_read_b128 v[96:99], v51 offset:24576
    ds_read_b128 v[100:103], v51 offset:26624
    v_mfma_f32_16x16x32_bf16 v[220:223], a[180:183], v[124:127], v[220:223]
    ds_read_b128 v[104:107], v51 offset:28672
    ds_read_b128 v[108:111], v51 offset:30720
    v_mfma_f32_16x16x32_bf16 v[204:207], a[176:179], v[124:127], v[204:207]
    v_cvt_pk_bf16_f32 v160, v160, v161
    v_cvt_pk_bf16_f32 v161, v162, v163
    v_mfma_f32_16x16x32_bf16 v[236:239], a[184:187], v[124:127], v[236:239]
    ds_write_b64 v57, v[160:161] offset:1024
    v_mfma_f32_16x16x32_bf16 v[252:255], a[188:191], v[124:127], v[252:255]
    v_mul_f32 v164, s6, v164
    v_mul_f32 v165, s6, v165
    v_mfma_f32_16x16x32_bf16 v[248:251], a[188:191], v[120:123], v[248:251]
    v_mul_f32 v166, s6, v166
    v_mul_f32 v167, s6, v167
    v_mfma_f32_16x16x32_bf16 v[232:235], a[184:187], v[120:123], v[232:235]
    s_waitcnt lgkmcnt(5)
    v_cvt_pk_bf16_f32 v164, v164, v165
    v_cvt_pk_bf16_f32 v165, v166, v167
    v_mfma_f32_16x16x32_bf16 v[228:231], a[184:187], v[116:119], v[228:231]
    ds_write_b64 v57, v[164:165] offset:5120
    v_mfma_f32_16x16x32_bf16 v[244:247], a[188:191], v[116:119], v[244:247]
    v_mul_f32 v168, s6, v168
    v_mul_f32 v169, s6, v169
    v_mfma_f32_16x16x32_bf16 v[240:243], a[188:191], v[112:115], v[240:243]
    v_mul_f32 v170, s6, v170
    v_mul_f32 v171, s6, v171
    v_mfma_f32_16x16x32_bf16 v[224:227], a[184:187], v[112:115], v[224:227]
    s_waitcnt lgkmcnt(2)
    v_cvt_pk_bf16_f32 v168, v168, v169
    v_cvt_pk_bf16_f32 v169, v170, v171
    v_mfma_f32_16x16x32_bf16 v[224:227], a[200:203], v[96:99], v[224:227]
    s_waitcnt vmcnt(0)
    ds_read_b64_tr_b16 a[176:177], v53 offset:12288
    ds_read_b64_tr_b16 a[178:179], v53 offset:14336
    v_mfma_f32_16x16x32_bf16 v[240:243], a[204:207], v[96:99], v[240:243]
    ds_read_b64_tr_b16 a[180:181], v54 offset:12288
    ds_read_b64_tr_b16 a[182:183], v54 offset:14336
    v_mfma_f32_16x16x32_bf16 v[244:247], a[204:207], v[100:103], v[244:247]
    ds_read_b64_tr_b16 a[184:185], v55 offset:12288
    ds_read_b64_tr_b16 a[186:187], v55 offset:14336
    v_mfma_f32_16x16x32_bf16 v[228:231], a[200:203], v[100:103], v[228:231]
    ds_write_b64 v57, v[168:169] offset:9216
    v_mfma_f32_16x16x32_bf16 v[232:235], a[200:203], v[104:107], v[232:235]
    ds_read_b64_tr_b16 a[188:189], v56 offset:12288
    ds_read_b64_tr_b16 a[190:191], v56 offset:14336
    v_mfma_f32_16x16x32_bf16 v[248:251], a[204:207], v[104:107], v[248:251]
    ds_read_b128 v[112:115], v52 offset:24576
    ds_read_b128 v[116:119], v52 offset:26624
    v_mfma_f32_16x16x32_bf16 v[252:255], a[204:207], v[108:111], v[252:255]
    ds_read_b128 v[120:123], v52 offset:28672
    ds_read_b128 v[124:127], v52 offset:30720
    v_mul_f32 v172, s6, v172
    v_mul_f32 v173, s6, v173
    v_mul_f32 v174, s6, v174
    v_mul_f32 v175, s6, v175
    v_cvt_pk_bf16_f32 v172, v172, v173
    v_cvt_pk_bf16_f32 v173, v174, v175
    ds_write_b64 v57, v[172:173] offset:13312
    v_mul_f32 v176, s6, v176
    v_mul_f32 v177, s6, v177
    v_mul_f32 v178, s6, v178
    v_mul_f32 v179, s6, v179
    v_cvt_pk_bf16_f32 v176, v176, v177
    v_cvt_pk_bf16_f32 v177, v178, v179
    ds_write_b64 v57, v[176:177] offset:1536
    v_mul_f32 v180, s6, v180
    v_mul_f32 v181, s6, v181
    v_mul_f32 v182, s6, v182
    v_mul_f32 v183, s6, v183
    v_cvt_pk_bf16_f32 v180, v180, v181
    v_cvt_pk_bf16_f32 v181, v182, v183
    ds_write_b64 v57, v[180:181] offset:5632
    v_mul_f32 v184, s6, v184
    v_mul_f32 v185, s6, v185
    v_mul_f32 v186, s6, v186
    v_mul_f32 v187, s6, v187
    v_cvt_pk_bf16_f32 v184, v184, v185
    v_cvt_pk_bf16_f32 v185, v186, v187
    ds_write_b64 v57, v[184:185] offset:9728
    v_mul_f32 v188, s6, v188
    v_mul_f32 v189, s6, v189
    v_mul_f32 v190, s6, v190
    v_mul_f32 v191, s6, v191
    v_cvt_pk_bf16_f32 v188, v188, v189
    v_cvt_pk_bf16_f32 v189, v190, v191
    ds_write_b64 v57, v[188:189] offset:13824
    v_mfma_f32_16x16x32_bf16 v[236:239], a[200:203], v[108:111], v[236:239]
    v_mfma_f32_16x16x32_bf16 v[204:207], a[192:195], v[108:111], v[204:207]
    v_mfma_f32_16x16x32_bf16 v[220:223], a[196:199], v[108:111], v[220:223]
    v_mfma_f32_16x16x32_bf16 v[216:219], a[196:199], v[104:107], v[216:219]
    v_mfma_f32_16x16x32_bf16 v[200:203], a[192:195], v[104:107], v[200:203]
    s_waitcnt lgkmcnt(9)
    v_mfma_f32_16x16x32_bf16 v[196:199], a[192:195], v[100:103], v[196:199]
    s_waitcnt lgkmcnt(0)
    s_barrier
    v_mfma_f32_16x16x32_bf16 v[212:215], a[196:199], v[100:103], v[212:215]
    s_add_u32 m0, s32, 0
    ds_read_b128 a[0:3], v58 offset:0
    v_mfma_f32_16x16x32_bf16 v[208:211], a[196:199], v[96:99], v[208:211]
    s_mov_b32 s33, 0
    buffer_load_dwordx4 v8, s[8:11], s33 offen offset:0 nt lds
    v_mfma_f32_16x16x32_bf16 v[192:195], a[192:195], v[96:99], v[192:195]
    ds_read_b128 a[32:35], v58 offset:4096
    v_mfma_f32_16x16x32_bf16 v[192:195], a[208:211], v[112:115], v[192:195]
    ds_read_b128 a[64:67], v59 offset:0
    v_mfma_f32_16x16x32_bf16 v[208:211], a[212:215], v[112:115], v[208:211]
    ds_read_b128 a[96:99], v59 offset:4096
    v_mfma_f32_16x16x32_bf16 v[212:215], a[212:215], v[116:119], v[212:215]
    ds_read_b128 a[4:7], v58 offset:1024
    v_mfma_f32_16x16x32_bf16 v[196:199], a[208:211], v[116:119], v[196:199]
    s_add_u32 m0, s32, 896
    ds_read_b128 a[36:39], v58 offset:5120
    v_mfma_f32_16x16x32_bf16 v[200:203], a[208:211], v[120:123], v[200:203]
    buffer_load_dwordx4 v8, s[8:11], s33 offen offset:128 nt lds
    v_mfma_f32_16x16x32_bf16 v[216:219], a[212:215], v[120:123], v[216:219]
    ds_read_b128 v[96:99], v51 offset:32768
    ds_read_b128 v[100:103], v51 offset:34816
    v_mfma_f32_16x16x32_bf16 v[220:223], a[212:215], v[124:127], v[220:223]
    ds_read_b128 v[104:107], v51 offset:36864
    ds_read_b128 v[108:111], v51 offset:38912
    v_mfma_f32_16x16x32_bf16 v[204:207], a[208:211], v[124:127], v[204:207]
    ds_read_b128 a[68:71], v59 offset:1024
    v_mfma_f32_16x16x32_bf16 v[236:239], a[216:219], v[124:127], v[236:239]
    ds_read_b128 a[100:103], v59 offset:5120
    v_mfma_f32_16x16x32_bf16 v[252:255], a[220:223], v[124:127], v[252:255]
    s_add_u32 m0, s32, 1792
    ds_read_b128 a[16:19], v58 offset:2048
    v_mfma_f32_16x16x32_bf16 v[248:251], a[220:223], v[120:123], v[248:251]
    buffer_load_dwordx4 v8, s[8:11], s33 offen offset:256 nt lds
    v_mfma_f32_16x16x32_bf16 v[232:235], a[216:219], v[120:123], v[232:235]
    ds_read_b128 a[48:51], v58 offset:6144
    v_mfma_f32_16x16x32_bf16 v[228:231], a[216:219], v[116:119], v[228:231]
    ds_read_b128 a[80:83], v59 offset:2048
    v_mfma_f32_16x16x32_bf16 v[244:247], a[220:223], v[116:119], v[244:247]
    ds_read_b128 a[112:115], v59 offset:6144
    v_mfma_f32_16x16x32_bf16 v[240:243], a[220:223], v[112:115], v[240:243]
    ds_read_b128 a[20:23], v58 offset:3072
    v_mfma_f32_16x16x32_bf16 v[224:227], a[216:219], v[112:115], v[224:227]
    s_waitcnt lgkmcnt(7)
    s_add_u32 m0, s32, 2688
    ds_read_b128 a[52:55], v58 offset:7168
    v_mfma_f32_16x16x32_bf16 v[224:227], a[232:235], v[96:99], v[224:227]
    buffer_load_dwordx4 v8, s[8:11], s33 offen offset:384 nt lds
    v_mfma_f32_16x16x32_bf16 v[240:243], a[236:239], v[96:99], v[240:243]
    ds_read_b128 a[84:87], v59 offset:3072
    v_mfma_f32_16x16x32_bf16 v[244:247], a[236:239], v[100:103], v[244:247]
    ds_read_b128 a[116:119], v59 offset:7168
    v_mfma_f32_16x16x32_bf16 v[228:231], a[232:235], v[100:103], v[228:231]
    v_mfma_f32_16x16x32_bf16 v[232:235], a[232:235], v[104:107], v[232:235]
    v_mfma_f32_16x16x32_bf16 v[248:251], a[236:239], v[104:107], v[248:251]
    ds_read_b128 v[112:115], v52 offset:32768
    ds_read_b128 v[116:119], v52 offset:34816
    v_mfma_f32_16x16x32_bf16 v[252:255], a[236:239], v[108:111], v[252:255]
    s_add_u32 m0, s32, 4096
    ds_read_b128 v[120:123], v52 offset:36864
    ds_read_b128 v[124:127], v52 offset:38912
    v_mfma_f32_16x16x32_bf16 v[236:239], a[232:235], v[108:111], v[236:239]
    buffer_load_dwordx4 v9, s[8:11], s33 offen offset:0 nt lds
    v_mfma_f32_16x16x32_bf16 v[204:207], a[224:227], v[108:111], v[204:207]
    v_mfma_f32_16x16x32_bf16 v[220:223], a[228:231], v[108:111], v[220:223]
    v_mfma_f32_16x16x32_bf16 v[216:219], a[228:231], v[104:107], v[216:219]
    v_mfma_f32_16x16x32_bf16 v[200:203], a[224:227], v[104:107], v[200:203]
    v_mfma_f32_16x16x32_bf16 v[196:199], a[224:227], v[100:103], v[196:199]
    s_add_u32 m0, s32, 4992
    v_mfma_f32_16x16x32_bf16 v[212:215], a[228:231], v[100:103], v[212:215]
    buffer_load_dwordx4 v9, s[8:11], s33 offen offset:128 nt lds
    v_mfma_f32_16x16x32_bf16 v[208:211], a[228:231], v[96:99], v[208:211]
    v_mfma_f32_16x16x32_bf16 v[192:195], a[224:227], v[96:99], v[192:195]
    s_waitcnt lgkmcnt(0)
    v_mfma_f32_16x16x32_bf16 v[192:195], a[240:243], v[112:115], v[192:195]
    v_mfma_f32_16x16x32_bf16 v[208:211], a[244:247], v[112:115], v[208:211]
    v_mfma_f32_16x16x32_bf16 v[212:215], a[244:247], v[116:119], v[212:215]
    s_add_u32 m0, s32, 5888
    v_mfma_f32_16x16x32_bf16 v[196:199], a[240:243], v[116:119], v[196:199]
    buffer_load_dwordx4 v9, s[8:11], s33 offen offset:256 nt lds
    v_mfma_f32_16x16x32_bf16 v[200:203], a[240:243], v[120:123], v[200:203]
    v_mfma_f32_16x16x32_bf16 v[216:219], a[244:247], v[120:123], v[216:219]
    ds_read_b128 v[96:99], v51 offset:40960
    ds_read_b128 v[100:103], v51 offset:43008
    v_mfma_f32_16x16x32_bf16 v[220:223], a[244:247], v[124:127], v[220:223]
    ds_read_b128 v[104:107], v51 offset:45056
    ds_read_b128 v[108:111], v51 offset:47104
    v_mfma_f32_16x16x32_bf16 v[204:207], a[240:243], v[124:127], v[204:207]
    v_mfma_f32_16x16x32_bf16 v[236:239], a[248:251], v[124:127], v[236:239]
    s_barrier
    s_add_u32 m0, s32, 6784
    v_mfma_f32_16x16x32_bf16 v[252:255], a[252:255], v[124:127], v[252:255]
    buffer_load_dwordx4 v9, s[8:11], s33 offen offset:384 nt lds
    v_mfma_f32_16x16x32_bf16 v[248:251], a[252:255], v[120:123], v[248:251]
    v_mfma_f32_16x16x32_bf16 v[232:235], a[248:251], v[120:123], v[232:235]
    v_mfma_f32_16x16x32_bf16 v[228:231], a[248:251], v[116:119], v[228:231]
    v_mfma_f32_16x16x32_bf16 v[244:247], a[252:255], v[116:119], v[244:247]
    v_mfma_f32_16x16x32_bf16 v[240:243], a[252:255], v[112:115], v[240:243]
    s_mov_b32 s33, 8192
    s_add_u32 m0, s32, 32768
    v_mfma_f32_16x16x32_bf16 v[224:227], a[248:251], v[112:115], v[224:227]
    s_waitcnt lgkmcnt(0)
    buffer_load_dwordx4 v8, s[8:11], s33 offen offset:0 nt lds
    v_mfma_f32_16x16x32_bf16 v[224:227], a[136:139], v[96:99], v[224:227]
    v_mfma_f32_16x16x32_bf16 v[240:243], a[140:143], v[96:99], v[240:243]
    v_mfma_f32_16x16x32_bf16 v[244:247], a[140:143], v[100:103], v[244:247]
    v_mfma_f32_16x16x32_bf16 v[228:231], a[136:139], v[100:103], v[228:231]
    v_mfma_f32_16x16x32_bf16 v[232:235], a[136:139], v[104:107], v[232:235]
    v_mfma_f32_16x16x32_bf16 v[248:251], a[140:143], v[104:107], v[248:251]
    ds_read_b128 v[112:115], v52 offset:40960
    ds_read_b128 v[116:119], v52 offset:43008
    v_mfma_f32_16x16x32_bf16 v[252:255], a[140:143], v[108:111], v[252:255]
    s_add_u32 m0, s32, 33664
    ds_read_b128 v[120:123], v52 offset:45056
    ds_read_b128 v[124:127], v52 offset:47104
    v_mfma_f32_16x16x32_bf16 v[236:239], a[136:139], v[108:111], v[236:239]
    buffer_load_dwordx4 v8, s[8:11], s33 offen offset:128 nt lds
    v_mfma_f32_16x16x32_bf16 v[204:207], a[128:131], v[108:111], v[204:207]
    v_mfma_f32_16x16x32_bf16 v[220:223], a[132:135], v[108:111], v[220:223]
    v_mfma_f32_16x16x32_bf16 v[216:219], a[132:135], v[104:107], v[216:219]
    v_mfma_f32_16x16x32_bf16 v[200:203], a[128:131], v[104:107], v[200:203]
    v_mfma_f32_16x16x32_bf16 v[196:199], a[128:131], v[100:103], v[196:199]
    s_add_u32 m0, s32, 34560
    v_mfma_f32_16x16x32_bf16 v[212:215], a[132:135], v[100:103], v[212:215]
    buffer_load_dwordx4 v8, s[8:11], s33 offen offset:256 nt lds
    v_mfma_f32_16x16x32_bf16 v[208:211], a[132:135], v[96:99], v[208:211]
    v_mfma_f32_16x16x32_bf16 v[192:195], a[128:131], v[96:99], v[192:195]
    s_waitcnt lgkmcnt(0)
    v_mfma_f32_16x16x32_bf16 v[192:195], a[144:147], v[112:115], v[192:195]
    v_mfma_f32_16x16x32_bf16 v[208:211], a[148:151], v[112:115], v[208:211]
    v_mfma_f32_16x16x32_bf16 v[212:215], a[148:151], v[116:119], v[212:215]
    s_add_u32 m0, s32, 35456
    v_mfma_f32_16x16x32_bf16 v[196:199], a[144:147], v[116:119], v[196:199]
    buffer_load_dwordx4 v8, s[8:11], s33 offen offset:384 nt lds
    v_mfma_f32_16x16x32_bf16 v[200:203], a[144:147], v[120:123], v[200:203]
    v_mfma_f32_16x16x32_bf16 v[216:219], a[148:151], v[120:123], v[216:219]
    ds_read_b128 v[96:99], v51 offset:49152
    ds_read_b128 v[100:103], v51 offset:51200
    v_mfma_f32_16x16x32_bf16 v[220:223], a[148:151], v[124:127], v[220:223]
    ds_read_b128 v[104:107], v51 offset:53248
    ds_read_b128 v[108:111], v51 offset:55296
    v_mfma_f32_16x16x32_bf16 v[204:207], a[144:147], v[124:127], v[204:207]
    v_mfma_f32_16x16x32_bf16 v[236:239], a[152:155], v[124:127], v[236:239]
    s_add_u32 m0, s32, 36864
    v_mfma_f32_16x16x32_bf16 v[252:255], a[156:159], v[124:127], v[252:255]
    buffer_load_dwordx4 v9, s[8:11], s33 offen offset:0 nt lds
    v_mfma_f32_16x16x32_bf16 v[248:251], a[156:159], v[120:123], v[248:251]
    v_mfma_f32_16x16x32_bf16 v[232:235], a[152:155], v[120:123], v[232:235]
    v_mfma_f32_16x16x32_bf16 v[228:231], a[152:155], v[116:119], v[228:231]
    v_mfma_f32_16x16x32_bf16 v[244:247], a[156:159], v[116:119], v[244:247]
    v_mfma_f32_16x16x32_bf16 v[240:243], a[156:159], v[112:115], v[240:243]
    s_add_u32 m0, s32, 37760
    v_mfma_f32_16x16x32_bf16 v[224:227], a[152:155], v[112:115], v[224:227]
    s_waitcnt lgkmcnt(0)
    buffer_load_dwordx4 v9, s[8:11], s33 offen offset:128 nt lds
    v_mfma_f32_16x16x32_bf16 v[224:227], a[168:171], v[96:99], v[224:227]
    v_mfma_f32_16x16x32_bf16 v[240:243], a[172:175], v[96:99], v[240:243]
    v_mfma_f32_16x16x32_bf16 v[244:247], a[172:175], v[100:103], v[244:247]
    v_mfma_f32_16x16x32_bf16 v[228:231], a[168:171], v[100:103], v[228:231]
    v_mfma_f32_16x16x32_bf16 v[232:235], a[168:171], v[104:107], v[232:235]
    v_mfma_f32_16x16x32_bf16 v[248:251], a[172:175], v[104:107], v[248:251]
    ds_read_b128 v[112:115], v52 offset:49152
    ds_read_b128 v[116:119], v52 offset:51200
    v_mfma_f32_16x16x32_bf16 v[252:255], a[172:175], v[108:111], v[252:255]
    s_add_u32 m0, s32, 38656
    ds_read_b128 v[120:123], v52 offset:53248
    ds_read_b128 v[124:127], v52 offset:55296
    v_mfma_f32_16x16x32_bf16 v[236:239], a[168:171], v[108:111], v[236:239]
    buffer_load_dwordx4 v9, s[8:11], s33 offen offset:256 nt lds
    v_mfma_f32_16x16x32_bf16 v[204:207], a[160:163], v[108:111], v[204:207]
    v_mfma_f32_16x16x32_bf16 v[220:223], a[164:167], v[108:111], v[220:223]
    v_mfma_f32_16x16x32_bf16 v[216:219], a[164:167], v[104:107], v[216:219]
    v_mfma_f32_16x16x32_bf16 v[200:203], a[160:163], v[104:107], v[200:203]
    v_mov_b32 v16, s6
    v_mfma_f32_16x16x32_bf16 v[196:199], a[160:163], v[100:103], v[196:199]
    s_add_u32 m0, s32, 39552
    v_mfma_f32_16x16x32_bf16 v[212:215], a[164:167], v[100:103], v[212:215]
    buffer_load_dwordx4 v9, s[8:11], s33 offen offset:384 nt lds
    v_mfma_f32_16x16x32_bf16 v[208:211], a[164:167], v[96:99], v[208:211]
    v_mfma_f32_16x16x32_bf16 v[192:195], a[160:163], v[96:99], v[192:195]
    s_waitcnt lgkmcnt(0)
    v_mfma_f32_16x16x32_bf16 v[192:195], a[176:179], v[112:115], v[192:195]
    v_mfma_f32_16x16x32_bf16 v[208:211], a[180:183], v[112:115], v[208:211]
    v_mfma_f32_16x16x32_bf16 v[212:215], a[180:183], v[116:119], v[212:215]
    s_mov_b32 s35, 4096
    s_add_u32 m0, s32, 65536
    v_mfma_f32_16x16x32_bf16 v[196:199], a[176:179], v[116:119], v[196:199]
    s_mov_b32 s34, 0
    s_waitcnt vmcnt(8)
    s_barrier
    buffer_load_dwordx4 v10, s[12:15], s34 offen offset:0 nt lds
    v_mfma_f32_16x16x32_bf16 v[200:203], a[176:179], v[120:123], v[200:203]
    ds_read_b128 v[24:27], v2 offset:0
    v_mfma_f32_16x16x32_bf16 v[216:219], a[180:183], v[120:123], v[216:219]
    ds_read_b128 v[28:31], v3 offset:0
    v_mfma_f32_16x16x32_bf16 v[220:223], a[180:183], v[124:127], v[220:223]
    ds_read_b128 v[32:35], v2 offset:1024
    v_mfma_f32_16x16x32_bf16 v[204:207], a[176:179], v[124:127], v[204:207]
    ds_read_b128 v[36:39], v3 offset:1024
    v_mfma_f32_16x16x32_bf16 v[236:239], a[184:187], v[124:127], v[236:239]
    v_mfma_f32_16x16x32_bf16 v[252:255], a[188:191], v[124:127], v[252:255]
    v_mfma_f32_16x16x32_bf16 v[248:251], a[188:191], v[120:123], v[248:251]
    v_mfma_f32_16x16x32_bf16 v[232:235], a[184:187], v[120:123], v[232:235]
    v_mfma_f32_16x16x32_bf16 v[228:231], a[184:187], v[116:119], v[228:231]
    v_mfma_f32_16x16x32_bf16 v[244:247], a[188:191], v[116:119], v[244:247]
    v_mfma_f32_16x16x32_bf16 v[240:243], a[188:191], v[112:115], v[240:243]
    v_mfma_f32_16x16x32_bf16 v[224:227], a[184:187], v[112:115], v[224:227]
    s_add_u32 m0, s32, 66432
    v_pk_mul_f32 v[192:193], v[192:193], v[16:17] op_sel_hi:[1,0]
    v_pk_mul_f32 v[194:195], v[194:195], v[16:17] op_sel_hi:[1,0]
    v_cvt_pk_bf16_f32 v192, v192, v193
    v_cvt_pk_bf16_f32 v193, v194, v195
    buffer_load_dwordx4 v10, s[12:15], s34 offen offset:128 nt lds
    ds_write_b64 v57, v[192:193] offset:32768
    s_add_u32 m0, s32, 67328
    v_pk_mul_f32 v[196:197], v[196:197], v[16:17] op_sel_hi:[1,0]
    v_pk_mul_f32 v[198:199], v[198:199], v[16:17] op_sel_hi:[1,0]
    v_cvt_pk_bf16_f32 v196, v196, v197
    v_cvt_pk_bf16_f32 v197, v198, v199
    buffer_load_dwordx4 v10, s[12:15], s34 offen offset:256 nt lds
    ds_write_b64 v57, v[196:197] offset:36864
    s_add_u32 m0, s32, 68224
    v_pk_mul_f32 v[200:201], v[200:201], v[16:17] op_sel_hi:[1,0]
    v_pk_mul_f32 v[202:203], v[202:203], v[16:17] op_sel_hi:[1,0]
    v_cvt_pk_bf16_f32 v200, v200, v201
    v_cvt_pk_bf16_f32 v201, v202, v203
    buffer_load_dwordx4 v10, s[12:15], s34 offen offset:384 nt lds
    ds_write_b64 v57, v[200:201] offset:40960
    s_add_u32 m0, s32, 69632
    v_pk_mul_f32 v[204:205], v[204:205], v[16:17] op_sel_hi:[1,0]
    v_pk_mul_f32 v[206:207], v[206:207], v[16:17] op_sel_hi:[1,0]
    v_cvt_pk_bf16_f32 v204, v204, v205
    v_cvt_pk_bf16_f32 v205, v206, v207
    buffer_load_dwordx4 v10, s[12:15], s35 offen offset:0 nt lds
    ds_write_b64 v57, v[204:205] offset:45056
    s_add_u32 m0, s32, 70528
    v_pk_mul_f32 v[208:209], v[208:209], v[16:17] op_sel_hi:[1,0]
    v_pk_mul_f32 v[210:211], v[210:211], v[16:17] op_sel_hi:[1,0]
    v_cvt_pk_bf16_f32 v208, v208, v209
    v_cvt_pk_bf16_f32 v209, v210, v211
    buffer_load_dwordx4 v10, s[12:15], s35 offen offset:128 nt lds
    ds_write_b64 v57, v[208:209] offset:33280
    s_add_u32 m0, s32, 71424
    v_pk_mul_f32 v[212:213], v[212:213], v[16:17] op_sel_hi:[1,0]
    v_pk_mul_f32 v[214:215], v[214:215], v[16:17] op_sel_hi:[1,0]
    v_cvt_pk_bf16_f32 v212, v212, v213
    v_cvt_pk_bf16_f32 v213, v214, v215
    buffer_load_dwordx4 v10, s[12:15], s35 offen offset:256 nt lds
    ds_write_b64 v57, v[212:213] offset:37376
    s_add_u32 m0, s32, 72320
    v_pk_mul_f32 v[216:217], v[216:217], v[16:17] op_sel_hi:[1,0]
    v_pk_mul_f32 v[218:219], v[218:219], v[16:17] op_sel_hi:[1,0]
    v_cvt_pk_bf16_f32 v216, v216, v217
    v_cvt_pk_bf16_f32 v217, v218, v219
    buffer_load_dwordx4 v10, s[12:15], s35 offen offset:384 nt lds
    ds_write_b64 v57, v[216:217] offset:41472
    v_pk_mul_f32 v[220:221], v[220:221], v[16:17] op_sel_hi:[1,0]
    v_pk_mul_f32 v[222:223], v[222:223], v[16:17] op_sel_hi:[1,0]
    v_cvt_pk_bf16_f32 v220, v220, v221
    v_cvt_pk_bf16_f32 v221, v222, v223
    ds_write_b64 v57, v[220:221] offset:45568
    v_pk_mul_f32 v[224:225], v[224:225], v[16:17] op_sel_hi:[1,0]
    v_pk_mul_f32 v[226:227], v[226:227], v[16:17] op_sel_hi:[1,0]
    v_cvt_pk_bf16_f32 v224, v224, v225
    v_cvt_pk_bf16_f32 v225, v226, v227
    ds_write_b64 v57, v[224:225] offset:33792
    v_pk_mul_f32 v[228:229], v[228:229], v[16:17] op_sel_hi:[1,0]
    v_pk_mul_f32 v[230:231], v[230:231], v[16:17] op_sel_hi:[1,0]
    v_cvt_pk_bf16_f32 v228, v228, v229
    v_cvt_pk_bf16_f32 v229, v230, v231
    ds_write_b64 v57, v[228:229] offset:37888
    v_pk_mul_f32 v[232:233], v[232:233], v[16:17] op_sel_hi:[1,0]
    v_pk_mul_f32 v[234:235], v[234:235], v[16:17] op_sel_hi:[1,0]
    v_cvt_pk_bf16_f32 v232, v232, v233
    v_cvt_pk_bf16_f32 v233, v234, v235
    ds_write_b64 v57, v[232:233] offset:41984
    v_pk_mul_f32 v[236:237], v[236:237], v[16:17] op_sel_hi:[1,0]
    v_pk_mul_f32 v[238:239], v[238:239], v[16:17] op_sel_hi:[1,0]
    v_cvt_pk_bf16_f32 v236, v236, v237
    v_cvt_pk_bf16_f32 v237, v238, v239
    ds_write_b64 v57, v[236:237] offset:46080
    v_pk_mul_f32 v[240:241], v[240:241], v[16:17] op_sel_hi:[1,0]
    v_pk_mul_f32 v[242:243], v[242:243], v[16:17] op_sel_hi:[1,0]
    v_cvt_pk_bf16_f32 v240, v240, v241
    v_cvt_pk_bf16_f32 v241, v242, v243
    ds_write_b64 v57, v[240:241] offset:34304
    v_pk_mul_f32 v[244:245], v[244:245], v[16:17] op_sel_hi:[1,0]
    v_pk_mul_f32 v[246:247], v[246:247], v[16:17] op_sel_hi:[1,0]
    v_cvt_pk_bf16_f32 v244, v244, v245
    v_cvt_pk_bf16_f32 v245, v246, v247
    ds_write_b64 v57, v[244:245] offset:38400
    v_pk_mul_f32 v[248:249], v[248:249], v[16:17] op_sel_hi:[1,0]
    v_pk_mul_f32 v[250:251], v[250:251], v[16:17] op_sel_hi:[1,0]
    v_cvt_pk_bf16_f32 v248, v248, v249
    v_cvt_pk_bf16_f32 v249, v250, v251
    ds_write_b64 v57, v[248:249] offset:42496
    v_pk_mul_f32 v[252:253], v[252:253], v[16:17] op_sel_hi:[1,0]
    v_pk_mul_f32 v[254:255], v[254:255], v[16:17] op_sel_hi:[1,0]
    v_cvt_pk_bf16_f32 v252, v252, v253
    v_cvt_pk_bf16_f32 v253, v254, v255
    ds_write_b64 v57, v[252:253] offset:46592
    s_waitcnt lgkmcnt(0)
    s_barrier
    ds_read_b128 a[8:11], v58 offset:32768
    ds_read_b128 a[40:43], v58 offset:36864
    ds_read_b128 a[72:75], v59 offset:32768
    ds_read_b128 a[104:107], v59 offset:36864
    ds_read_b128 a[12:15], v58 offset:33792
    ds_read_b128 a[44:47], v58 offset:37888
    ds_read_b128 a[76:79], v59 offset:33792
    ds_read_b128 a[108:111], v59 offset:37888
    ds_read_b128 a[24:27], v58 offset:34816
    ds_read_b128 a[56:59], v58 offset:38912
    ds_read_b128 a[88:91], v59 offset:34816
    ds_read_b128 a[120:123], v59 offset:38912
    ds_read_b128 a[28:31], v58 offset:35840
    ds_read_b128 a[60:63], v58 offset:39936
    ds_read_b128 a[92:95], v59 offset:35840
    ds_read_b128 a[124:127], v59 offset:39936
    v_mfma_f32_16x16x32_bf16 v[64:67], v[24:27], a[0:3], 0
    ds_read_b128 v[40:43], v2 offset:2048
    v_mfma_f32_16x16x32_bf16 v[72:75], v[24:27], a[32:35], 0
    v_mfma_f32_16x16x32_bf16 v[80:83], v[24:27], a[64:67], 0
    v_mfma_f32_16x16x32_bf16 v[88:91], v[24:27], a[96:99], 0
    v_mfma_f32_16x16x32_bf16 v[88:91], v[28:31], a[100:103], v[88:91]
    ds_read_b128 v[24:27], v3 offset:2048
    v_mfma_f32_16x16x32_bf16 v[80:83], v[28:31], a[68:71], v[80:83]
    v_mfma_f32_16x16x32_bf16 v[72:75], v[28:31], a[36:39], v[72:75]
    v_mfma_f32_16x16x32_bf16 v[64:67], v[28:31], a[4:7], v[64:67]
    s_waitcnt lgkmcnt(2)
    v_mfma_f32_16x16x32_bf16 v[64:67], v[32:35], a[8:11], v[64:67]
    s_mul_i32 s70, s36, 3584
    s_lshl_b32 s62, s40, 7
    ds_read_b128 v[28:31], v2 offset:3072
    v_mfma_f32_16x16x32_bf16 v[72:75], v[32:35], a[40:43], v[72:75]
    s_lshl_b32 s63, s41, 7
    s_lshl_b32 s64, s42, 7
    s_lshl_b32 s65, s43, 7
    v_mfma_f32_16x16x32_bf16 v[80:83], v[32:35], a[72:75], v[80:83]
    s_lshl_b32 s66, s44, 7
    s_lshl_b32 s67, s45, 7
    s_lshl_b32 s68, s46, 7
    v_mfma_f32_16x16x32_bf16 v[88:91], v[32:35], a[104:107], v[88:91]
    s_mov_b32 s36, 0
    s_lshl_b32 s17, s101, 6
    v_mfma_f32_16x16x32_bf16 v[88:91], v[36:39], a[108:111], v[88:91]
    s_add_u32 s17, s17, 1
    ds_read_b128 v[32:35], v3 offset:3072
    v_mfma_f32_16x16x32_bf16 v[80:83], v[36:39], a[76:79], v[80:83]
    v_mfma_f32_16x16x32_bf16 v[72:75], v[36:39], a[44:47], v[72:75]
    v_mfma_f32_16x16x32_bf16 v[64:67], v[36:39], a[12:15], v[64:67]
    s_waitcnt lgkmcnt(3)
    v_mfma_f32_16x16x32_bf16 v[64:67], v[40:43], a[16:19], v[64:67]
    ds_read_b128 v[36:39], v2 offset:8192
    v_mfma_f32_16x16x32_bf16 v[72:75], v[40:43], a[48:51], v[72:75]
    v_mfma_f32_16x16x32_bf16 v[80:83], v[40:43], a[80:83], v[80:83]
    v_mfma_f32_16x16x32_bf16 v[88:91], v[40:43], a[112:115], v[88:91]
    s_waitcnt lgkmcnt(3)
    v_mfma_f32_16x16x32_bf16 v[88:91], v[24:27], a[116:119], v[88:91]
    ds_read_b128 v[40:43], v3 offset:8192
    v_mfma_f32_16x16x32_bf16 v[80:83], v[24:27], a[84:87], v[80:83]
    v_mfma_f32_16x16x32_bf16 v[72:75], v[24:27], a[52:55], v[72:75]
    v_mfma_f32_16x16x32_bf16 v[64:67], v[24:27], a[20:23], v[64:67]
    s_waitcnt lgkmcnt(3)
    v_mfma_f32_16x16x32_bf16 v[64:67], v[28:31], a[24:27], v[64:67]
    ds_read_b128 v[24:27], v2 offset:9216
    v_mfma_f32_16x16x32_bf16 v[72:75], v[28:31], a[56:59], v[72:75]
    v_mfma_f32_16x16x32_bf16 v[80:83], v[28:31], a[88:91], v[80:83]
    v_mfma_f32_16x16x32_bf16 v[88:91], v[28:31], a[120:123], v[88:91]
    s_waitcnt lgkmcnt(3)
    v_mfma_f32_16x16x32_bf16 v[88:91], v[32:35], a[124:127], v[88:91]
    ds_read_b128 v[28:31], v3 offset:9216
    v_mfma_f32_16x16x32_bf16 v[80:83], v[32:35], a[92:95], v[80:83]
    v_mfma_f32_16x16x32_bf16 v[72:75], v[32:35], a[60:63], v[72:75]
    v_mfma_f32_16x16x32_bf16 v[64:67], v[32:35], a[28:31], v[64:67]
    s_waitcnt lgkmcnt(3)
    v_mfma_f32_16x16x32_bf16 v[68:71], v[36:39], a[0:3], 0
    ds_read_b128 v[32:35], v2 offset:10240
    v_mfma_f32_16x16x32_bf16 v[76:79], v[36:39], a[32:35], 0
    v_mfma_f32_16x16x32_bf16 v[84:87], v[36:39], a[64:67], 0
    v_mfma_f32_16x16x32_bf16 v[92:95], v[36:39], a[96:99], 0
    s_waitcnt lgkmcnt(3)
    v_mfma_f32_16x16x32_bf16 v[92:95], v[40:43], a[100:103], v[92:95]
    ds_read_b128 v[36:39], v3 offset:10240
    v_mfma_f32_16x16x32_bf16 v[84:87], v[40:43], a[68:71], v[84:87]
    v_mfma_f32_16x16x32_bf16 v[76:79], v[40:43], a[36:39], v[76:79]
    v_mfma_f32_16x16x32_bf16 v[68:71], v[40:43], a[4:7], v[68:71]
    s_waitcnt lgkmcnt(3)
    v_mfma_f32_16x16x32_bf16 v[68:71], v[24:27], a[8:11], v[68:71]
    ds_read_b128 v[40:43], v2 offset:11264
    v_max3_f32 v16, v64, v65, v66
    v_mfma_f32_16x16x32_bf16 v[76:79], v[24:27], a[40:43], v[76:79]
    v_max_f32 v16, v16, v67
    v_max3_f32 v17, v72, v73, v74
    v_mfma_f32_16x16x32_bf16 v[84:87], v[24:27], a[72:75], v[84:87]
    ds_read_b128 v[44:47], v3 offset:11264
    v_max_f32 v17, v17, v75
    v_mfma_f32_16x16x32_bf16 v[92:95], v[24:27], a[104:107], v[92:95]
    s_waitcnt lgkmcnt(4)
    v_max3_f32 v18, v80, v81, v82
    v_max_f32 v18, v18, v83
    v_mfma_f32_16x16x32_bf16 v[92:95], v[28:31], a[108:111], v[92:95]
    v_max3_f32 v19, v88, v89, v90
    v_max_f32 v19, v19, v91
    v_mfma_f32_16x16x32_bf16 v[84:87], v[28:31], a[76:79], v[84:87]
    v_mfma_f32_16x16x32_bf16 v[76:79], v[28:31], a[44:47], v[76:79]
    v_mfma_f32_16x16x32_bf16 v[68:71], v[28:31], a[12:15], v[68:71]
    s_waitcnt lgkmcnt(3)
    v_mfma_f32_16x16x32_bf16 v[68:71], v[32:35], a[16:19], v[68:71]
    v_mfma_f32_16x16x32_bf16 v[76:79], v[32:35], a[48:51], v[76:79]
    v_mfma_f32_16x16x32_bf16 v[84:87], v[32:35], a[80:83], v[84:87]
    v_mfma_f32_16x16x32_bf16 v[92:95], v[32:35], a[112:115], v[92:95]
    s_waitcnt lgkmcnt(2)
    v_mfma_f32_16x16x32_bf16 v[92:95], v[36:39], a[116:119], v[92:95]
    s_waitcnt vmcnt(8) lgkmcnt(0)
    s_barrier
    v_mfma_f32_16x16x32_bf16 v[84:87], v[36:39], a[84:87], v[84:87]
    s_add_u32 m0, s32, 0
    ds_read_b128 v[24:27], v2 offset:32768
    v_mfma_f32_16x16x32_bf16 v[76:79], v[36:39], a[52:55], v[76:79]
    s_mov_b32 s33, 16384
    buffer_load_dwordx4 v8, s[8:11], s33 offen offset:0 nt lds
    v_mfma_f32_16x16x32_bf16 v[68:71], v[36:39], a[20:23], v[68:71]
    s_add_u32 m0, s32, 896
    ds_read_b128 v[28:31], v3 offset:32768
    v_mfma_f32_16x16x32_bf16 v[68:71], v[40:43], a[24:27], v[68:71]
    buffer_load_dwordx4 v8, s[8:11], s33 offen offset:128 nt lds
    v_mfma_f32_16x16x32_bf16 v[76:79], v[40:43], a[56:59], v[76:79]
    s_add_u32 m0, s32, 1792
    ds_read_b128 v[32:35], v2 offset:33792
    v_mfma_f32_16x16x32_bf16 v[84:87], v[40:43], a[88:91], v[84:87]
    buffer_load_dwordx4 v8, s[8:11], s33 offen offset:256 nt lds
    v_mfma_f32_16x16x32_bf16 v[92:95], v[40:43], a[120:123], v[92:95]
    v_mfma_f32_16x16x32_bf16 v[92:95], v[44:47], a[124:127], v[92:95]
    ds_read_b128 v[36:39], v3 offset:33792
    v_mfma_f32_16x16x32_bf16 v[84:87], v[44:47], a[92:95], v[84:87]
    v_mfma_f32_16x16x32_bf16 v[76:79], v[44:47], a[60:63], v[76:79]
    v_mfma_f32_16x16x32_bf16 v[68:71], v[44:47], a[28:31], v[68:71]
    s_waitcnt lgkmcnt(3)
L_ramp0:
    v_mfma_f32_16x16x32_bf16 v[96:99], v[24:27], a[0:3], 0
    s_add_u32 s34, s34, 8192
    s_add_u32 s35, s35, 8192
    ds_read_b128 v[40:43], v2 offset:34816
    v_mfma_f32_16x16x32_bf16 v[104:107], v[24:27], a[32:35], 0
    s_add_u32 m0, s32, 2688
    v_mfma_f32_16x16x32_bf16 v[112:115], v[24:27], a[64:67], 0
    buffer_load_dwordx4 v8, s[8:11], s33 offen offset:384 nt lds
    v_mfma_f32_16x16x32_bf16 v[120:123], v[24:27], a[96:99], 0
    s_waitcnt lgkmcnt(3)
    v_max3_f32 v16, v16, v68, v69
    v_max3_f32 v16, v16, v70, v71
    v_max3_f32 v17, v17, v76, v77
    v_max3_f32 v17, v17, v78, v79
    v_mfma_f32_16x16x32_bf16 v[120:123], v[28:31], a[100:103], v[120:123]
    s_add_u32 m0, s32, 4096
    ds_read_b128 v[24:27], v3 offset:34816
    v_max3_f32 v18, v18, v84, v85
    v_max3_f32 v18, v18, v86, v87
    v_max3_f32 v19, v19, v92, v93
    v_mfma_f32_16x16x32_bf16 v[112:115], v[28:31], a[68:71], v[112:115]
    buffer_load_dwordx4 v9, s[8:11], s33 offen offset:0 nt lds
    v_max3_f32 v19, v19, v94, v95
    v_mov_b32 v20, v16
    v_mov_b32 v21, v17
    v_mov_b32 v22, v18
    v_mfma_f32_16x16x32_bf16 v[104:107], v[28:31], a[36:39], v[104:107]
    v_mov_b32 v23, v19
    v_permlane32_swap_b32 v16, v20
    v_permlane32_swap_b32 v17, v21
    v_mfma_f32_16x16x32_bf16 v[96:99], v[28:31], a[4:7], v[96:99]
    s_waitcnt lgkmcnt(3)
    v_permlane32_swap_b32 v18, v22
    v_permlane32_swap_b32 v19, v23
    v_max_f32 v16, v16, v20
    v_max_f32 v17, v17, v21
    v_mfma_f32_16x16x32_bf16 v[96:99], v[32:35], a[8:11], v[96:99]
    s_add_u32 m0, s32, 4992
    ds_read_b128 v[28:31], v2 offset:35840
    v_max_f32 v18, v18, v22
    v_max_f32 v19, v19, v23
    v_mov_b32 v20, v16
    v_mfma_f32_16x16x32_bf16 v[104:107], v[32:35], a[40:43], v[104:107]
    buffer_load_dwordx4 v9, s[8:11], s33 offen offset:128 nt lds
    v_mov_b32 v21, v17
    v_mov_b32 v22, v18
    v_mov_b32 v23, v19
    v_permlane16_swap_b32 v16, v20
    v_mfma_f32_16x16x32_bf16 v[112:115], v[32:35], a[72:75], v[112:115]
    v_permlane16_swap_b32 v17, v21
    v_permlane16_swap_b32 v18, v22
    v_permlane16_swap_b32 v19, v23
    v_mfma_f32_16x16x32_bf16 v[120:123], v[32:35], a[104:107], v[120:123]
    s_waitcnt lgkmcnt(3)
    v_max_f32 v16, v16, v20
    v_max_f32 v17, v17, v21
    v_max_f32 v18, v18, v22
    v_mfma_f32_16x16x32_bf16 v[120:123], v[36:39], a[108:111], v[120:123]
    s_add_u32 m0, s32, 5888
    ds_read_b128 v[32:35], v3 offset:35840
    v_max_f32 v19, v19, v23
    v_ceil_f32 v16, v16
    v_ceil_f32 v17, v17
    v_ceil_f32 v18, v18
    v_mfma_f32_16x16x32_bf16 v[112:115], v[36:39], a[76:79], v[112:115]
    buffer_load_dwordx4 v9, s[8:11], s33 offen offset:256 nt lds
    v_ceil_f32 v19, v19
    v_sub_f32 v48, 0, v16
    v_sub_f32 v49, 0, v16
    v_mfma_f32_16x16x32_bf16 v[104:107], v[36:39], a[44:47], v[104:107]
    v_sub_f32 v50, 0, v16
    v_sub_f32 v51, 0, v16
    v_sub_f32 v52, 0, v17
    v_sub_f32 v53, 0, v17
    v_mfma_f32_16x16x32_bf16 v[96:99], v[36:39], a[12:15], v[96:99]
    s_waitcnt lgkmcnt(3)
    v_sub_f32 v54, 0, v17
    v_sub_f32 v55, 0, v17
    v_sub_f32 v56, 0, v18
    v_mfma_f32_16x16x32_bf16 v[96:99], v[40:43], a[16:19], v[96:99]
    s_add_u32 m0, s32, 6784
    ds_read_b128 v[36:39], v2 offset:40960
    v_sub_f32 v57, 0, v18
    v_sub_f32 v58, 0, v18
    v_sub_f32 v59, 0, v18
    v_sub_f32 v60, 0, v19
    v_mfma_f32_16x16x32_bf16 v[104:107], v[40:43], a[48:51], v[104:107]
    buffer_load_dwordx4 v9, s[8:11], s33 offen offset:384 nt lds
    v_sub_f32 v61, 0, v19
    v_sub_f32 v62, 0, v19
    v_sub_f32 v63, 0, v19
    v_mfma_f32_16x16x32_bf16 v[112:115], v[40:43], a[80:83], v[112:115]
    v_add_f32 v64, v64, v48
    v_add_f32 v65, v65, v48
    v_add_f32 v66, v66, v48
    v_add_f32 v67, v67, v48
    v_mfma_f32_16x16x32_bf16 v[120:123], v[40:43], a[112:115], v[120:123]
    s_waitcnt lgkmcnt(3)
    v_add_f32 v68, v68, v48
    v_add_f32 v69, v69, v48
    v_add_f32 v70, v70, v48
    v_mfma_f32_16x16x32_bf16 v[120:123], v[24:27], a[116:119], v[120:123]
    s_add_u32 m0, s32, 98304
    ds_read_b128 v[40:43], v3 offset:40960
    v_add_f32 v71, v71, v48
    v_add_f32 v72, v72, v52
    v_add_f32 v73, v73, v52
    v_mfma_f32_16x16x32_bf16 v[112:115], v[24:27], a[84:87], v[112:115]
    buffer_load_dwordx4 v10, s[12:15], s34 offen offset:0 nt lds
    v_add_f32 v74, v74, v52
    v_add_f32 v75, v75, v52
    v_add_f32 v76, v76, v52
    v_add_f32 v77, v77, v52
    v_mfma_f32_16x16x32_bf16 v[104:107], v[24:27], a[52:55], v[104:107]
    v_add_f32 v78, v78, v52
    v_add_f32 v79, v79, v52
    v_add_f32 v80, v80, v56
    v_mfma_f32_16x16x32_bf16 v[96:99], v[24:27], a[20:23], v[96:99]
    s_waitcnt lgkmcnt(3)
    v_add_f32 v81, v81, v56
    v_add_f32 v82, v82, v56
    v_add_f32 v83, v83, v56
    v_add_f32 v84, v84, v56
    v_mfma_f32_16x16x32_bf16 v[96:99], v[28:31], a[24:27], v[96:99]
    s_add_u32 m0, s32, 99200
    ds_read_b128 v[24:27], v2 offset:41984
    v_add_f32 v85, v85, v56
    v_add_f32 v86, v86, v56
    v_add_f32 v87, v87, v56
    v_mfma_f32_16x16x32_bf16 v[104:107], v[28:31], a[56:59], v[104:107]
    buffer_load_dwordx4 v10, s[12:15], s34 offen offset:128 nt lds
    v_add_f32 v88, v88, v60
    v_add_f32 v89, v89, v60
    v_add_f32 v90, v90, v60
    v_add_f32 v91, v91, v60
    v_mfma_f32_16x16x32_bf16 v[112:115], v[28:31], a[88:91], v[112:115]
    v_add_f32 v92, v92, v60
    v_add_f32 v93, v93, v60
    v_add_f32 v94, v94, v60
    v_mfma_f32_16x16x32_bf16 v[120:123], v[28:31], a[120:123], v[120:123]
    s_waitcnt lgkmcnt(3)
    v_add_f32 v95, v95, v60
    v_exp_f32 v64, v64
    v_mfma_f32_16x16x32_bf16 v[120:123], v[32:35], a[124:127], v[120:123]
    s_add_u32 m0, s32, 100096
    ds_read_b128 v[28:31], v3 offset:41984
    v_add_f32 v12, v12, v64
    v_exp_f32 v65, v65
    v_exp_f32 v66, v66
    v_mfma_f32_16x16x32_bf16 v[112:115], v[32:35], a[92:95], v[112:115]
    buffer_load_dwordx4 v10, s[12:15], s34 offen offset:256 nt lds
    v_add_f32 v12, v12, v65
    v_cvt_pk_bf16_f32 v64, v64, v65
    v_mfma_f32_16x16x32_bf16 v[104:107], v[32:35], a[60:63], v[104:107]
    v_exp_f32 v67, v67
    v_add_f32 v12, v12, v66
    v_add_f32 v12, v12, v67
    v_mfma_f32_16x16x32_bf16 v[96:99], v[32:35], a[28:31], v[96:99]
    s_waitcnt lgkmcnt(3)
    v_exp_f32 v68, v68
    v_cvt_pk_bf16_f32 v65, v66, v67
    v_mfma_f32_16x16x32_bf16 v[100:103], v[36:39], a[0:3], 0
    s_add_u32 m0, s32, 100992
    ds_read_b128 v[32:35], v2 offset:43008
    v_add_f32 v12, v12, v68
    v_exp_f32 v69, v69
    s_nop 0
    v_add_f32 v12, v12, v69
    v_mfma_f32_16x16x32_bf16 v[108:111], v[36:39], a[32:35], 0
    buffer_load_dwordx4 v10, s[12:15], s34 offen offset:384 nt lds
    v_cvt_pk_bf16_f32 v66, v68, v69
    v_exp_f32 v70, v70
    v_mfma_f32_16x16x32_bf16 v[116:119], v[36:39], a[64:67], 0
    v_add_f32 v12, v12, v70
    v_exp_f32 v71, v71
    s_nop 0
    v_add_f32 v12, v12, v71
    v_mfma_f32_16x16x32_bf16 v[124:127], v[36:39], a[96:99], 0
    s_waitcnt lgkmcnt(3)
    v_cvt_pk_bf16_f32 v67, v70, v71
    v_exp_f32 v72, v72
    v_mfma_f32_16x16x32_bf16 v[124:127], v[40:43], a[100:103], v[124:127]
    s_add_u32 m0, s32, 102400
    ds_read_b128 v[36:39], v3 offset:43008
    v_exp_f32 v73, v73
    v_add_f32 v13, v13, v72
    v_mfma_f32_16x16x32_bf16 v[116:119], v[40:43], a[68:71], v[116:119]
    buffer_load_dwordx4 v10, s[12:15], s35 offen offset:0 nt lds
    v_add_f32 v13, v13, v73
    v_exp_f32 v74, v74
    v_cvt_pk_bf16_f32 v72, v72, v73
    v_mfma_f32_16x16x32_bf16 v[108:111], v[40:43], a[36:39], v[108:111]
    v_add_f32 v13, v13, v74
    v_exp_f32 v75, v75
    v_mfma_f32_16x16x32_bf16 v[100:103], v[40:43], a[4:7], v[100:103]
    s_waitcnt lgkmcnt(3)
    v_add_f32 v13, v13, v75
    v_cvt_pk_bf16_f32 v73, v74, v75
    v_exp_f32 v76, v76
    v_mfma_f32_16x16x32_bf16 v[100:103], v[24:27], a[8:11], v[100:103]
    s_add_u32 m0, s32, 103296
    ds_read_b128 v[40:43], v2 offset:44032
    v_exp_f32 v77, v77
    v_add_f32 v13, v13, v76
    v_mfma_f32_16x16x32_bf16 v[108:111], v[24:27], a[40:43], v[108:111]
    buffer_load_dwordx4 v10, s[12:15], s35 offen offset:128 nt lds
    v_add_f32 v13, v13, v77
    v_cvt_pk_bf16_f32 v74, v76, v77
    v_exp_f32 v78, v78
    v_mfma_f32_16x16x32_bf16 v[116:119], v[24:27], a[72:75], v[116:119]
    ds_read_b128 v[44:47], v3 offset:44032
    v_add_f32 v13, v13, v78
    v_exp_f32 v79, v79
    v_mfma_f32_16x16x32_bf16 v[124:127], v[24:27], a[104:107], v[124:127]
    s_waitcnt lgkmcnt(4)
    s_add_u32 m0, s32, 104192
    v_add_f32 v13, v13, v79
    v_cvt_pk_bf16_f32 v75, v78, v79
    v_exp_f32 v80, v80
    v_mfma_f32_16x16x32_bf16 v[124:127], v[28:31], a[108:111], v[124:127]
    buffer_load_dwordx4 v10, s[12:15], s35 offen offset:256 nt lds
    v_add_f32 v14, v14, v80
    v_exp_f32 v81, v81
    v_mfma_f32_16x16x32_bf16 v[116:119], v[28:31], a[76:79], v[116:119]
    v_add_f32 v14, v14, v81
    v_cvt_pk_bf16_f32 v80, v80, v81
    v_exp_f32 v82, v82
    v_mfma_f32_16x16x32_bf16 v[108:111], v[28:31], a[44:47], v[108:111]
    s_add_u32 m0, s32, 105088
    v_exp_f32 v83, v83
    v_exp_f32 v84, v84
    v_mfma_f32_16x16x32_bf16 v[100:103], v[28:31], a[12:15], v[100:103]
    s_waitcnt lgkmcnt(3)
    buffer_load_dwordx4 v10, s[12:15], s35 offen offset:384 nt lds
    v_add_f32 v14, v14, v82
    v_add_f32 v14, v14, v83
    v_mfma_f32_16x16x32_bf16 v[100:103], v[32:35], a[16:19], v[100:103]
    v_exp_f32 v85, v85
    v_cvt_pk_bf16_f32 v81, v82, v83
    v_add_f32 v14, v14, v84
    v_mfma_f32_16x16x32_bf16 v[108:111], v[32:35], a[48:51], v[108:111]
    v_add_f32 v14, v14, v85
    v_cvt_pk_bf16_f32 v82, v84, v85
    v_exp_f32 v86, v86
    v_mfma_f32_16x16x32_bf16 v[116:119], v[32:35], a[80:83], v[116:119]
    v_add_f32 v14, v14, v86
    v_exp_f32 v87, v87
    v_mfma_f32_16x16x32_bf16 v[124:127], v[32:35], a[112:115], v[124:127]
    s_waitcnt lgkmcnt(2)
    v_add_f32 v14, v14, v87
    v_cvt_pk_bf16_f32 v83, v86, v87
    v_exp_f32 v88, v88
    v_mfma_f32_16x16x32_bf16 v[124:127], v[36:39], a[116:119], v[124:127]
    s_waitcnt vmcnt(16) lgkmcnt(0)
    s_barrier
    v_add_f32 v15, v15, v88
    v_exp_f32 v89, v89
    v_mfma_f32_16x16x32_bf16 v[116:119], v[36:39], a[84:87], v[116:119]
    ds_read_b64_tr_b16 v[24:25], v4 offset:0
    v_add_f32 v15, v15, v89
    v_cvt_pk_bf16_f32 v88, v88, v89
    v_exp_f32 v90, v90
    v_mfma_f32_16x16x32_bf16 v[108:111], v[36:39], a[52:55], v[108:111]
    ds_read_b64_tr_b16 v[26:27], v4 offset:8192
    v_add_f32 v15, v15, v90
    v_exp_f32 v91, v91
    v_mfma_f32_16x16x32_bf16 v[100:103], v[36:39], a[20:23], v[100:103]
    ds_read_b64_tr_b16 v[28:29], v5 offset:0
    v_exp_f32 v92, v92
    v_exp_f32 v93, v93
    v_mfma_f32_16x16x32_bf16 v[100:103], v[40:43], a[24:27], v[100:103]
    ds_read_b64_tr_b16 v[30:31], v5 offset:8192
    v_add_f32 v15, v15, v91
    v_cvt_pk_bf16_f32 v89, v90, v91
    v_mfma_f32_16x16x32_bf16 v[108:111], v[40:43], a[56:59], v[108:111]
    ds_read_b64_tr_b16 v[32:33], v6 offset:0
    v_add_f32 v15, v15, v92
    v_add_f32 v15, v15, v93
    v_exp_f32 v94, v94
    v_mfma_f32_16x16x32_bf16 v[116:119], v[40:43], a[88:91], v[116:119]
    ds_read_b64_tr_b16 v[34:35], v6 offset:8192
    v_cvt_pk_bf16_f32 v90, v92, v93
    v_add_f32 v15, v15, v94
    v_exp_f32 v95, v95
    v_mfma_f32_16x16x32_bf16 v[124:127], v[40:43], a[120:123], v[124:127]
    v_add_f32 v15, v15, v95
    v_cvt_pk_bf16_f32 v91, v94, v95
    v_mfma_f32_16x16x32_bf16 v[124:127], v[44:47], a[124:127], v[124:127]
    ds_read_b64_tr_b16 v[36:37], v7 offset:0
    v_mfma_f32_16x16x32_bf16 v[116:119], v[44:47], a[92:95], v[116:119]
    ds_read_b64_tr_b16 v[38:39], v7 offset:8192
    v_mfma_f32_16x16x32_bf16 v[108:111], v[44:47], a[60:63], v[108:111]
    v_mfma_f32_16x16x32_bf16 v[100:103], v[44:47], a[28:31], v[100:103]
    s_waitcnt lgkmcnt(4)
    v_mfma_f32_16x16x32_bf16 v[128:131], v[24:27], v[64:67], 0
    s_add_u32 s33, s33, 8192
    ds_read_b64_tr_b16 v[40:41], v4 offset:1024
    v_mfma_f32_16x16x32_bf16 v[132:135], v[24:27], v[72:75], 0
    s_add_u32 m0, s32, 32768
    ds_read_b64_tr_b16 v[42:43], v4 offset:9216
    v_mfma_f32_16x16x32_bf16 a[128:131], v[24:27], v[80:83], 0
    buffer_load_dwordx4 v8, s[8:11], s33 offen offset:0 nt lds
    v_mfma_f32_16x16x32_bf16 a[132:135], v[24:27], v[88:91], 0
    v_add_f32 v96, v96, v48
    v_add_f32 v97, v97, v48
    v_add_f32 v98, v98, v48
    v_add_f32 v99, v99, v48
    v_mfma_f32_16x16x32_bf16 a[140:143], v[28:31], v[88:91], 0
    ds_read_b64_tr_b16 v[24:25], v5 offset:1024
    v_mfma_f32_16x16x32_bf16 a[136:139], v[28:31], v[80:83], 0
    ds_read_b64_tr_b16 v[26:27], v5 offset:9216
    v_add_f32 v104, v104, v52
    v_add_f32 v105, v105, v52
    v_add_f32 v106, v106, v52
    v_mfma_f32_16x16x32_bf16 v[140:143], v[28:31], v[72:75], 0
    v_mfma_f32_16x16x32_bf16 v[136:139], v[28:31], v[64:67], 0
    s_waitcnt lgkmcnt(6)
    v_add_f32 v107, v107, v52
    v_add_f32 v112, v112, v56
    v_add_f32 v113, v113, v56
    v_add_f32 v114, v114, v56
    v_mfma_f32_16x16x32_bf16 v[144:147], v[32:35], v[64:67], 0
    ds_read_b64_tr_b16 v[28:29], v6 offset:1024
    v_mfma_f32_16x16x32_bf16 v[148:151], v[32:35], v[72:75], 0
    s_add_u32 m0, s32, 33664
    ds_read_b64_tr_b16 v[30:31], v6 offset:9216
    v_add_f32 v115, v115, v56
    v_add_f32 v120, v120, v60
    v_add_f32 v121, v121, v60
    v_mfma_f32_16x16x32_bf16 a[144:147], v[32:35], v[80:83], 0
    buffer_load_dwordx4 v8, s[8:11], s33 offen offset:128 nt lds
    v_mfma_f32_16x16x32_bf16 a[148:151], v[32:35], v[88:91], 0
    s_waitcnt lgkmcnt(6)
    v_add_f32 v122, v122, v60
    v_add_f32 v123, v123, v60
    v_add_f32 v100, v100, v48
    v_add_f32 v101, v101, v48
    v_mfma_f32_16x16x32_bf16 a[156:159], v[36:39], v[88:91], 0
    ds_read_b64_tr_b16 v[32:33], v7 offset:1024
    v_mfma_f32_16x16x32_bf16 a[152:155], v[36:39], v[80:83], 0
    s_add_u32 m0, s32, 34560
    ds_read_b64_tr_b16 v[34:35], v7 offset:9216
    v_add_f32 v102, v102, v48
    v_add_f32 v103, v103, v48
    v_add_f32 v108, v108, v52
    v_mfma_f32_16x16x32_bf16 v[156:159], v[36:39], v[72:75], 0
    buffer_load_dwordx4 v8, s[8:11], s33 offen offset:256 nt lds
    v_mfma_f32_16x16x32_bf16 v[152:155], v[36:39], v[64:67], 0
    s_waitcnt lgkmcnt(6)
    v_add_f32 v109, v109, v52
    v_add_f32 v110, v110, v52
    v_add_f32 v111, v111, v52
    v_add_f32 v116, v116, v56
    v_mfma_f32_16x16x32_bf16 v[160:163], v[40:43], v[64:67], 0
    ds_read_b64_tr_b16 v[36:37], v4 offset:2048
    v_mfma_f32_16x16x32_bf16 v[164:167], v[40:43], v[72:75], 0
    ds_read_b64_tr_b16 v[38:39], v4 offset:10240
    v_add_f32 v117, v117, v56
    v_add_f32 v118, v118, v56
    v_add_f32 v119, v119, v56
    v_mfma_f32_16x16x32_bf16 a[160:163], v[40:43], v[80:83], 0
    v_mfma_f32_16x16x32_bf16 a[164:167], v[40:43], v[88:91], 0
    s_waitcnt lgkmcnt(6)
    v_add_f32 v124, v124, v60
    v_add_f32 v125, v125, v60
    v_add_f32 v126, v126, v60
    v_add_f32 v127, v127, v60
    v_mfma_f32_16x16x32_bf16 a[172:175], v[24:27], v[88:91], 0
    ds_read_b64_tr_b16 v[40:41], v5 offset:2048
    v_mfma_f32_16x16x32_bf16 a[168:171], v[24:27], v[80:83], 0
    s_add_u32 m0, s32, 35456
    ds_read_b64_tr_b16 v[42:43], v5 offset:10240
    v_max3_f32 v11, v96, v97, v98
    v_max3_f32 v11, v11, v99, v104
    v_max3_f32 v11, v11, v105, v106
    v_mfma_f32_16x16x32_bf16 v[172:175], v[24:27], v[72:75], 0
    buffer_load_dwordx4 v8, s[8:11], s33 offen offset:384 nt lds
    v_mfma_f32_16x16x32_bf16 v[168:171], v[24:27], v[64:67], 0
    s_waitcnt lgkmcnt(6)
    v_max3_f32 v11, v11, v107, v112
    v_max3_f32 v11, v11, v113, v114
    v_max3_f32 v11, v11, v115, v120
    v_max3_f32 v11, v11, v121, v122
    v_mfma_f32_16x16x32_bf16 v[176:179], v[28:31], v[64:67], 0
    ds_read_b64_tr_b16 v[24:25], v6 offset:2048
    v_mfma_f32_16x16x32_bf16 v[180:183], v[28:31], v[72:75], 0
    s_add_u32 m0, s32, 36864
    ds_read_b64_tr_b16 v[26:27], v6 offset:10240
    v_max3_f32 v11, v11, v123, v100
    v_max3_f32 v11, v11, v101, v102
    v_max3_f32 v11, v11, v103, v108
    v_mfma_f32_16x16x32_bf16 a[176:179], v[28:31], v[80:83], 0
    buffer_load_dwordx4 v9, s[8:11], s33 offen offset:0 nt lds
    v_mfma_f32_16x16x32_bf16 a[180:183], v[28:31], v[88:91], 0
    s_waitcnt lgkmcnt(6)
    v_max3_f32 v11, v11, v109, v110
    v_max3_f32 v11, v11, v111, v116
    v_max3_f32 v11, v11, v117, v118
    v_max3_f32 v11, v11, v119, v124
    v_mfma_f32_16x16x32_bf16 a[188:191], v[32:35], v[88:91], 0
    ds_read_b64_tr_b16 v[28:29], v7 offset:2048
    v_mfma_f32_16x16x32_bf16 a[184:187], v[32:35], v[80:83], 0
    ds_read_b64_tr_b16 v[30:31], v7 offset:10240
    v_max3_f32 v11, v11, v125, v126
    v_max3_f32 v11, v11, v127, v127
    v_cmp_lt_f32 vcc, 0x41200000, v11
    v_mfma_f32_16x16x32_bf16 v[188:191], v[32:35], v[72:75], 0
    v_mfma_f32_16x16x32_bf16 v[184:187], v[32:35], v[64:67], 0
    s_waitcnt lgkmcnt(6)
    s_cbranch_vccnz L_tr0
L_ret0:
    v_mfma_f32_16x16x32_bf16 v[192:195], v[36:39], v[64:67], 0
    ds_read_b64_tr_b16 v[32:33], v4 offset:3072
    v_mfma_f32_16x16x32_bf16 v[196:199], v[36:39], v[72:75], 0
    s_add_u32 m0, s32, 37760
    ds_read_b64_tr_b16 v[34:35], v4 offset:11264
    v_exp_f32 v96, v96
    s_nop 0
    v_add_f32 v12, v12, v96
    v_exp_f32 v97, v97
    v_mfma_f32_16x16x32_bf16 a[192:195], v[36:39], v[80:83], 0
    buffer_load_dwordx4 v9, s[8:11], s33 offen offset:128 nt lds
    v_mfma_f32_16x16x32_bf16 a[196:199], v[36:39], v[88:91], 0
    s_waitcnt lgkmcnt(6)
    v_exp_f32 v98, v98
    v_add_f32 v12, v12, v97
    v_cvt_pk_bf16_f32 v96, v96, v97
    v_mfma_f32_16x16x32_bf16 a[204:207], v[40:43], v[88:91], 0
    ds_read_b64_tr_b16 v[36:37], v5 offset:3072
    v_mfma_f32_16x16x32_bf16 a[200:203], v[40:43], v[80:83], 0
    s_add_u32 m0, s32, 38656
    ds_read_b64_tr_b16 v[38:39], v5 offset:11264
    v_exp_f32 v99, v99
    v_add_f32 v12, v12, v98
    v_add_f32 v12, v12, v99
    v_mfma_f32_16x16x32_bf16 v[204:207], v[40:43], v[72:75], 0
    buffer_load_dwordx4 v9, s[8:11], s33 offen offset:256 nt lds
    v_mfma_f32_16x16x32_bf16 v[200:203], v[40:43], v[64:67], 0
    s_waitcnt lgkmcnt(6)
    v_exp_f32 v100, v100
    v_cvt_pk_bf16_f32 v97, v98, v99
    v_add_f32 v12, v12, v100
    v_exp_f32 v101, v101
    v_mfma_f32_16x16x32_bf16 v[208:211], v[24:27], v[64:67], 0
    ds_read_b64_tr_b16 v[40:41], v6 offset:3072
    v_mfma_f32_16x16x32_bf16 v[212:215], v[24:27], v[72:75], 0
    ds_read_b64_tr_b16 v[42:43], v6 offset:11264
    v_add_f32 v12, v12, v101
    v_cvt_pk_bf16_f32 v98, v100, v101
    v_exp_f32 v102, v102
    v_mfma_f32_16x16x32_bf16 a[208:211], v[24:27], v[80:83], 0
    ds_read_b64_tr_b16 v[44:45], v7 offset:3072
    v_mfma_f32_16x16x32_bf16 a[212:215], v[24:27], v[88:91], 0
    s_waitcnt lgkmcnt(7)
    s_add_u32 m0, s32, 39552
    ds_read_b64_tr_b16 v[46:47], v7 offset:11264
    v_add_f32 v12, v12, v102
    v_exp_f32 v103, v103
    v_mfma_f32_16x16x32_bf16 a[220:223], v[28:31], v[88:91], 0
    buffer_load_dwordx4 v9, s[8:11], s33 offen offset:384 nt lds
    v_mfma_f32_16x16x32_bf16 a[216:219], v[28:31], v[80:83], 0
    v_add_f32 v12, v12, v103
    v_cvt_pk_bf16_f32 v99, v102, v103
    v_exp_f32 v104, v104
    v_exp_f32 v105, v105
    v_mfma_f32_16x16x32_bf16 v[220:223], v[28:31], v[72:75], 0
    v_mfma_f32_16x16x32_bf16 v[216:219], v[28:31], v[64:67], 0
    s_waitcnt lgkmcnt(6)
    v_add_f32 v13, v13, v104
    v_add_f32 v13, v13, v105
    v_exp_f32 v106, v106
    v_mfma_f32_16x16x32_bf16 v[224:227], v[32:35], v[64:67], 0
    v_mfma_f32_16x16x32_bf16 v[228:231], v[32:35], v[72:75], 0
    v_cvt_pk_bf16_f32 v104, v104, v105
    v_add_f32 v13, v13, v106
    v_exp_f32 v107, v107
    v_mfma_f32_16x16x32_bf16 a[224:227], v[32:35], v[80:83], 0
    v_mfma_f32_16x16x32_bf16 a[228:231], v[32:35], v[88:91], 0
    s_waitcnt lgkmcnt(4)
    v_add_f32 v13, v13, v107
    v_cvt_pk_bf16_f32 v105, v106, v107
    v_exp_f32 v108, v108
    v_mfma_f32_16x16x32_bf16 a[236:239], v[36:39], v[88:91], 0
    s_waitcnt vmcnt(16) lgkmcnt(0)
    s_barrier
    v_mfma_f32_16x16x32_bf16 a[232:235], v[36:39], v[80:83], 0
    ds_read_b128 v[24:27], v2 offset:0
    v_exp_f32 v109, v109
    v_add_f32 v13, v13, v108
    v_add_f32 v13, v13, v109
    v_mfma_f32_16x16x32_bf16 v[236:239], v[36:39], v[72:75], 0
    v_mfma_f32_16x16x32_bf16 v[232:235], v[36:39], v[64:67], 0
    ds_read_b128 v[28:31], v3 offset:0
    v_cvt_pk_bf16_f32 v106, v108, v109
    v_exp_f32 v110, v110
    s_nop 0
    v_add_f32 v13, v13, v110
    v_mfma_f32_16x16x32_bf16 v[240:243], v[40:43], v[64:67], 0
    v_mfma_f32_16x16x32_bf16 v[244:247], v[40:43], v[72:75], 0
    ds_read_b128 v[32:35], v2 offset:1024
    v_exp_f32 v111, v111
    s_nop 0
    v_add_f32 v13, v13, v111
    v_cvt_pk_bf16_f32 v107, v110, v111
    v_exp_f32 v112, v112
    v_mfma_f32_16x16x32_bf16 a[240:243], v[40:43], v[80:83], 0
    v_mfma_f32_16x16x32_bf16 a[244:247], v[40:43], v[88:91], 0
    v_add_f32 v14, v14, v112
    v_exp_f32 v113, v113
    v_mfma_f32_16x16x32_bf16 a[252:255], v[44:47], v[88:91], 0
    ds_read_b128 v[36:39], v3 offset:1024
    v_mfma_f32_16x16x32_bf16 a[248:251], v[44:47], v[80:83], 0
    v_add_f32 v14, v14, v113
    v_cvt_pk_bf16_f32 v112, v112, v113
    v_exp_f32 v114, v114
    v_mfma_f32_16x16x32_bf16 v[252:255], v[44:47], v[72:75], 0
    s_add_u32 s36, s36, 1
    v_mfma_f32_16x16x32_bf16 v[248:251], v[44:47], v[64:67], 0
    s_waitcnt lgkmcnt(2)
    v_mfma_f32_16x16x32_bf16 v[64:67], v[24:27], a[0:3], v[48:51]
    s_add_u32 s34, s34, 8192
    s_add_u32 s35, s35, 8192
    ds_read_b128 v[40:43], v2 offset:2048
    v_mfma_f32_16x16x32_bf16 v[72:75], v[24:27], a[32:35], v[52:55]
    s_add_u32 m0, s32, 65536
    v_mfma_f32_16x16x32_bf16 v[80:83], v[24:27], a[64:67], v[56:59]
    buffer_load_dwordx4 v10, s[12:15], s34 offen offset:0 nt lds
    v_mfma_f32_16x16x32_bf16 v[88:91], v[24:27], a[96:99], v[60:63]
    v_mfma_f32_16x16x32_bf16 v[88:91], v[28:31], a[100:103], v[88:91]
    ds_read_b128 v[24:27], v3 offset:2048
    v_add_f32 v14, v14, v114
    v_exp_f32 v115, v115
    v_exp_f32 v116, v116
    v_add_f32 v14, v14, v115
    v_cvt_pk_bf16_f32 v113, v114, v115
    v_mfma_f32_16x16x32_bf16 v[80:83], v[28:31], a[68:71], v[80:83]
    v_mfma_f32_16x16x32_bf16 v[72:75], v[28:31], a[36:39], v[72:75]
    v_mfma_f32_16x16x32_bf16 v[64:67], v[28:31], a[4:7], v[64:67]
    s_waitcnt lgkmcnt(3)
    v_mfma_f32_16x16x32_bf16 v[64:67], v[32:35], a[8:11], v[64:67]
    s_add_u32 m0, s32, 66432
    ds_read_b128 v[28:31], v2 offset:3072
    v_mfma_f32_16x16x32_bf16 v[72:75], v[32:35], a[40:43], v[72:75]
    buffer_load_dwordx4 v10, s[12:15], s34 offen offset:128 nt lds
    v_mfma_f32_16x16x32_bf16 v[80:83], v[32:35], a[72:75], v[80:83]
    v_mfma_f32_16x16x32_bf16 v[88:91], v[32:35], a[104:107], v[88:91]
    s_waitcnt lgkmcnt(3)
    v_mfma_f32_16x16x32_bf16 v[88:91], v[36:39], a[108:111], v[88:91]
    ds_read_b128 v[32:35], v3 offset:3072
    v_add_f32 v14, v14, v116
    v_exp_f32 v117, v117
    s_nop 0
    v_add_f32 v14, v14, v117
    v_cvt_pk_bf16_f32 v114, v116, v117
    v_exp_f32 v118, v118
    v_mfma_f32_16x16x32_bf16 v[80:83], v[36:39], a[76:79], v[80:83]
    s_add_u32 m0, s32, 67328
    v_mfma_f32_16x16x32_bf16 v[72:75], v[36:39], a[44:47], v[72:75]
    buffer_load_dwordx4 v10, s[12:15], s34 offen offset:256 nt lds
    v_mfma_f32_16x16x32_bf16 v[64:67], v[36:39], a[12:15], v[64:67]
    s_waitcnt lgkmcnt(3)
    v_mfma_f32_16x16x32_bf16 v[64:67], v[40:43], a[16:19], v[64:67]
    ds_read_b128 v[36:39], v2 offset:8192
    v_mfma_f32_16x16x32_bf16 v[72:75], v[40:43], a[48:51], v[72:75]
    v_mfma_f32_16x16x32_bf16 v[80:83], v[40:43], a[80:83], v[80:83]
    v_mfma_f32_16x16x32_bf16 v[88:91], v[40:43], a[112:115], v[88:91]
    s_waitcnt lgkmcnt(3)
    v_mfma_f32_16x16x32_bf16 v[88:91], v[24:27], a[116:119], v[88:91]
    s_add_u32 m0, s32, 68224
    ds_read_b128 v[40:43], v3 offset:8192
    v_add_f32 v14, v14, v118
    v_exp_f32 v119, v119
    s_nop 0
    v_add_f32 v14, v14, v119
    v_cvt_pk_bf16_f32 v115, v118, v119
    v_exp_f32 v120, v120
    v_mfma_f32_16x16x32_bf16 v[80:83], v[24:27], a[84:87], v[80:83]
    buffer_load_dwordx4 v10, s[12:15], s34 offen offset:384 nt lds
    v_mfma_f32_16x16x32_bf16 v[72:75], v[24:27], a[52:55], v[72:75]
    v_mfma_f32_16x16x32_bf16 v[64:67], v[24:27], a[20:23], v[64:67]
    s_waitcnt lgkmcnt(3)
    v_mfma_f32_16x16x32_bf16 v[64:67], v[28:31], a[24:27], v[64:67]
    ds_read_b128 v[24:27], v2 offset:9216
    v_mfma_f32_16x16x32_bf16 v[72:75], v[28:31], a[56:59], v[72:75]
    s_add_u32 m0, s32, 69632
    v_mfma_f32_16x16x32_bf16 v[80:83], v[28:31], a[88:91], v[80:83]
    buffer_load_dwordx4 v10, s[12:15], s35 offen offset:0 nt lds
    v_mfma_f32_16x16x32_bf16 v[88:91], v[28:31], a[120:123], v[88:91]
    s_waitcnt lgkmcnt(3)
    v_mfma_f32_16x16x32_bf16 v[88:91], v[32:35], a[124:127], v[88:91]
    ds_read_b128 v[28:31], v3 offset:9216
    v_add_f32 v15, v15, v120
    v_exp_f32 v121, v121
    s_nop 0
    v_add_f32 v15, v15, v121
    v_cvt_pk_bf16_f32 v120, v120, v121
    v_exp_f32 v122, v122
    v_mfma_f32_16x16x32_bf16 v[80:83], v[32:35], a[92:95], v[80:83]
    v_mfma_f32_16x16x32_bf16 v[72:75], v[32:35], a[60:63], v[72:75]
    v_mfma_f32_16x16x32_bf16 v[64:67], v[32:35], a[28:31], v[64:67]
    s_waitcnt lgkmcnt(3)
    v_mfma_f32_16x16x32_bf16 v[68:71], v[36:39], a[0:3], v[48:51]
    s_add_u32 m0, s32, 70528
    ds_read_b128 v[32:35], v2 offset:10240
    v_mfma_f32_16x16x32_bf16 v[76:79], v[36:39], a[32:35], v[52:55]
    buffer_load_dwordx4 v10, s[12:15], s35 offen offset:128 nt lds
    v_mfma_f32_16x16x32_bf16 v[84:87], v[36:39], a[64:67], v[56:59]
    v_mfma_f32_16x16x32_bf16 v[92:95], v[36:39], a[96:99], v[60:63]
    s_waitcnt lgkmcnt(3)
    v_mfma_f32_16x16x32_bf16 v[92:95], v[40:43], a[100:103], v[92:95]
    ds_read_b128 v[36:39], v3 offset:10240
    v_add_f32 v15, v15, v122
    v_exp_f32 v123, v123
    v_exp_f32 v124, v124
    v_exp_f32 v125, v125
    v_mfma_f32_16x16x32_bf16 v[84:87], v[40:43], a[68:71], v[84:87]
    s_add_u32 m0, s32, 71424
    v_mfma_f32_16x16x32_bf16 v[76:79], v[40:43], a[36:39], v[76:79]
    buffer_load_dwordx4 v10, s[12:15], s35 offen offset:256 nt lds
    v_mfma_f32_16x16x32_bf16 v[68:71], v[40:43], a[4:7], v[68:71]
    s_waitcnt lgkmcnt(3)
    v_mfma_f32_16x16x32_bf16 v[68:71], v[24:27], a[8:11], v[68:71]
    ds_read_b128 v[40:43], v2 offset:11264
    v_mfma_f32_16x16x32_bf16 v[76:79], v[24:27], a[40:43], v[76:79]
    v_mfma_f32_16x16x32_bf16 v[84:87], v[24:27], a[72:75], v[84:87]
    ds_read_b128 v[44:47], v3 offset:11264
    v_mfma_f32_16x16x32_bf16 v[92:95], v[24:27], a[104:107], v[92:95]
    s_waitcnt lgkmcnt(4)
    s_add_u32 m0, s32, 72320
    v_mfma_f32_16x16x32_bf16 v[92:95], v[28:31], a[108:111], v[92:95]
    buffer_load_dwordx4 v10, s[12:15], s35 offen offset:384 nt lds
    v_add_f32 v15, v15, v123
    v_cvt_pk_bf16_f32 v121, v122, v123
    v_add_f32 v15, v15, v124
    v_add_f32 v15, v15, v125
    v_exp_f32 v126, v126
    v_mfma_f32_16x16x32_bf16 v[84:87], v[28:31], a[76:79], v[84:87]
    v_mfma_f32_16x16x32_bf16 v[76:79], v[28:31], a[44:47], v[76:79]
    v_mfma_f32_16x16x32_bf16 v[68:71], v[28:31], a[12:15], v[68:71]
    s_waitcnt lgkmcnt(3)
    v_mfma_f32_16x16x32_bf16 v[68:71], v[32:35], a[16:19], v[68:71]
    v_mfma_f32_16x16x32_bf16 v[76:79], v[32:35], a[48:51], v[76:79]
    v_mfma_f32_16x16x32_bf16 v[84:87], v[32:35], a[80:83], v[84:87]
    v_mfma_f32_16x16x32_bf16 v[92:95], v[32:35], a[112:115], v[92:95]
    s_waitcnt lgkmcnt(2)
    v_mfma_f32_16x16x32_bf16 v[92:95], v[36:39], a[116:119], v[92:95]
    s_waitcnt vmcnt(16) lgkmcnt(0)
    s_barrier
    v_cvt_pk_bf16_f32 v122, v124, v125
    v_add_f32 v15, v15, v126
    v_exp_f32 v127, v127
    s_nop 0
    v_add_f32 v15, v15, v127
    v_cvt_pk_bf16_f32 v123, v126, v127
    v_mfma_f32_16x16x32_bf16 v[84:87], v[36:39], a[84:87], v[84:87]
    ds_read_b64_tr_b16 v[24:25], v4 offset:32768
    v_mfma_f32_16x16x32_bf16 v[76:79], v[36:39], a[52:55], v[76:79]
    ds_read_b64_tr_b16 v[26:27], v4 offset:40960
    v_mfma_f32_16x16x32_bf16 v[68:71], v[36:39], a[20:23], v[68:71]
    ds_read_b64_tr_b16 v[28:29], v5 offset:32768
    v_mfma_f32_16x16x32_bf16 v[68:71], v[40:43], a[24:27], v[68:71]
    ds_read_b64_tr_b16 v[30:31], v5 offset:40960
    v_mfma_f32_16x16x32_bf16 v[76:79], v[40:43], a[56:59], v[76:79]
    ds_read_b64_tr_b16 v[32:33], v6 offset:32768
    v_mfma_f32_16x16x32_bf16 v[84:87], v[40:43], a[88:91], v[84:87]
    ds_read_b64_tr_b16 v[34:35], v6 offset:40960
    v_mfma_f32_16x16x32_bf16 v[92:95], v[40:43], a[120:123], v[92:95]
    v_mfma_f32_16x16x32_bf16 v[92:95], v[44:47], a[124:127], v[92:95]
    ds_read_b64_tr_b16 v[36:37], v7 offset:32768
    v_mfma_f32_16x16x32_bf16 v[84:87], v[44:47], a[92:95], v[84:87]
    ds_read_b64_tr_b16 v[38:39], v7 offset:40960
    v_mfma_f32_16x16x32_bf16 v[76:79], v[44:47], a[60:63], v[76:79]
    v_mfma_f32_16x16x32_bf16 v[68:71], v[44:47], a[28:31], v[68:71]
    s_waitcnt lgkmcnt(4)
    v_mfma_f32_16x16x32_bf16 v[128:131], v[24:27], v[96:99], v[128:131]
    s_add_u32 s33, s33, 8192
    ds_read_b64_tr_b16 v[40:41], v4 offset:33792
    v_mfma_f32_16x16x32_bf16 v[132:135], v[24:27], v[104:107], v[132:135]
    s_add_u32 m0, s32, 0
    ds_read_b64_tr_b16 v[42:43], v4 offset:41984
    v_mfma_f32_16x16x32_bf16 a[128:131], v[24:27], v[112:115], a[128:131]
    buffer_load_dwordx4 v8, s[8:11], s33 offen offset:0 nt lds
    v_mfma_f32_16x16x32_bf16 a[132:135], v[24:27], v[120:123], a[132:135]
    v_mfma_f32_16x16x32_bf16 a[140:143], v[28:31], v[120:123], a[140:143]
    ds_read_b64_tr_b16 v[24:25], v5 offset:33792
    v_mfma_f32_16x16x32_bf16 a[136:139], v[28:31], v[112:115], a[136:139]
    ds_read_b64_tr_b16 v[26:27], v5 offset:41984
    v_mfma_f32_16x16x32_bf16 v[140:143], v[28:31], v[104:107], v[140:143]
    v_mfma_f32_16x16x32_bf16 v[136:139], v[28:31], v[96:99], v[136:139]
    s_waitcnt lgkmcnt(6)
    v_mfma_f32_16x16x32_bf16 v[144:147], v[32:35], v[96:99], v[144:147]
    ds_read_b64_tr_b16 v[28:29], v6 offset:33792
    v_mfma_f32_16x16x32_bf16 v[148:151], v[32:35], v[104:107], v[148:151]
    s_add_u32 m0, s32, 896
    ds_read_b64_tr_b16 v[30:31], v6 offset:41984
    v_mfma_f32_16x16x32_bf16 a[144:147], v[32:35], v[112:115], a[144:147]
    buffer_load_dwordx4 v8, s[8:11], s33 offen offset:128 nt lds
    v_mfma_f32_16x16x32_bf16 a[148:151], v[32:35], v[120:123], a[148:151]
    s_waitcnt lgkmcnt(6)
    v_mfma_f32_16x16x32_bf16 a[156:159], v[36:39], v[120:123], a[156:159]
    ds_read_b64_tr_b16 v[32:33], v7 offset:33792
    v_max3_f32 v11, v64, v65, v66
    v_max3_f32 v11, v11, v67, v72
    v_max3_f32 v11, v11, v73, v74
    v_max3_f32 v11, v11, v75, v80
    v_max3_f32 v11, v11, v81, v82
    v_max3_f32 v11, v11, v83, v88
    v_max3_f32 v11, v11, v89, v90
    v_max3_f32 v11, v11, v91, v68
    v_max3_f32 v11, v11, v69, v70
    v_max3_f32 v11, v11, v71, v76
    v_max3_f32 v11, v11, v77, v78
    v_max3_f32 v11, v11, v79, v84
    v_max3_f32 v11, v11, v85, v86
    v_max3_f32 v11, v11, v87, v92
    v_max3_f32 v11, v11, v93, v94
    v_max3_f32 v11, v11, v95, v95
    v_cmp_lt_f32 vcc, 0x41200000, v11
    v_mfma_f32_16x16x32_bf16 a[152:155], v[36:39], v[112:115], a[152:155]
    s_add_u32 m0, s32, 1792
    ds_read_b64_tr_b16 v[34:35], v7 offset:41984
    v_mfma_f32_16x16x32_bf16 v[156:159], v[36:39], v[104:107], v[156:159]
    buffer_load_dwordx4 v8, s[8:11], s33 offen offset:256 nt lds
    v_mfma_f32_16x16x32_bf16 v[152:155], v[36:39], v[96:99], v[152:155]
    s_waitcnt lgkmcnt(6)
    v_mfma_f32_16x16x32_bf16 v[160:163], v[40:43], v[96:99], v[160:163]
    ds_read_b64_tr_b16 v[36:37], v4 offset:34816
    v_mfma_f32_16x16x32_bf16 v[164:167], v[40:43], v[104:107], v[164:167]
    ds_read_b64_tr_b16 v[38:39], v4 offset:43008
    v_mfma_f32_16x16x32_bf16 a[160:163], v[40:43], v[112:115], a[160:163]
    v_mfma_f32_16x16x32_bf16 a[164:167], v[40:43], v[120:123], a[164:167]
    s_waitcnt lgkmcnt(6)
    s_cbranch_vccnz L_tr1
L_ret1:
    v_mfma_f32_16x16x32_bf16 a[172:175], v[24:27], v[120:123], a[172:175]
    ds_read_b64_tr_b16 v[40:41], v5 offset:34816
    v_exp_f32 v64, v64
    s_nop 0
    v_add_f32 v12, v12, v64
    v_exp_f32 v65, v65
    v_exp_f32 v66, v66
    v_add_f32 v12, v12, v65
    v_cvt_pk_bf16_f32 v64, v64, v65
    v_exp_f32 v67, v67
    v_mfma_f32_16x16x32_bf16 a[168:171], v[24:27], v[112:115], a[168:171]
    s_add_u32 m0, s32, 2688
    ds_read_b64_tr_b16 v[42:43], v5 offset:43008
    v_mfma_f32_16x16x32_bf16 v[172:175], v[24:27], v[104:107], v[172:175]
    buffer_load_dwordx4 v8, s[8:11], s33 offen offset:384 nt lds
    v_mfma_f32_16x16x32_bf16 v[168:171], v[24:27], v[96:99], v[168:171]
    s_waitcnt lgkmcnt(6)
    v_mfma_f32_16x16x32_bf16 v[176:179], v[28:31], v[96:99], v[176:179]
    ds_read_b64_tr_b16 v[24:25], v6 offset:34816
    v_mfma_f32_16x16x32_bf16 v[180:183], v[28:31], v[104:107], v[180:183]
    s_add_u32 m0, s32, 4096
    ds_read_b64_tr_b16 v[26:27], v6 offset:43008
    v_mfma_f32_16x16x32_bf16 a[176:179], v[28:31], v[112:115], a[176:179]
    buffer_load_dwordx4 v9, s[8:11], s33 offen offset:0 nt lds
    v_mfma_f32_16x16x32_bf16 a[180:183], v[28:31], v[120:123], a[180:183]
    s_waitcnt lgkmcnt(6)
    v_mfma_f32_16x16x32_bf16 a[188:191], v[32:35], v[120:123], a[188:191]
    ds_read_b64_tr_b16 v[28:29], v7 offset:34816
    v_add_f32 v12, v12, v66
    v_add_f32 v12, v12, v67
    v_exp_f32 v68, v68
    v_cvt_pk_bf16_f32 v65, v66, v67
    v_add_f32 v12, v12, v68
    v_exp_f32 v69, v69
    s_nop 0
    v_add_f32 v12, v12, v69
    v_cvt_pk_bf16_f32 v66, v68, v69
    v_mfma_f32_16x16x32_bf16 a[184:187], v[32:35], v[112:115], a[184:187]
    ds_read_b64_tr_b16 v[30:31], v7 offset:43008
    v_mfma_f32_16x16x32_bf16 v[188:191], v[32:35], v[104:107], v[188:191]
    v_mfma_f32_16x16x32_bf16 v[184:187], v[32:35], v[96:99], v[184:187]
    s_waitcnt lgkmcnt(6)
    v_mfma_f32_16x16x32_bf16 v[192:195], v[36:39], v[96:99], v[192:195]
    ds_read_b64_tr_b16 v[32:33], v4 offset:35840
    v_mfma_f32_16x16x32_bf16 v[196:199], v[36:39], v[104:107], v[196:199]
    s_add_u32 m0, s32, 4992
    ds_read_b64_tr_b16 v[34:35], v4 offset:44032
    v_mfma_f32_16x16x32_bf16 a[192:195], v[36:39], v[112:115], a[192:195]
    buffer_load_dwordx4 v9, s[8:11], s33 offen offset:128 nt lds
    v_mfma_f32_16x16x32_bf16 a[196:199], v[36:39], v[120:123], a[196:199]
    s_waitcnt lgkmcnt(6)
    v_mfma_f32_16x16x32_bf16 a[204:207], v[40:43], v[120:123], a[204:207]
    ds_read_b64_tr_b16 v[36:37], v5 offset:35840
    v_exp_f32 v70, v70
    s_nop 0
    v_add_f32 v12, v12, v70
    v_exp_f32 v71, v71
    s_nop 0
    v_add_f32 v12, v12, v71
    v_cvt_pk_bf16_f32 v67, v70, v71
    v_exp_f32 v72, v72
    v_exp_f32 v73, v73
    v_mfma_f32_16x16x32_bf16 a[200:203], v[40:43], v[112:115], a[200:203]
    s_add_u32 m0, s32, 5888
    ds_read_b64_tr_b16 v[38:39], v5 offset:44032
    v_mfma_f32_16x16x32_bf16 v[204:207], v[40:43], v[104:107], v[204:207]
    buffer_load_dwordx4 v9, s[8:11], s33 offen offset:256 nt lds
    v_mfma_f32_16x16x32_bf16 v[200:203], v[40:43], v[96:99], v[200:203]
    s_waitcnt lgkmcnt(6)
    v_mfma_f32_16x16x32_bf16 v[208:211], v[24:27], v[96:99], v[208:211]
    ds_read_b64_tr_b16 v[40:41], v6 offset:35840
    v_mfma_f32_16x16x32_bf16 v[212:215], v[24:27], v[104:107], v[212:215]
    ds_read_b64_tr_b16 v[42:43], v6 offset:44032
    v_mfma_f32_16x16x32_bf16 a[208:211], v[24:27], v[112:115], a[208:211]
    ds_read_b64_tr_b16 v[44:45], v7 offset:35840
    v_mfma_f32_16x16x32_bf16 a[212:215], v[24:27], v[120:123], a[212:215]
    s_waitcnt lgkmcnt(7)
    s_add_u32 m0, s32, 6784
    ds_read_b64_tr_b16 v[46:47], v7 offset:44032
    v_mfma_f32_16x16x32_bf16 a[220:223], v[28:31], v[120:123], a[220:223]
    buffer_load_dwordx4 v9, s[8:11], s33 offen offset:384 nt lds
    v_add_f32 v13, v13, v72
    v_add_f32 v13, v13, v73
    v_exp_f32 v74, v74
    v_cvt_pk_bf16_f32 v72, v72, v73
    v_add_f32 v13, v13, v74
    v_exp_f32 v75, v75
    s_nop 0
    v_add_f32 v13, v13, v75
    v_cvt_pk_bf16_f32 v73, v74, v75
    v_mfma_f32_16x16x32_bf16 a[216:219], v[28:31], v[112:115], a[216:219]
    v_mfma_f32_16x16x32_bf16 v[220:223], v[28:31], v[104:107], v[220:223]
    v_mfma_f32_16x16x32_bf16 v[216:219], v[28:31], v[96:99], v[216:219]
    s_waitcnt lgkmcnt(6)
    v_mfma_f32_16x16x32_bf16 v[224:227], v[32:35], v[96:99], v[224:227]
    v_mfma_f32_16x16x32_bf16 v[228:231], v[32:35], v[104:107], v[228:231]
    v_mfma_f32_16x16x32_bf16 a[224:227], v[32:35], v[112:115], a[224:227]
    v_mfma_f32_16x16x32_bf16 a[228:231], v[32:35], v[120:123], a[228:231]
    s_waitcnt lgkmcnt(4)
    v_mfma_f32_16x16x32_bf16 a[236:239], v[36:39], v[120:123], a[236:239]
    s_waitcnt vmcnt(16) lgkmcnt(0)
    s_barrier
    v_exp_f32 v76, v76
    v_exp_f32 v77, v77
    v_add_f32 v13, v13, v76
    v_add_f32 v13, v13, v77
    v_cvt_pk_bf16_f32 v74, v76, v77
    v_exp_f32 v78, v78
    s_nop 0
    v_add_f32 v13, v13, v78
    v_exp_f32 v79, v79
    v_mfma_f32_16x16x32_bf16 a[232:235], v[36:39], v[112:115], a[232:235]
    ds_read_b128 v[24:27], v2 offset:32768
    v_mfma_f32_16x16x32_bf16 v[236:239], v[36:39], v[104:107], v[236:239]
    v_mfma_f32_16x16x32_bf16 v[232:235], v[36:39], v[96:99], v[232:235]
    ds_read_b128 v[28:31], v3 offset:32768
    v_mfma_f32_16x16x32_bf16 v[240:243], v[40:43], v[96:99], v[240:243]
    v_mfma_f32_16x16x32_bf16 v[244:247], v[40:43], v[104:107], v[244:247]
    ds_read_b128 v[32:35], v2 offset:33792
    v_mfma_f32_16x16x32_bf16 a[240:243], v[40:43], v[112:115], a[240:243]
    v_mfma_f32_16x16x32_bf16 a[244:247], v[40:43], v[120:123], a[244:247]
    v_mfma_f32_16x16x32_bf16 a[252:255], v[44:47], v[120:123], a[252:255]
    ds_read_b128 v[36:39], v3 offset:33792
    v_add_f32 v13, v13, v79
    v_cvt_pk_bf16_f32 v75, v78, v79
    v_exp_f32 v80, v80
    s_nop 0
    v_add_f32 v14, v14, v80
    v_exp_f32 v81, v81
    s_nop 0
    v_add_f32 v14, v14, v81
    v_cvt_pk_bf16_f32 v80, v80, v81
    v_mfma_f32_16x16x32_bf16 a[248:251], v[44:47], v[112:115], a[248:251]
    v_mfma_f32_16x16x32_bf16 v[252:255], v[44:47], v[104:107], v[252:255]
    v_mfma_f32_16x16x32_bf16 v[248:251], v[44:47], v[96:99], v[248:251]
    s_waitcnt lgkmcnt(2)
    s_cmp_lt_u32 s36, s17
    s_cbranch_scc0 L_loop
L_ramp1:
    v_mfma_f32_16x16x32_bf16 v[96:99], v[24:27], a[0:3], v[48:51]
    s_add_u32 s34, s34, 8192
    s_add_u32 s35, s35, 8192
    ds_read_b128 v[40:43], v2 offset:34816
    v_mfma_f32_16x16x32_bf16 v[104:107], v[24:27], a[32:35], v[52:55]
    s_add_u32 m0, s32, 98304
    v_mfma_f32_16x16x32_bf16 v[112:115], v[24:27], a[64:67], v[56:59]
    buffer_load_dwordx4 v10, s[12:15], s34 offen offset:0 nt lds
    v_mfma_f32_16x16x32_bf16 v[120:123], v[24:27], a[96:99], v[60:63]
    v_mfma_f32_16x16x32_bf16 v[120:123], v[28:31], a[100:103], v[120:123]
    ds_read_b128 v[24:27], v3 offset:34816
    v_exp_f32 v82, v82
    v_exp_f32 v83, v83
    v_exp_f32 v84, v84
    v_add_f32 v14, v14, v82
    v_mfma_f32_16x16x32_bf16 v[112:115], v[28:31], a[68:71], v[112:115]
    v_mfma_f32_16x16x32_bf16 v[104:107], v[28:31], a[36:39], v[104:107]
    v_mfma_f32_16x16x32_bf16 v[96:99], v[28:31], a[4:7], v[96:99]
    s_waitcnt lgkmcnt(3)
    v_mfma_f32_16x16x32_bf16 v[96:99], v[32:35], a[8:11], v[96:99]
    s_add_u32 m0, s32, 99200
    ds_read_b128 v[28:31], v2 offset:35840
    v_mfma_f32_16x16x32_bf16 v[104:107], v[32:35], a[40:43], v[104:107]
    buffer_load_dwordx4 v10, s[12:15], s34 offen offset:128 nt lds
    v_mfma_f32_16x16x32_bf16 v[112:115], v[32:35], a[72:75], v[112:115]
    v_mfma_f32_16x16x32_bf16 v[120:123], v[32:35], a[104:107], v[120:123]
    s_waitcnt lgkmcnt(3)
    v_mfma_f32_16x16x32_bf16 v[120:123], v[36:39], a[108:111], v[120:123]
    ds_read_b128 v[32:35], v3 offset:35840
    v_add_f32 v14, v14, v83
    v_exp_f32 v85, v85
    v_cvt_pk_bf16_f32 v81, v82, v83
    v_add_f32 v14, v14, v84
    v_add_f32 v14, v14, v85
    v_cvt_pk_bf16_f32 v82, v84, v85
    v_mfma_f32_16x16x32_bf16 v[112:115], v[36:39], a[76:79], v[112:115]
    s_add_u32 m0, s32, 100096
    v_mfma_f32_16x16x32_bf16 v[104:107], v[36:39], a[44:47], v[104:107]
    buffer_load_dwordx4 v10, s[12:15], s34 offen offset:256 nt lds
    v_mfma_f32_16x16x32_bf16 v[96:99], v[36:39], a[12:15], v[96:99]
    s_waitcnt lgkmcnt(3)
    v_mfma_f32_16x16x32_bf16 v[96:99], v[40:43], a[16:19], v[96:99]
    ds_read_b128 v[36:39], v2 offset:40960
    v_mfma_f32_16x16x32_bf16 v[104:107], v[40:43], a[48:51], v[104:107]
    v_mfma_f32_16x16x32_bf16 v[112:115], v[40:43], a[80:83], v[112:115]
    v_mfma_f32_16x16x32_bf16 v[120:123], v[40:43], a[112:115], v[120:123]
    s_waitcnt lgkmcnt(3)
    v_mfma_f32_16x16x32_bf16 v[120:123], v[24:27], a[116:119], v[120:123]
    s_add_u32 m0, s32, 100992
    ds_read_b128 v[40:43], v3 offset:40960
    v_exp_f32 v86, v86
    s_nop 0
    v_add_f32 v14, v14, v86
    v_exp_f32 v87, v87
    s_nop 0
    v_add_f32 v14, v14, v87
    v_cvt_pk_bf16_f32 v83, v86, v87
    v_mfma_f32_16x16x32_bf16 v[112:115], v[24:27], a[84:87], v[112:115]
    buffer_load_dwordx4 v10, s[12:15], s34 offen offset:384 nt lds
    v_mfma_f32_16x16x32_bf16 v[104:107], v[24:27], a[52:55], v[104:107]
    v_mfma_f32_16x16x32_bf16 v[96:99], v[24:27], a[20:23], v[96:99]
    s_waitcnt lgkmcnt(3)
    v_mfma_f32_16x16x32_bf16 v[96:99], v[28:31], a[24:27], v[96:99]
    ds_read_b128 v[24:27], v2 offset:41984
    v_mfma_f32_16x16x32_bf16 v[104:107], v[28:31], a[56:59], v[104:107]
    s_add_u32 m0, s32, 102400
    v_mfma_f32_16x16x32_bf16 v[112:115], v[28:31], a[88:91], v[112:115]
    buffer_load_dwordx4 v10, s[12:15], s35 offen offset:0 nt lds
    v_mfma_f32_16x16x32_bf16 v[120:123], v[28:31], a[120:123], v[120:123]
    s_waitcnt lgkmcnt(3)
    v_mfma_f32_16x16x32_bf16 v[120:123], v[32:35], a[124:127], v[120:123]
    ds_read_b128 v[28:31], v3 offset:41984
    v_exp_f32 v88, v88
    s_nop 0
    v_add_f32 v15, v15, v88
    v_exp_f32 v89, v89
    s_nop 0
    v_add_f32 v15, v15, v89
    v_cvt_pk_bf16_f32 v88, v88, v89
    v_mfma_f32_16x16x32_bf16 v[112:115], v[32:35], a[92:95], v[112:115]
    v_mfma_f32_16x16x32_bf16 v[104:107], v[32:35], a[60:63], v[104:107]
    v_mfma_f32_16x16x32_bf16 v[96:99], v[32:35], a[28:31], v[96:99]
    s_waitcnt lgkmcnt(3)
    v_mfma_f32_16x16x32_bf16 v[100:103], v[36:39], a[0:3], v[48:51]
    s_add_u32 m0, s32, 103296
    ds_read_b128 v[32:35], v2 offset:43008
    v_mfma_f32_16x16x32_bf16 v[108:111], v[36:39], a[32:35], v[52:55]
    buffer_load_dwordx4 v10, s[12:15], s35 offen offset:128 nt lds
    v_mfma_f32_16x16x32_bf16 v[116:119], v[36:39], a[64:67], v[56:59]
    v_mfma_f32_16x16x32_bf16 v[124:127], v[36:39], a[96:99], v[60:63]
    s_waitcnt lgkmcnt(3)
    v_mfma_f32_16x16x32_bf16 v[124:127], v[40:43], a[100:103], v[124:127]
    ds_read_b128 v[36:39], v3 offset:43008
    v_exp_f32 v90, v90
    s_nop 0
    v_add_f32 v15, v15, v90
    v_exp_f32 v91, v91
    v_exp_f32 v92, v92
    v_mfma_f32_16x16x32_bf16 v[116:119], v[40:43], a[68:71], v[116:119]
    s_add_u32 m0, s32, 104192
    v_mfma_f32_16x16x32_bf16 v[108:111], v[40:43], a[36:39], v[108:111]
    buffer_load_dwordx4 v10, s[12:15], s35 offen offset:256 nt lds
    v_mfma_f32_16x16x32_bf16 v[100:103], v[40:43], a[4:7], v[100:103]
    s_waitcnt lgkmcnt(3)
    v_mfma_f32_16x16x32_bf16 v[100:103], v[24:27], a[8:11], v[100:103]
    ds_read_b128 v[40:43], v2 offset:44032
    v_mfma_f32_16x16x32_bf16 v[108:111], v[24:27], a[40:43], v[108:111]
    v_mfma_f32_16x16x32_bf16 v[116:119], v[24:27], a[72:75], v[116:119]
    ds_read_b128 v[44:47], v3 offset:44032
    v_mfma_f32_16x16x32_bf16 v[124:127], v[24:27], a[104:107], v[124:127]
    s_waitcnt lgkmcnt(4)
    s_add_u32 m0, s32, 105088
    v_mfma_f32_16x16x32_bf16 v[124:127], v[28:31], a[108:111], v[124:127]
    buffer_load_dwordx4 v10, s[12:15], s35 offen offset:384 nt lds
    v_exp_f32 v93, v93
    v_add_f32 v15, v15, v91
    v_cvt_pk_bf16_f32 v89, v90, v91
    v_add_f32 v15, v15, v92
    v_add_f32 v15, v15, v93
    v_exp_f32 v94, v94
    v_mfma_f32_16x16x32_bf16 v[116:119], v[28:31], a[76:79], v[116:119]
    v_mfma_f32_16x16x32_bf16 v[108:111], v[28:31], a[44:47], v[108:111]
    v_mfma_f32_16x16x32_bf16 v[100:103], v[28:31], a[12:15], v[100:103]
    s_waitcnt lgkmcnt(3)
    v_mfma_f32_16x16x32_bf16 v[100:103], v[32:35], a[16:19], v[100:103]
    v_mfma_f32_16x16x32_bf16 v[108:111], v[32:35], a[48:51], v[108:111]
    v_mfma_f32_16x16x32_bf16 v[116:119], v[32:35], a[80:83], v[116:119]
    v_mfma_f32_16x16x32_bf16 v[124:127], v[32:35], a[112:115], v[124:127]
    s_waitcnt lgkmcnt(2)
    v_mfma_f32_16x16x32_bf16 v[124:127], v[36:39], a[116:119], v[124:127]
    s_waitcnt vmcnt(16) lgkmcnt(0)
    s_barrier
    v_cvt_pk_bf16_f32 v90, v92, v93
    v_add_f32 v15, v15, v94
    v_exp_f32 v95, v95
    s_nop 0
    v_add_f32 v15, v15, v95
    v_cvt_pk_bf16_f32 v91, v94, v95
    v_mfma_f32_16x16x32_bf16 v[116:119], v[36:39], a[84:87], v[116:119]
    ds_read_b64_tr_b16 v[24:25], v4 offset:0
    v_mfma_f32_16x16x32_bf16 v[108:111], v[36:39], a[52:55], v[108:111]
    ds_read_b64_tr_b16 v[26:27], v4 offset:8192
    v_mfma_f32_16x16x32_bf16 v[100:103], v[36:39], a[20:23], v[100:103]
    ds_read_b64_tr_b16 v[28:29], v5 offset:0
    v_mfma_f32_16x16x32_bf16 v[100:103], v[40:43], a[24:27], v[100:103]
    ds_read_b64_tr_b16 v[30:31], v5 offset:8192
    v_mfma_f32_16x16x32_bf16 v[108:111], v[40:43], a[56:59], v[108:111]
    ds_read_b64_tr_b16 v[32:33], v6 offset:0
    v_mfma_f32_16x16x32_bf16 v[116:119], v[40:43], a[88:91], v[116:119]
    ds_read_b64_tr_b16 v[34:35], v6 offset:8192
    v_mfma_f32_16x16x32_bf16 v[124:127], v[40:43], a[120:123], v[124:127]
    v_mfma_f32_16x16x32_bf16 v[124:127], v[44:47], a[124:127], v[124:127]
    ds_read_b64_tr_b16 v[36:37], v7 offset:0
    v_mfma_f32_16x16x32_bf16 v[116:119], v[44:47], a[92:95], v[116:119]
    ds_read_b64_tr_b16 v[38:39], v7 offset:8192
    v_mfma_f32_16x16x32_bf16 v[108:111], v[44:47], a[60:63], v[108:111]
    v_mfma_f32_16x16x32_bf16 v[100:103], v[44:47], a[28:31], v[100:103]
    s_waitcnt lgkmcnt(4)
    s_cmp_eq_u32 s36, 15
    s_cbranch_scc1 L_tail
    v_mfma_f32_16x16x32_bf16 v[128:131], v[24:27], v[64:67], v[128:131]
    s_add_u32 s33, s33, 8192
    ds_read_b64_tr_b16 v[40:41], v4 offset:1024
    v_mfma_f32_16x16x32_bf16 v[132:135], v[24:27], v[72:75], v[132:135]
    s_add_u32 m0, s32, 32768
    ds_read_b64_tr_b16 v[42:43], v4 offset:9216
    v_mfma_f32_16x16x32_bf16 a[128:131], v[24:27], v[80:83], a[128:131]
    buffer_load_dwordx4 v8, s[8:11], s33 offen offset:0 nt lds
    v_mfma_f32_16x16x32_bf16 a[132:135], v[24:27], v[88:91], a[132:135]
    v_mfma_f32_16x16x32_bf16 a[140:143], v[28:31], v[88:91], a[140:143]
    ds_read_b64_tr_b16 v[24:25], v5 offset:1024
    v_mfma_f32_16x16x32_bf16 a[136:139], v[28:31], v[80:83], a[136:139]
    ds_read_b64_tr_b16 v[26:27], v5 offset:9216
    v_mfma_f32_16x16x32_bf16 v[140:143], v[28:31], v[72:75], v[140:143]
    v_mfma_f32_16x16x32_bf16 v[136:139], v[28:31], v[64:67], v[136:139]
    s_waitcnt lgkmcnt(6)
    v_mfma_f32_16x16x32_bf16 v[144:147], v[32:35], v[64:67], v[144:147]
    ds_read_b64_tr_b16 v[28:29], v6 offset:1024
    v_mfma_f32_16x16x32_bf16 v[148:151], v[32:35], v[72:75], v[148:151]
    s_add_u32 m0, s32, 33664
    ds_read_b64_tr_b16 v[30:31], v6 offset:9216
    v_mfma_f32_16x16x32_bf16 a[144:147], v[32:35], v[80:83], a[144:147]
    buffer_load_dwordx4 v8, s[8:11], s33 offen offset:128 nt lds
    v_mfma_f32_16x16x32_bf16 a[148:151], v[32:35], v[88:91], a[148:151]
    s_waitcnt lgkmcnt(6)
    v_mfma_f32_16x16x32_bf16 a[156:159], v[36:39], v[88:91], a[156:159]
    ds_read_b64_tr_b16 v[32:33], v7 offset:1024
    v_max3_f32 v11, v96, v97, v98
    v_max3_f32 v11, v11, v99, v104
    v_max3_f32 v11, v11, v105, v106
    v_max3_f32 v11, v11, v107, v112
    v_max3_f32 v11, v11, v113, v114
    v_max3_f32 v11, v11, v115, v120
    v_max3_f32 v11, v11, v121, v122
    v_max3_f32 v11, v11, v123, v100
    v_max3_f32 v11, v11, v101, v102
    v_max3_f32 v11, v11, v103, v108
    v_max3_f32 v11, v11, v109, v110
    v_max3_f32 v11, v11, v111, v116
    v_max3_f32 v11, v11, v117, v118
    v_max3_f32 v11, v11, v119, v124
    v_max3_f32 v11, v11, v125, v126
    v_max3_f32 v11, v11, v127, v127
    v_cmp_lt_f32 vcc, 0x41200000, v11
    v_mfma_f32_16x16x32_bf16 a[152:155], v[36:39], v[80:83], a[152:155]
    s_add_u32 m0, s32, 34560
    ds_read_b64_tr_b16 v[34:35], v7 offset:9216
    v_mfma_f32_16x16x32_bf16 v[156:159], v[36:39], v[72:75], v[156:159]
    buffer_load_dwordx4 v8, s[8:11], s33 offen offset:256 nt lds
    v_mfma_f32_16x16x32_bf16 v[152:155], v[36:39], v[64:67], v[152:155]
    s_waitcnt lgkmcnt(6)
    v_mfma_f32_16x16x32_bf16 v[160:163], v[40:43], v[64:67], v[160:163]
    ds_read_b64_tr_b16 v[36:37], v4 offset:2048
    v_mfma_f32_16x16x32_bf16 v[164:167], v[40:43], v[72:75], v[164:167]
    ds_read_b64_tr_b16 v[38:39], v4 offset:10240
    v_mfma_f32_16x16x32_bf16 a[160:163], v[40:43], v[80:83], a[160:163]
    v_mfma_f32_16x16x32_bf16 a[164:167], v[40:43], v[88:91], a[164:167]
    s_waitcnt lgkmcnt(6)
    s_cbranch_vccnz L_tr2
L_ret2:
    v_mfma_f32_16x16x32_bf16 a[172:175], v[24:27], v[88:91], a[172:175]
    ds_read_b64_tr_b16 v[40:41], v5 offset:2048
    v_exp_f32 v96, v96
    s_nop 0
    v_add_f32 v12, v12, v96
    v_exp_f32 v97, v97
    v_exp_f32 v98, v98
    v_add_f32 v12, v12, v97
    v_cvt_pk_bf16_f32 v96, v96, v97
    v_exp_f32 v99, v99
    v_mfma_f32_16x16x32_bf16 a[168:171], v[24:27], v[80:83], a[168:171]
    s_add_u32 m0, s32, 35456
    ds_read_b64_tr_b16 v[42:43], v5 offset:10240
    v_mfma_f32_16x16x32_bf16 v[172:175], v[24:27], v[72:75], v[172:175]
    buffer_load_dwordx4 v8, s[8:11], s33 offen offset:384 nt lds
    v_mfma_f32_16x16x32_bf16 v[168:171], v[24:27], v[64:67], v[168:171]
    s_waitcnt lgkmcnt(6)
    v_mfma_f32_16x16x32_bf16 v[176:179], v[28:31], v[64:67], v[176:179]
    ds_read_b64_tr_b16 v[24:25], v6 offset:2048
    v_mfma_f32_16x16x32_bf16 v[180:183], v[28:31], v[72:75], v[180:183]
    s_add_u32 m0, s32, 36864
    ds_read_b64_tr_b16 v[26:27], v6 offset:10240
    v_mfma_f32_16x16x32_bf16 a[176:179], v[28:31], v[80:83], a[176:179]
    buffer_load_dwordx4 v9, s[8:11], s33 offen offset:0 nt lds
    v_mfma_f32_16x16x32_bf16 a[180:183], v[28:31], v[88:91], a[180:183]
    s_waitcnt lgkmcnt(6)
    v_mfma_f32_16x16x32_bf16 a[188:191], v[32:35], v[88:91], a[188:191]
    ds_read_b64_tr_b16 v[28:29], v7 offset:2048
    v_add_f32 v12, v12, v98
    v_add_f32 v12, v12, v99
    v_exp_f32 v100, v100
    v_cvt_pk_bf16_f32 v97, v98, v99
    v_add_f32 v12, v12, v100
    v_exp_f32 v101, v101
    s_nop 0
    v_add_f32 v12, v12, v101
    v_cvt_pk_bf16_f32 v98, v100, v101
    v_exp_f32 v102, v102
    v_mfma_f32_16x16x32_bf16 a[184:187], v[32:35], v[80:83], a[184:187]
    ds_read_b64_tr_b16 v[30:31], v7 offset:10240
    v_mfma_f32_16x16x32_bf16 v[188:191], v[32:35], v[72:75], v[188:191]
    v_mfma_f32_16x16x32_bf16 v[184:187], v[32:35], v[64:67], v[184:187]
    s_waitcnt lgkmcnt(6)
    v_mfma_f32_16x16x32_bf16 v[192:195], v[36:39], v[64:67], v[192:195]
    ds_read_b64_tr_b16 v[32:33], v4 offset:3072
    v_mfma_f32_16x16x32_bf16 v[196:199], v[36:39], v[72:75], v[196:199]
    s_add_u32 m0, s32, 37760
    ds_read_b64_tr_b16 v[34:35], v4 offset:11264
    v_mfma_f32_16x16x32_bf16 a[192:195], v[36:39], v[80:83], a[192:195]
    buffer_load_dwordx4 v9, s[8:11], s33 offen offset:128 nt lds
    v_mfma_f32_16x16x32_bf16 a[196:199], v[36:39], v[88:91], a[196:199]
    s_waitcnt lgkmcnt(6)
    v_mfma_f32_16x16x32_bf16 a[204:207], v[40:43], v[88:91], a[204:207]
    ds_read_b64_tr_b16 v[36:37], v5 offset:3072
    v_add_f32 v12, v12, v102
    v_exp_f32 v103, v103
    s_nop 0
    v_add_f32 v12, v12, v103
    v_cvt_pk_bf16_f32 v99, v102, v103
    v_exp_f32 v104, v104
    v_exp_f32 v105, v105
    v_add_f32 v13, v13, v104
    v_mfma_f32_16x16x32_bf16 a[200:203], v[40:43], v[80:83], a[200:203]
    s_add_u32 m0, s32, 38656
    ds_read_b64_tr_b16 v[38:39], v5 offset:11264
    v_mfma_f32_16x16x32_bf16 v[204:207], v[40:43], v[72:75], v[204:207]
    buffer_load_dwordx4 v9, s[8:11], s33 offen offset:256 nt lds
    v_mfma_f32_16x16x32_bf16 v[200:203], v[40:43], v[64:67], v[200:203]
    s_waitcnt lgkmcnt(6)
    v_mfma_f32_16x16x32_bf16 v[208:211], v[24:27], v[64:67], v[208:211]
    ds_read_b64_tr_b16 v[40:41], v6 offset:3072
    v_mfma_f32_16x16x32_bf16 v[212:215], v[24:27], v[72:75], v[212:215]
    ds_read_b64_tr_b16 v[42:43], v6 offset:11264
    v_mfma_f32_16x16x32_bf16 a[208:211], v[24:27], v[80:83], a[208:211]
    ds_read_b64_tr_b16 v[44:45], v7 offset:3072
    v_mfma_f32_16x16x32_bf16 a[212:215], v[24:27], v[88:91], a[212:215]
    s_waitcnt lgkmcnt(7)
    s_add_u32 m0, s32, 39552
    ds_read_b64_tr_b16 v[46:47], v7 offset:11264
    v_mfma_f32_16x16x32_bf16 a[220:223], v[28:31], v[88:91], a[220:223]
    buffer_load_dwordx4 v9, s[8:11], s33 offen offset:384 nt lds
    v_add_f32 v13, v13, v105
    v_exp_f32 v106, v106
    v_cvt_pk_bf16_f32 v104, v104, v105
    v_add_f32 v13, v13, v106
    v_exp_f32 v107, v107
    s_nop 0
    v_add_f32 v13, v13, v107
    v_cvt_pk_bf16_f32 v105, v106, v107
    v_exp_f32 v108, v108
    v_mfma_f32_16x16x32_bf16 a[216:219], v[28:31], v[80:83], a[216:219]
    v_mfma_f32_16x16x32_bf16 v[220:223], v[28:31], v[72:75], v[220:223]
    v_mfma_f32_16x16x32_bf16 v[216:219], v[28:31], v[64:67], v[216:219]
    s_waitcnt lgkmcnt(6)
    v_mfma_f32_16x16x32_bf16 v[224:227], v[32:35], v[64:67], v[224:227]
    v_mfma_f32_16x16x32_bf16 v[228:231], v[32:35], v[72:75], v[228:231]
    v_mfma_f32_16x16x32_bf16 a[224:227], v[32:35], v[80:83], a[224:227]
    v_mfma_f32_16x16x32_bf16 a[228:231], v[32:35], v[88:91], a[228:231]
    s_waitcnt lgkmcnt(4)
    v_mfma_f32_16x16x32_bf16 a[236:239], v[36:39], v[88:91], a[236:239]
    s_waitcnt vmcnt(16) lgkmcnt(0)
    s_barrier
    v_exp_f32 v109, v109
    v_add_f32 v13, v13, v108
    v_add_f32 v13, v13, v109
    v_cvt_pk_bf16_f32 v106, v108, v109
    v_exp_f32 v110, v110
    s_nop 0
    v_add_f32 v13, v13, v110
    v_exp_f32 v111, v111
    s_nop 0
    v_add_f32 v13, v13, v111
    v_mfma_f32_16x16x32_bf16 a[232:235], v[36:39], v[80:83], a[232:235]
    ds_read_b128 v[24:27], v2 offset:0
    v_mfma_f32_16x16x32_bf16 v[236:239], v[36:39], v[72:75], v[236:239]
    v_mfma_f32_16x16x32_bf16 v[232:235], v[36:39], v[64:67], v[232:235]
    ds_read_b128 v[28:31], v3 offset:0
    v_mfma_f32_16x16x32_bf16 v[240:243], v[40:43], v[64:67], v[240:243]
    v_mfma_f32_16x16x32_bf16 v[244:247], v[40:43], v[72:75], v[244:247]
    ds_read_b128 v[32:35], v2 offset:1024
    v_mfma_f32_16x16x32_bf16 a[240:243], v[40:43], v[80:83], a[240:243]
    v_mfma_f32_16x16x32_bf16 a[244:247], v[40:43], v[88:91], a[244:247]
    v_mfma_f32_16x16x32_bf16 a[252:255], v[44:47], v[88:91], a[252:255]
    ds_read_b128 v[36:39], v3 offset:1024
    v_cvt_pk_bf16_f32 v107, v110, v111
    v_exp_f32 v112, v112
    s_nop 0
    v_add_f32 v14, v14, v112
    v_exp_f32 v113, v113
    s_nop 0
    v_add_f32 v14, v14, v113
    v_cvt_pk_bf16_f32 v112, v112, v113
    v_exp_f32 v114, v114
    v_mfma_f32_16x16x32_bf16 a[248:251], v[44:47], v[80:83], a[248:251]
    v_mfma_f32_16x16x32_bf16 v[252:255], v[44:47], v[72:75], v[252:255]
    s_add_u32 s36, s36, 1
    v_mfma_f32_16x16x32_bf16 v[248:251], v[44:47], v[64:67], v[248:251]
    s_waitcnt lgkmcnt(2)
    v_mfma_f32_16x16x32_bf16 v[64:67], v[24:27], a[0:3], v[48:51]
    s_add_u32 s34, s34, 8192
    s_add_u32 s35, s35, 8192
    ds_read_b128 v[40:43], v2 offset:2048
    v_mfma_f32_16x16x32_bf16 v[72:75], v[24:27], a[32:35], v[52:55]
    s_add_u32 m0, s32, 65536
    v_mfma_f32_16x16x32_bf16 v[80:83], v[24:27], a[64:67], v[56:59]
    buffer_load_dwordx4 v10, s[12:15], s34 offen offset:0 nt lds
    v_mfma_f32_16x16x32_bf16 v[88:91], v[24:27], a[96:99], v[60:63]
    v_mfma_f32_16x16x32_bf16 v[88:91], v[28:31], a[100:103], v[88:91]
    ds_read_b128 v[24:27], v3 offset:2048
    v_add_f32 v14, v14, v114
    v_exp_f32 v115, v115
    v_exp_f32 v116, v116
    v_add_f32 v14, v14, v115
    v_cvt_pk_bf16_f32 v113, v114, v115
    v_mfma_f32_16x16x32_bf16 v[80:83], v[28:31], a[68:71], v[80:83]
    v_mfma_f32_16x16x32_bf16 v[72:75], v[28:31], a[36:39], v[72:75]
    v_mfma_f32_16x16x32_bf16 v[64:67], v[28:31], a[4:7], v[64:67]
    s_waitcnt lgkmcnt(3)
    v_mfma_f32_16x16x32_bf16 v[64:67], v[32:35], a[8:11], v[64:67]
    s_add_u32 m0, s32, 66432
    ds_read_b128 v[28:31], v2 offset:3072
    v_mfma_f32_16x16x32_bf16 v[72:75], v[32:35], a[40:43], v[72:75]
    buffer_load_dwordx4 v10, s[12:15], s34 offen offset:128 nt lds
    v_mfma_f32_16x16x32_bf16 v[80:83], v[32:35], a[72:75], v[80:83]
    v_mfma_f32_16x16x32_bf16 v[88:91], v[32:35], a[104:107], v[88:91]
    s_waitcnt lgkmcnt(3)
    v_mfma_f32_16x16x32_bf16 v[88:91], v[36:39], a[108:111], v[88:91]
    ds_read_b128 v[32:35], v3 offset:3072
    v_add_f32 v14, v14, v116
    v_exp_f32 v117, v117
    s_nop 0
    v_add_f32 v14, v14, v117
    v_cvt_pk_bf16_f32 v114, v116, v117
    v_exp_f32 v118, v118
    v_mfma_f32_16x16x32_bf16 v[80:83], v[36:39], a[76:79], v[80:83]
    s_add_u32 m0, s32, 67328
    v_mfma_f32_16x16x32_bf16 v[72:75], v[36:39], a[44:47], v[72:75]
    buffer_load_dwordx4 v10, s[12:15], s34 offen offset:256 nt lds
    v_mfma_f32_16x16x32_bf16 v[64:67], v[36:39], a[12:15], v[64:67]
    s_waitcnt lgkmcnt(3)
    v_mfma_f32_16x16x32_bf16 v[64:67], v[40:43], a[16:19], v[64:67]
    ds_read_b128 v[36:39], v2 offset:8192
    v_mfma_f32_16x16x32_bf16 v[72:75], v[40:43], a[48:51], v[72:75]
    v_mfma_f32_16x16x32_bf16 v[80:83], v[40:43], a[80:83], v[80:83]
    v_mfma_f32_16x16x32_bf16 v[88:91], v[40:43], a[112:115], v[88:91]
    s_waitcnt lgkmcnt(3)
    v_mfma_f32_16x16x32_bf16 v[88:91], v[24:27], a[116:119], v[88:91]
    s_add_u32 m0, s32, 68224
    ds_read_b128 v[40:43], v3 offset:8192
    v_add_f32 v14, v14, v118
    v_exp_f32 v119, v119
    s_nop 0
    v_add_f32 v14, v14, v119
    v_cvt_pk_bf16_f32 v115, v118, v119
    v_exp_f32 v120, v120
    v_mfma_f32_16x16x32_bf16 v[80:83], v[24:27], a[84:87], v[80:83]
    buffer_load_dwordx4 v10, s[12:15], s34 offen offset:384 nt lds
    v_mfma_f32_16x16x32_bf16 v[72:75], v[24:27], a[52:55], v[72:75]
    v_mfma_f32_16x16x32_bf16 v[64:67], v[24:27], a[20:23], v[64:67]
    s_waitcnt lgkmcnt(3)
    v_mfma_f32_16x16x32_bf16 v[64:67], v[28:31], a[24:27], v[64:67]
    ds_read_b128 v[24:27], v2 offset:9216
    v_mfma_f32_16x16x32_bf16 v[72:75], v[28:31], a[56:59], v[72:75]
    s_add_u32 m0, s32, 69632
    v_mfma_f32_16x16x32_bf16 v[80:83], v[28:31], a[88:91], v[80:83]
    buffer_load_dwordx4 v10, s[12:15], s35 offen offset:0 nt lds
    v_mfma_f32_16x16x32_bf16 v[88:91], v[28:31], a[120:123], v[88:91]
    s_waitcnt lgkmcnt(3)
    v_mfma_f32_16x16x32_bf16 v[88:91], v[32:35], a[124:127], v[88:91]
    ds_read_b128 v[28:31], v3 offset:9216
    v_add_f32 v15, v15, v120
    v_exp_f32 v121, v121
    s_nop 0
    v_add_f32 v15, v15, v121
    v_cvt_pk_bf16_f32 v120, v120, v121
    v_exp_f32 v122, v122
    v_mfma_f32_16x16x32_bf16 v[80:83], v[32:35], a[92:95], v[80:83]
    v_mfma_f32_16x16x32_bf16 v[72:75], v[32:35], a[60:63], v[72:75]
    v_mfma_f32_16x16x32_bf16 v[64:67], v[32:35], a[28:31], v[64:67]
    s_waitcnt lgkmcnt(3)
    v_mfma_f32_16x16x32_bf16 v[68:71], v[36:39], a[0:3], v[48:51]
    s_add_u32 m0, s32, 70528
    ds_read_b128 v[32:35], v2 offset:10240
    v_mfma_f32_16x16x32_bf16 v[76:79], v[36:39], a[32:35], v[52:55]
    buffer_load_dwordx4 v10, s[12:15], s35 offen offset:128 nt lds
    v_mfma_f32_16x16x32_bf16 v[84:87], v[36:39], a[64:67], v[56:59]
    v_mfma_f32_16x16x32_bf16 v[92:95], v[36:39], a[96:99], v[60:63]
    s_waitcnt lgkmcnt(3)
    v_mfma_f32_16x16x32_bf16 v[92:95], v[40:43], a[100:103], v[92:95]
    ds_read_b128 v[36:39], v3 offset:10240
    v_add_f32 v15, v15, v122
    v_exp_f32 v123, v123
    v_exp_f32 v124, v124
    v_exp_f32 v125, v125
    v_mfma_f32_16x16x32_bf16 v[84:87], v[40:43], a[68:71], v[84:87]
    s_add_u32 m0, s32, 71424
    v_mfma_f32_16x16x32_bf16 v[76:79], v[40:43], a[36:39], v[76:79]
    buffer_load_dwordx4 v10, s[12:15], s35 offen offset:256 nt lds
    v_mfma_f32_16x16x32_bf16 v[68:71], v[40:43], a[4:7], v[68:71]
    s_waitcnt lgkmcnt(3)
    v_mfma_f32_16x16x32_bf16 v[68:71], v[24:27], a[8:11], v[68:71]
    ds_read_b128 v[40:43], v2 offset:11264
    v_mfma_f32_16x16x32_bf16 v[76:79], v[24:27], a[40:43], v[76:79]
    v_mfma_f32_16x16x32_bf16 v[84:87], v[24:27], a[72:75], v[84:87]
    ds_read_b128 v[44:47], v3 offset:11264
    v_mfma_f32_16x16x32_bf16 v[92:95], v[24:27], a[104:107], v[92:95]
    s_waitcnt lgkmcnt(4)
    s_add_u32 m0, s32, 72320
    v_mfma_f32_16x16x32_bf16 v[92:95], v[28:31], a[108:111], v[92:95]
    buffer_load_dwordx4 v10, s[12:15], s35 offen offset:384 nt lds
    v_add_f32 v15, v15, v123
    v_cvt_pk_bf16_f32 v121, v122, v123
    v_add_f32 v15, v15, v124
    v_add_f32 v15, v15, v125
    v_exp_f32 v126, v126
    v_mfma_f32_16x16x32_bf16 v[84:87], v[28:31], a[76:79], v[84:87]
    v_mfma_f32_16x16x32_bf16 v[76:79], v[28:31], a[44:47], v[76:79]
    v_mfma_f32_16x16x32_bf16 v[68:71], v[28:31], a[12:15], v[68:71]
    s_waitcnt lgkmcnt(3)
    v_mfma_f32_16x16x32_bf16 v[68:71], v[32:35], a[16:19], v[68:71]
    v_mfma_f32_16x16x32_bf16 v[76:79], v[32:35], a[48:51], v[76:79]
    v_mfma_f32_16x16x32_bf16 v[84:87], v[32:35], a[80:83], v[84:87]
    v_mfma_f32_16x16x32_bf16 v[92:95], v[32:35], a[112:115], v[92:95]
    s_waitcnt lgkmcnt(2)
    v_mfma_f32_16x16x32_bf16 v[92:95], v[36:39], a[116:119], v[92:95]
    s_waitcnt vmcnt(16) lgkmcnt(0)
    s_barrier
    v_cvt_pk_bf16_f32 v122, v124, v125
    v_add_f32 v15, v15, v126
    v_exp_f32 v127, v127
    s_nop 0
    v_add_f32 v15, v15, v127
    v_cvt_pk_bf16_f32 v123, v126, v127
    v_mfma_f32_16x16x32_bf16 v[84:87], v[36:39], a[84:87], v[84:87]
    ds_read_b64_tr_b16 v[24:25], v4 offset:32768
    v_mfma_f32_16x16x32_bf16 v[76:79], v[36:39], a[52:55], v[76:79]
    ds_read_b64_tr_b16 v[26:27], v4 offset:40960
    v_mfma_f32_16x16x32_bf16 v[68:71], v[36:39], a[20:23], v[68:71]
    ds_read_b64_tr_b16 v[28:29], v5 offset:32768
    v_mfma_f32_16x16x32_bf16 v[68:71], v[40:43], a[24:27], v[68:71]
    ds_read_b64_tr_b16 v[30:31], v5 offset:40960
    v_mfma_f32_16x16x32_bf16 v[76:79], v[40:43], a[56:59], v[76:79]
    ds_read_b64_tr_b16 v[32:33], v6 offset:32768
    v_mfma_f32_16x16x32_bf16 v[84:87], v[40:43], a[88:91], v[84:87]
    ds_read_b64_tr_b16 v[34:35], v6 offset:40960
    v_mfma_f32_16x16x32_bf16 v[92:95], v[40:43], a[120:123], v[92:95]
    v_mfma_f32_16x16x32_bf16 v[92:95], v[44:47], a[124:127], v[92:95]
    ds_read_b64_tr_b16 v[36:37], v7 offset:32768
    v_mfma_f32_16x16x32_bf16 v[84:87], v[44:47], a[92:95], v[84:87]
    ds_read_b64_tr_b16 v[38:39], v7 offset:40960
    v_mfma_f32_16x16x32_bf16 v[76:79], v[44:47], a[60:63], v[76:79]
    v_mfma_f32_16x16x32_bf16 v[68:71], v[44:47], a[28:31], v[68:71]
    s_waitcnt lgkmcnt(4)
    v_mfma_f32_16x16x32_bf16 v[128:131], v[24:27], v[96:99], v[128:131]
    s_add_u32 s33, s33, 8192
    ds_read_b64_tr_b16 v[40:41], v4 offset:33792
    v_mfma_f32_16x16x32_bf16 v[132:135], v[24:27], v[104:107], v[132:135]
    s_add_u32 m0, s32, 0
    ds_read_b64_tr_b16 v[42:43], v4 offset:41984
    v_mfma_f32_16x16x32_bf16 a[128:131], v[24:27], v[112:115], a[128:131]
    buffer_load_dwordx4 v8, s[8:11], s33 offen offset:0 nt lds
    v_mfma_f32_16x16x32_bf16 a[132:135], v[24:27], v[120:123], a[132:135]
    v_mfma_f32_16x16x32_bf16 a[140:143], v[28:31], v[120:123], a[140:143]
    ds_read_b64_tr_b16 v[24:25], v5 offset:33792
    v_mfma_f32_16x16x32_bf16 a[136:139], v[28:31], v[112:115], a[136:139]
    ds_read_b64_tr_b16 v[26:27], v5 offset:41984
    v_mfma_f32_16x16x32_bf16 v[140:143], v[28:31], v[104:107], v[140:143]
    v_mfma_f32_16x16x32_bf16 v[136:139], v[28:31], v[96:99], v[136:139]
    s_waitcnt lgkmcnt(6)
    v_mfma_f32_16x16x32_bf16 v[144:147], v[32:35], v[96:99], v[144:147]
    ds_read_b64_tr_b16 v[28:29], v6 offset:33792
    v_mfma_f32_16x16x32_bf16 v[148:151], v[32:35], v[104:107], v[148:151]
    s_add_u32 m0, s32, 896
    ds_read_b64_tr_b16 v[30:31], v6 offset:41984
    v_mfma_f32_16x16x32_bf16 a[144:147], v[32:35], v[112:115], a[144:147]
    buffer_load_dwordx4 v8, s[8:11], s33 offen offset:128 nt lds
    v_mfma_f32_16x16x32_bf16 a[148:151], v[32:35], v[120:123], a[148:151]
    s_waitcnt lgkmcnt(6)
    v_mfma_f32_16x16x32_bf16 a[156:159], v[36:39], v[120:123], a[156:159]
    ds_read_b64_tr_b16 v[32:33], v7 offset:33792
    v_max3_f32 v11, v64, v65, v66
    v_max3_f32 v11, v11, v67, v72
    v_max3_f32 v11, v11, v73, v74
    v_max3_f32 v11, v11, v75, v80
    v_max3_f32 v11, v11, v81, v82
    v_max3_f32 v11, v11, v83, v88
    v_max3_f32 v11, v11, v89, v90
    v_max3_f32 v11, v11, v91, v68
    v_max3_f32 v11, v11, v69, v70
    v_max3_f32 v11, v11, v71, v76
    v_max3_f32 v11, v11, v77, v78
    v_max3_f32 v11, v11, v79, v84
    v_max3_f32 v11, v11, v85, v86
    v_max3_f32 v11, v11, v87, v92
    v_max3_f32 v11, v11, v93, v94
    v_max3_f32 v11, v11, v95, v95
    v_cmp_lt_f32 vcc, 0x41200000, v11
    v_mfma_f32_16x16x32_bf16 a[152:155], v[36:39], v[112:115], a[152:155]
    s_add_u32 m0, s32, 1792
    ds_read_b64_tr_b16 v[34:35], v7 offset:41984
    v_mfma_f32_16x16x32_bf16 v[156:159], v[36:39], v[104:107], v[156:159]
    buffer_load_dwordx4 v8, s[8:11], s33 offen offset:256 nt lds
    v_mfma_f32_16x16x32_bf16 v[152:155], v[36:39], v[96:99], v[152:155]
    s_waitcnt lgkmcnt(6)
    v_mfma_f32_16x16x32_bf16 v[160:163], v[40:43], v[96:99], v[160:163]
    ds_read_b64_tr_b16 v[36:37], v4 offset:34816
    v_mfma_f32_16x16x32_bf16 v[164:167], v[40:43], v[104:107], v[164:167]
    ds_read_b64_tr_b16 v[38:39], v4 offset:43008
    v_mfma_f32_16x16x32_bf16 a[160:163], v[40:43], v[112:115], a[160:163]
    v_mfma_f32_16x16x32_bf16 a[164:167], v[40:43], v[120:123], a[164:167]
    s_waitcnt lgkmcnt(6)
    s_cbranch_vccnz L_tr3
L_ret3:
    v_mfma_f32_16x16x32_bf16 a[172:175], v[24:27], v[120:123], a[172:175]
    ds_read_b64_tr_b16 v[40:41], v5 offset:34816
    v_exp_f32 v64, v64
    s_nop 0
    v_add_f32 v12, v12, v64
    v_exp_f32 v65, v65
    v_exp_f32 v66, v66
    v_add_f32 v12, v12, v65
    v_cvt_pk_bf16_f32 v64, v64, v65
    v_exp_f32 v67, v67
    v_mfma_f32_16x16x32_bf16 a[168:171], v[24:27], v[112:115], a[168:171]
    s_add_u32 m0, s32, 2688
    ds_read_b64_tr_b16 v[42:43], v5 offset:43008
    v_mfma_f32_16x16x32_bf16 v[172:175], v[24:27], v[104:107], v[172:175]
    buffer_load_dwordx4 v8, s[8:11], s33 offen offset:384 nt lds
    v_mfma_f32_16x16x32_bf16 v[168:171], v[24:27], v[96:99], v[168:171]
    s_waitcnt lgkmcnt(6)
    v_mfma_f32_16x16x32_bf16 v[176:179], v[28:31], v[96:99], v[176:179]
    ds_read_b64_tr_b16 v[24:25], v6 offset:34816
    v_mfma_f32_16x16x32_bf16 v[180:183], v[28:31], v[104:107], v[180:183]
    s_add_u32 m0, s32, 4096
    ds_read_b64_tr_b16 v[26:27], v6 offset:43008
    v_mfma_f32_16x16x32_bf16 a[176:179], v[28:31], v[112:115], a[176:179]
    buffer_load_dwordx4 v9, s[8:11], s33 offen offset:0 nt lds
    v_mfma_f32_16x16x32_bf16 a[180:183], v[28:31], v[120:123], a[180:183]
    s_waitcnt lgkmcnt(6)
    v_mfma_f32_16x16x32_bf16 a[188:191], v[32:35], v[120:123], a[188:191]
    ds_read_b64_tr_b16 v[28:29], v7 offset:34816
    v_add_f32 v12, v12, v66
    v_add_f32 v12, v12, v67
    v_exp_f32 v68, v68
    v_cvt_pk_bf16_f32 v65, v66, v67
    v_add_f32 v12, v12, v68
    v_exp_f32 v69, v69
    s_nop 0
    v_add_f32 v12, v12, v69
    v_cvt_pk_bf16_f32 v66, v68, v69
    v_mfma_f32_16x16x32_bf16 a[184:187], v[32:35], v[112:115], a[184:187]
    ds_read_b64_tr_b16 v[30:31], v7 offset:43008
    v_mfma_f32_16x16x32_bf16 v[188:191], v[32:35], v[104:107], v[188:191]
    v_mfma_f32_16x16x32_bf16 v[184:187], v[32:35], v[96:99], v[184:187]
    s_waitcnt lgkmcnt(6)
    v_mfma_f32_16x16x32_bf16 v[192:195], v[36:39], v[96:99], v[192:195]
    ds_read_b64_tr_b16 v[32:33], v4 offset:35840
    v_mfma_f32_16x16x32_bf16 v[196:199], v[36:39], v[104:107], v[196:199]
    s_add_u32 m0, s32, 4992
    ds_read_b64_tr_b16 v[34:35], v4 offset:44032
    v_mfma_f32_16x16x32_bf16 a[192:195], v[36:39], v[112:115], a[192:195]
    buffer_load_dwordx4 v9, s[8:11], s33 offen offset:128 nt lds
    v_mfma_f32_16x16x32_bf16 a[196:199], v[36:39], v[120:123], a[196:199]
    s_waitcnt lgkmcnt(6)
    v_mfma_f32_16x16x32_bf16 a[204:207], v[40:43], v[120:123], a[204:207]
    ds_read_b64_tr_b16 v[36:37], v5 offset:35840
    v_exp_f32 v70, v70
    s_nop 0
    v_add_f32 v12, v12, v70
    v_exp_f32 v71, v71
    s_nop 0
    v_add_f32 v12, v12, v71
    v_cvt_pk_bf16_f32 v67, v70, v71
    v_exp_f32 v72, v72
    v_exp_f32 v73, v73
    v_mfma_f32_16x16x32_bf16 a[200:203], v[40:43], v[112:115], a[200:203]
    s_add_u32 m0, s32, 5888
    ds_read_b64_tr_b16 v[38:39], v5 offset:44032
    v_mfma_f32_16x16x32_bf16 v[204:207], v[40:43], v[104:107], v[204:207]
    buffer_load_dwordx4 v9, s[8:11], s33 offen offset:256 nt lds
    v_mfma_f32_16x16x32_bf16 v[200:203], v[40:43], v[96:99], v[200:203]
    s_waitcnt lgkmcnt(6)
    v_mfma_f32_16x16x32_bf16 v[208:211], v[24:27], v[96:99], v[208:211]
    ds_read_b64_tr_b16 v[40:41], v6 offset:35840
    v_mfma_f32_16x16x32_bf16 v[212:215], v[24:27], v[104:107], v[212:215]
    ds_read_b64_tr_b16 v[42:43], v6 offset:44032
    v_mfma_f32_16x16x32_bf16 a[208:211], v[24:27], v[112:115], a[208:211]
    ds_read_b64_tr_b16 v[44:45], v7 offset:35840
    v_mfma_f32_16x16x32_bf16 a[212:215], v[24:27], v[120:123], a[212:215]
    s_waitcnt lgkmcnt(7)
    s_add_u32 m0, s32, 6784
    ds_read_b64_tr_b16 v[46:47], v7 offset:44032
    v_mfma_f32_16x16x32_bf16 a[220:223], v[28:31], v[120:123], a[220:223]
    buffer_load_dwordx4 v9, s[8:11], s33 offen offset:384 nt lds
    v_add_f32 v13, v13, v72
    v_add_f32 v13, v13, v73
    v_exp_f32 v74, v74
    v_cvt_pk_bf16_f32 v72, v72, v73
    v_add_f32 v13, v13, v74
    v_exp_f32 v75, v75
    s_nop 0
    v_add_f32 v13, v13, v75
    v_cvt_pk_bf16_f32 v73, v74, v75
    v_mfma_f32_16x16x32_bf16 a[216:219], v[28:31], v[112:115], a[216:219]
    v_mfma_f32_16x16x32_bf16 v[220:223], v[28:31], v[104:107], v[220:223]
    v_mfma_f32_16x16x32_bf16 v[216:219], v[28:31], v[96:99], v[216:219]
    s_waitcnt lgkmcnt(6)
    v_mfma_f32_16x16x32_bf16 v[224:227], v[32:35], v[96:99], v[224:227]
    v_mfma_f32_16x16x32_bf16 v[228:231], v[32:35], v[104:107], v[228:231]
    v_mfma_f32_16x16x32_bf16 a[224:227], v[32:35], v[112:115], a[224:227]
    v_mfma_f32_16x16x32_bf16 a[228:231], v[32:35], v[120:123], a[228:231]
    s_waitcnt lgkmcnt(4)
    v_mfma_f32_16x16x32_bf16 a[236:239], v[36:39], v[120:123], a[236:239]
    s_waitcnt vmcnt(16) lgkmcnt(0)
    s_barrier
    v_exp_f32 v76, v76
    v_exp_f32 v77, v77
    v_add_f32 v13, v13, v76
    v_add_f32 v13, v13, v77
    v_cvt_pk_bf16_f32 v74, v76, v77
    v_exp_f32 v78, v78
    s_nop 0
    v_add_f32 v13, v13, v78
    v_exp_f32 v79, v79
    v_mfma_f32_16x16x32_bf16 a[232:235], v[36:39], v[112:115], a[232:235]
    ds_read_b128 v[24:27], v2 offset:32768
    v_mfma_f32_16x16x32_bf16 v[236:239], v[36:39], v[104:107], v[236:239]
    v_mfma_f32_16x16x32_bf16 v[232:235], v[36:39], v[96:99], v[232:235]
    ds_read_b128 v[28:31], v3 offset:32768
    v_mfma_f32_16x16x32_bf16 v[240:243], v[40:43], v[96:99], v[240:243]
    v_mfma_f32_16x16x32_bf16 v[244:247], v[40:43], v[104:107], v[244:247]
    ds_read_b128 v[32:35], v2 offset:33792
    v_mfma_f32_16x16x32_bf16 a[240:243], v[40:43], v[112:115], a[240:243]
    v_mfma_f32_16x16x32_bf16 a[244:247], v[40:43], v[120:123], a[244:247]
    v_mfma_f32_16x16x32_bf16 a[252:255], v[44:47], v[120:123], a[252:255]
    ds_read_b128 v[36:39], v3 offset:33792
    v_add_f32 v13, v13, v79
    v_cvt_pk_bf16_f32 v75, v78, v79
    v_exp_f32 v80, v80
    s_nop 0
    v_add_f32 v14, v14, v80
    v_exp_f32 v81, v81
    s_nop 0
    v_add_f32 v14, v14, v81
    v_cvt_pk_bf16_f32 v80, v80, v81
    v_mfma_f32_16x16x32_bf16 a[248:251], v[44:47], v[112:115], a[248:251]
    v_mfma_f32_16x16x32_bf16 v[252:255], v[44:47], v[104:107], v[252:255]
    v_mfma_f32_16x16x32_bf16 v[248:251], v[44:47], v[96:99], v[248:251]
    s_waitcnt lgkmcnt(2)
    s_cmp_lt_u32 s36, s17
    s_cbranch_scc1 L_ramp1
    .p2align 6
L_loop:
    v_mfma_f32_16x16x32_bf16 v[96:99], v[24:27], a[0:3], v[48:51]
    s_add_u32 s34, s34, 8192
    s_add_u32 s35, s35, 8192
    ds_read_b128 v[40:43], v2 offset:34816
    v_mfma_f32_16x16x32_bf16 v[96:99], v[28:31], a[4:7], v[96:99]
    s_waitcnt lgkmcnt(1)
    s_add_u32 m0, s32, 98304
    ds_read_b128 v[44:47], v3 offset:34816
    v_mfma_f32_16x16x32_bf16 v[96:99], v[32:35], a[8:11], v[96:99]
    buffer_load_dwordx4 v10, s[12:15], s34 offen offset:0 nt lds
    v_mfma_f32_16x16x32_bf16 v[96:99], v[36:39], a[12:15], v[96:99]
    ds_read_b128 v[16:19], v2 offset:35840
    v_mfma_f32_16x16x32_bf16 v[104:107], v[36:39], a[44:47], v[52:55]
    ds_read_b128 v[20:23], v3 offset:35840
    v_mfma_f32_16x16x32_bf16 v[104:107], v[32:35], a[40:43], v[104:107]
    v_exp_f32 v82, v82
    v_mfma_f32_16x16x32_bf16 v[104:107], v[28:31], a[36:39], v[104:107]
    v_exp_f32 v83, v83
    v_mfma_f32_16x16x32_bf16 v[104:107], v[24:27], a[32:35], v[104:107]
    s_add_u32 m0, s32, 99200
    v_exp_f32 v84, v84
    v_mfma_f32_16x16x32_bf16 v[112:115], v[24:27], a[64:67], v[56:59]
    buffer_load_dwordx4 v10, s[12:15], s34 offen offset:128 nt lds
    v_mfma_f32_16x16x32_bf16 v[112:115], v[28:31], a[68:71], v[112:115]
    v_add_f32 v14, v14, v82
    v_add_f32 v14, v14, v83
    v_mfma_f32_16x16x32_bf16 v[112:115], v[32:35], a[72:75], v[112:115]
    v_exp_f32 v85, v85
    v_mfma_f32_16x16x32_bf16 v[112:115], v[36:39], a[76:79], v[112:115]
    v_cvt_pk_bf16_f32 v81, v82, v83
    v_add_f32 v14, v14, v84
    v_mfma_f32_16x16x32_bf16 v[120:123], v[36:39], a[108:111], v[60:63]
    v_add_f32 v14, v14, v85
    v_cvt_pk_bf16_f32 v82, v84, v85
    v_mfma_f32_16x16x32_bf16 v[120:123], v[32:35], a[104:107], v[120:123]
    s_add_u32 m0, s32, 100096
    v_mfma_f32_16x16x32_bf16 v[120:123], v[28:31], a[100:103], v[120:123]
    buffer_load_dwordx4 v10, s[12:15], s34 offen offset:256 nt lds
    v_mfma_f32_16x16x32_bf16 v[120:123], v[24:27], a[96:99], v[120:123]
    s_waitcnt lgkmcnt(0)
    v_exp_f32 v86, v86
    v_mfma_f32_16x16x32_bf16 v[120:123], v[40:43], a[112:115], v[120:123]
    ds_read_b128 v[24:27], v2 offset:40960
    v_add_f32 v14, v14, v86
    v_mfma_f32_16x16x32_bf16 v[120:123], v[44:47], a[116:119], v[120:123]
    ds_read_b128 v[28:31], v3 offset:40960
    v_mfma_f32_16x16x32_bf16 v[120:123], v[16:19], a[120:123], v[120:123]
    v_exp_f32 v87, v87
    v_mfma_f32_16x16x32_bf16 v[120:123], v[20:23], a[124:127], v[120:123]
    ds_read_b128 v[32:35], v2 offset:41984
    v_add_f32 v14, v14, v87
    v_mfma_f32_16x16x32_bf16 v[112:115], v[20:23], a[92:95], v[112:115]
    s_add_u32 m0, s32, 100992
    ds_read_b128 v[36:39], v3 offset:41984
    v_cvt_pk_bf16_f32 v83, v86, v87
    v_mfma_f32_16x16x32_bf16 v[112:115], v[16:19], a[88:91], v[112:115]
    buffer_load_dwordx4 v10, s[12:15], s34 offen offset:384 nt lds
    v_mfma_f32_16x16x32_bf16 v[112:115], v[44:47], a[84:87], v[112:115]
    v_exp_f32 v88, v88
    v_mfma_f32_16x16x32_bf16 v[112:115], v[40:43], a[80:83], v[112:115]
    v_add_f32 v15, v15, v88
    v_mfma_f32_16x16x32_bf16 v[104:107], v[40:43], a[48:51], v[104:107]
    v_mfma_f32_16x16x32_bf16 v[104:107], v[44:47], a[52:55], v[104:107]
    s_add_u32 m0, s32, 102400
    v_exp_f32 v89, v89
    v_mfma_f32_16x16x32_bf16 v[104:107], v[16:19], a[56:59], v[104:107]
    buffer_load_dwordx4 v10, s[12:15], s35 offen offset:0 nt lds
    v_mfma_f32_16x16x32_bf16 v[104:107], v[20:23], a[60:63], v[104:107]
    v_add_f32 v15, v15, v89
    v_cvt_pk_bf16_f32 v88, v88, v89
    v_mfma_f32_16x16x32_bf16 v[96:99], v[20:23], a[28:31], v[96:99]
    v_exp_f32 v90, v90
    v_mfma_f32_16x16x32_bf16 v[96:99], v[16:19], a[24:27], v[96:99]
    v_add_f32 v15, v15, v90
    v_mfma_f32_16x16x32_bf16 v[96:99], v[44:47], a[20:23], v[96:99]
    v_mfma_f32_16x16x32_bf16 v[96:99], v[40:43], a[16:19], v[96:99]
    s_waitcnt lgkmcnt(0)
    v_mfma_f32_16x16x32_bf16 v[100:103], v[24:27], a[0:3], v[48:51]
    ds_read_b128 v[40:43], v2 offset:43008
    v_mfma_f32_16x16x32_bf16 v[100:103], v[28:31], a[4:7], v[100:103]
    s_add_u32 m0, s32, 103296
    ds_read_b128 v[44:47], v3 offset:43008
    v_mfma_f32_16x16x32_bf16 v[100:103], v[32:35], a[8:11], v[100:103]
    buffer_load_dwordx4 v10, s[12:15], s35 offen offset:128 nt lds
    v_mfma_f32_16x16x32_bf16 v[100:103], v[36:39], a[12:15], v[100:103]
    ds_read_b128 v[16:19], v2 offset:44032
    v_mfma_f32_16x16x32_bf16 v[108:111], v[36:39], a[44:47], v[52:55]
    ds_read_b128 v[20:23], v3 offset:44032
    v_mfma_f32_16x16x32_bf16 v[108:111], v[32:35], a[40:43], v[108:111]
    s_add_u32 m0, s32, 104192
    v_exp_f32 v91, v91
    v_mfma_f32_16x16x32_bf16 v[108:111], v[28:31], a[36:39], v[108:111]
    buffer_load_dwordx4 v10, s[12:15], s35 offen offset:256 nt lds
    v_mfma_f32_16x16x32_bf16 v[108:111], v[24:27], a[32:35], v[108:111]
    v_exp_f32 v92, v92
    v_mfma_f32_16x16x32_bf16 v[116:119], v[24:27], a[64:67], v[56:59]
    v_exp_f32 v93, v93
    v_mfma_f32_16x16x32_bf16 v[116:119], v[28:31], a[68:71], v[116:119]
    v_add_f32 v15, v15, v91
    v_cvt_pk_bf16_f32 v89, v90, v91
    v_mfma_f32_16x16x32_bf16 v[116:119], v[32:35], a[72:75], v[116:119]
    v_add_f32 v15, v15, v92
    v_add_f32 v15, v15, v93
    v_mfma_f32_16x16x32_bf16 v[116:119], v[36:39], a[76:79], v[116:119]
    s_add_u32 m0, s32, 105088
    v_exp_f32 v94, v94
    v_mfma_f32_16x16x32_bf16 v[124:127], v[36:39], a[108:111], v[60:63]
    buffer_load_dwordx4 v10, s[12:15], s35 offen offset:384 nt lds
    v_mfma_f32_16x16x32_bf16 v[124:127], v[32:35], a[104:107], v[124:127]
    v_cvt_pk_bf16_f32 v90, v92, v93
    v_add_f32 v15, v15, v94
    v_mfma_f32_16x16x32_bf16 v[124:127], v[28:31], a[100:103], v[124:127]
    v_exp_f32 v95, v95
    v_mfma_f32_16x16x32_bf16 v[124:127], v[24:27], a[96:99], v[124:127]
    s_waitcnt lgkmcnt(0)
    v_add_f32 v15, v15, v95
    v_cvt_pk_bf16_f32 v91, v94, v95
    v_mfma_f32_16x16x32_bf16 v[124:127], v[40:43], a[112:115], v[124:127]
    v_mfma_f32_16x16x32_bf16 v[124:127], v[44:47], a[116:119], v[124:127]
    v_mfma_f32_16x16x32_bf16 v[124:127], v[16:19], a[120:123], v[124:127]
    v_mfma_f32_16x16x32_bf16 v[124:127], v[20:23], a[124:127], v[124:127]
    v_mfma_f32_16x16x32_bf16 v[116:119], v[20:23], a[92:95], v[116:119]
    s_waitcnt vmcnt(16) lgkmcnt(0)
    s_barrier
    v_mfma_f32_16x16x32_bf16 v[116:119], v[16:19], a[88:91], v[116:119]
    ds_read_b64_tr_b16 v[24:25], v4 offset:0
    v_mfma_f32_16x16x32_bf16 v[116:119], v[44:47], a[84:87], v[116:119]
    ds_read_b64_tr_b16 v[26:27], v4 offset:8192
    v_mfma_f32_16x16x32_bf16 v[116:119], v[40:43], a[80:83], v[116:119]
    ds_read_b64_tr_b16 v[28:29], v5 offset:0
    v_mfma_f32_16x16x32_bf16 v[108:111], v[40:43], a[48:51], v[108:111]
    ds_read_b64_tr_b16 v[30:31], v5 offset:8192
    v_mfma_f32_16x16x32_bf16 v[108:111], v[44:47], a[52:55], v[108:111]
    ds_read_b64_tr_b16 v[32:33], v6 offset:0
    v_mfma_f32_16x16x32_bf16 v[108:111], v[16:19], a[56:59], v[108:111]
    ds_read_b64_tr_b16 v[34:35], v6 offset:8192
    v_mfma_f32_16x16x32_bf16 v[108:111], v[20:23], a[60:63], v[108:111]
    v_mfma_f32_16x16x32_bf16 v[100:103], v[20:23], a[28:31], v[100:103]
    ds_read_b64_tr_b16 v[36:37], v7 offset:0
    v_mfma_f32_16x16x32_bf16 v[100:103], v[16:19], a[24:27], v[100:103]
    ds_read_b64_tr_b16 v[38:39], v7 offset:8192
    v_mfma_f32_16x16x32_bf16 v[100:103], v[44:47], a[20:23], v[100:103]
    v_mfma_f32_16x16x32_bf16 v[100:103], v[40:43], a[16:19], v[100:103]
    s_waitcnt lgkmcnt(4)
    s_cmp_eq_u32 s36, 15
    s_cbranch_scc1 L_tail
    v_mfma_f32_16x16x32_bf16 v[128:131], v[24:27], v[64:67], v[128:131]
    s_add_u32 s33, s33, 8192
    ds_read_b64_tr_b16 v[40:41], v4 offset:1024
    v_mfma_f32_16x16x32_bf16 v[136:139], v[28:31], v[64:67], v[136:139]
    s_add_u32 m0, s32, 32768
    ds_read_b64_tr_b16 v[42:43], v4 offset:9216
    v_mfma_f32_16x16x32_bf16 v[140:143], v[28:31], v[72:75], v[140:143]
    buffer_load_dwordx4 v8, s[8:11], s33 offen offset:0 nt lds
    v_mfma_f32_16x16x32_bf16 v[132:135], v[24:27], v[72:75], v[132:135]
    v_exp_f32 v96, v96
    v_mfma_f32_16x16x32_bf16 a[128:131], v[24:27], v[80:83], a[128:131]
    ds_read_b64_tr_b16 v[44:45], v5 offset:1024
    v_add_f32 v12, v12, v96
    v_mfma_f32_16x16x32_bf16 a[136:139], v[28:31], v[80:83], a[136:139]
    ds_read_b64_tr_b16 v[46:47], v5 offset:9216
    v_mfma_f32_16x16x32_bf16 a[140:143], v[28:31], v[88:91], a[140:143]
    v_exp_f32 v97, v97
    v_mfma_f32_16x16x32_bf16 a[132:135], v[24:27], v[88:91], a[132:135]
    s_waitcnt lgkmcnt(4)
    v_exp_f32 v98, v98
    v_mfma_f32_16x16x32_bf16 a[148:151], v[32:35], v[88:91], a[148:151]
    ds_read_b64_tr_b16 v[16:17], v6 offset:1024
    v_add_f32 v12, v12, v97
    v_mfma_f32_16x16x32_bf16 a[156:159], v[36:39], v[88:91], a[156:159]
    s_add_u32 m0, s32, 33664
    ds_read_b64_tr_b16 v[18:19], v6 offset:9216
    v_cvt_pk_bf16_f32 v96, v96, v97
    v_mfma_f32_16x16x32_bf16 a[152:155], v[36:39], v[80:83], a[152:155]
    buffer_load_dwordx4 v8, s[8:11], s33 offen offset:128 nt lds
    v_mfma_f32_16x16x32_bf16 a[144:147], v[32:35], v[80:83], a[144:147]
    v_exp_f32 v99, v99
    v_mfma_f32_16x16x32_bf16 v[148:151], v[32:35], v[72:75], v[148:151]
    ds_read_b64_tr_b16 v[20:21], v7 offset:1024
    v_add_f32 v12, v12, v98
    v_mfma_f32_16x16x32_bf16 v[156:159], v[36:39], v[72:75], v[156:159]
    s_add_u32 m0, s32, 34560
    ds_read_b64_tr_b16 v[22:23], v7 offset:9216
    v_add_f32 v12, v12, v99
    v_mfma_f32_16x16x32_bf16 v[152:155], v[36:39], v[64:67], v[152:155]
    buffer_load_dwordx4 v8, s[8:11], s33 offen offset:256 nt lds
    v_mfma_f32_16x16x32_bf16 v[144:147], v[32:35], v[64:67], v[144:147]
    s_waitcnt lgkmcnt(4)
    v_exp_f32 v100, v100
    v_mfma_f32_16x16x32_bf16 v[160:163], v[40:43], v[64:67], v[160:163]
    ds_read_b64_tr_b16 v[24:25], v4 offset:2048
    v_cvt_pk_bf16_f32 v97, v98, v99
    v_mfma_f32_16x16x32_bf16 v[168:171], v[44:47], v[64:67], v[168:171]
    ds_read_b64_tr_b16 v[26:27], v4 offset:10240
    v_add_f32 v12, v12, v100
    v_mfma_f32_16x16x32_bf16 v[172:175], v[44:47], v[72:75], v[172:175]
    v_exp_f32 v101, v101
    v_mfma_f32_16x16x32_bf16 v[164:167], v[40:43], v[72:75], v[164:167]
    v_add_f32 v12, v12, v101
    v_cvt_pk_bf16_f32 v98, v100, v101
    v_mfma_f32_16x16x32_bf16 a[160:163], v[40:43], v[80:83], a[160:163]
    ds_read_b64_tr_b16 v[28:29], v5 offset:2048
    v_mfma_f32_16x16x32_bf16 a[168:171], v[44:47], v[80:83], a[168:171]
    s_add_u32 m0, s32, 35456
    ds_read_b64_tr_b16 v[30:31], v5 offset:10240
    v_mfma_f32_16x16x32_bf16 a[172:175], v[44:47], v[88:91], a[172:175]
    buffer_load_dwordx4 v8, s[8:11], s33 offen offset:384 nt lds
    v_mfma_f32_16x16x32_bf16 a[164:167], v[40:43], v[88:91], a[164:167]
    s_waitcnt lgkmcnt(4)
    v_exp_f32 v102, v102
    v_mfma_f32_16x16x32_bf16 a[180:183], v[16:19], v[88:91], a[180:183]
    ds_read_b64_tr_b16 v[32:33], v6 offset:2048
    v_add_f32 v12, v12, v102
    v_mfma_f32_16x16x32_bf16 a[188:191], v[20:23], v[88:91], a[188:191]
    s_add_u32 m0, s32, 36864
    ds_read_b64_tr_b16 v[34:35], v6 offset:10240
    v_mfma_f32_16x16x32_bf16 a[184:187], v[20:23], v[80:83], a[184:187]
    buffer_load_dwordx4 v9, s[8:11], s33 offen offset:0 nt lds
    v_mfma_f32_16x16x32_bf16 a[176:179], v[16:19], v[80:83], a[176:179]
    v_exp_f32 v103, v103
    v_mfma_f32_16x16x32_bf16 v[180:183], v[16:19], v[72:75], v[180:183]
    ds_read_b64_tr_b16 v[36:37], v7 offset:2048
    v_add_f32 v12, v12, v103
    v_mfma_f32_16x16x32_bf16 v[188:191], v[20:23], v[72:75], v[188:191]
    ds_read_b64_tr_b16 v[38:39], v7 offset:10240
    v_cvt_pk_bf16_f32 v99, v102, v103
    v_mfma_f32_16x16x32_bf16 v[184:187], v[20:23], v[64:67], v[184:187]
    v_exp_f32 v104, v104
    v_mfma_f32_16x16x32_bf16 v[176:179], v[16:19], v[64:67], v[176:179]
    s_waitcnt lgkmcnt(4)
    v_exp_f32 v105, v105
    v_mfma_f32_16x16x32_bf16 v[192:195], v[24:27], v[64:67], v[192:195]
    ds_read_b64_tr_b16 v[40:41], v4 offset:3072
    v_add_f32 v13, v13, v104
    v_mfma_f32_16x16x32_bf16 v[200:203], v[28:31], v[64:67], v[200:203]
    s_add_u32 m0, s32, 37760
    ds_read_b64_tr_b16 v[42:43], v4 offset:11264
    v_add_f32 v13, v13, v105
    v_mfma_f32_16x16x32_bf16 v[204:207], v[28:31], v[72:75], v[204:207]
    buffer_load_dwordx4 v9, s[8:11], s33 offen offset:128 nt lds
    v_mfma_f32_16x16x32_bf16 v[196:199], v[24:27], v[72:75], v[196:199]
    v_exp_f32 v106, v106
    v_mfma_f32_16x16x32_bf16 a[192:195], v[24:27], v[80:83], a[192:195]
    ds_read_b64_tr_b16 v[44:45], v5 offset:3072
    v_cvt_pk_bf16_f32 v104, v104, v105
    v_mfma_f32_16x16x32_bf16 a[200:203], v[28:31], v[80:83], a[200:203]
    s_add_u32 m0, s32, 38656
    ds_read_b64_tr_b16 v[46:47], v5 offset:11264
    v_add_f32 v13, v13, v106
    v_mfma_f32_16x16x32_bf16 a[204:207], v[28:31], v[88:91], a[204:207]
    buffer_load_dwordx4 v9, s[8:11], s33 offen offset:256 nt lds
    v_mfma_f32_16x16x32_bf16 a[196:199], v[24:27], v[88:91], a[196:199]
    s_waitcnt lgkmcnt(4)
    v_exp_f32 v107, v107
    v_mfma_f32_16x16x32_bf16 a[212:215], v[32:35], v[88:91], a[212:215]
    ds_read_b64_tr_b16 v[16:17], v6 offset:3072
    v_add_f32 v13, v13, v107
    v_mfma_f32_16x16x32_bf16 a[220:223], v[36:39], v[88:91], a[220:223]
    ds_read_b64_tr_b16 v[18:19], v6 offset:11264
    v_cvt_pk_bf16_f32 v105, v106, v107
    v_mfma_f32_16x16x32_bf16 a[216:219], v[36:39], v[80:83], a[216:219]
    ds_read_b64_tr_b16 v[20:21], v7 offset:3072
    v_mfma_f32_16x16x32_bf16 a[208:211], v[32:35], v[80:83], a[208:211]
    s_add_u32 m0, s32, 39552
    ds_read_b64_tr_b16 v[22:23], v7 offset:11264
    v_mfma_f32_16x16x32_bf16 v[212:215], v[32:35], v[72:75], v[212:215]
    buffer_load_dwordx4 v9, s[8:11], s33 offen offset:384 nt lds
    v_mfma_f32_16x16x32_bf16 v[220:223], v[36:39], v[72:75], v[220:223]
    v_exp_f32 v108, v108
    v_mfma_f32_16x16x32_bf16 v[216:219], v[36:39], v[64:67], v[216:219]
    v_exp_f32 v109, v109
    v_mfma_f32_16x16x32_bf16 v[208:211], v[32:35], v[64:67], v[208:211]
    s_waitcnt lgkmcnt(4)
    v_add_f32 v13, v13, v108
    v_add_f32 v13, v13, v109
    v_mfma_f32_16x16x32_bf16 v[224:227], v[40:43], v[64:67], v[224:227]
    v_cvt_pk_bf16_f32 v106, v108, v109
    v_mfma_f32_16x16x32_bf16 v[232:235], v[44:47], v[64:67], v[232:235]
    v_exp_f32 v110, v110
    v_mfma_f32_16x16x32_bf16 v[236:239], v[44:47], v[72:75], v[236:239]
    v_add_f32 v13, v13, v110
    v_mfma_f32_16x16x32_bf16 v[228:231], v[40:43], v[72:75], v[228:231]
    v_mfma_f32_16x16x32_bf16 a[224:227], v[40:43], v[80:83], a[224:227]
    s_waitcnt vmcnt(16) lgkmcnt(0)
    s_barrier
    v_mfma_f32_16x16x32_bf16 a[232:235], v[44:47], v[80:83], a[232:235]
    ds_read_b128 v[24:27], v2 offset:0
    v_mfma_f32_16x16x32_bf16 a[236:239], v[44:47], v[88:91], a[236:239]
    ds_read_b128 v[28:31], v3 offset:0
    v_mfma_f32_16x16x32_bf16 a[228:231], v[40:43], v[88:91], a[228:231]
    v_exp_f32 v111, v111
    v_mfma_f32_16x16x32_bf16 a[244:247], v[16:19], v[88:91], a[244:247]
    ds_read_b128 v[32:35], v2 offset:1024
    v_add_f32 v13, v13, v111
    v_mfma_f32_16x16x32_bf16 a[252:255], v[20:23], v[88:91], a[252:255]
    ds_read_b128 v[36:39], v3 offset:1024
    v_cvt_pk_bf16_f32 v107, v110, v111
    v_mfma_f32_16x16x32_bf16 a[248:251], v[20:23], v[80:83], a[248:251]
    v_exp_f32 v112, v112
    v_mfma_f32_16x16x32_bf16 a[240:243], v[16:19], v[80:83], a[240:243]
    v_add_f32 v14, v14, v112
    v_mfma_f32_16x16x32_bf16 v[244:247], v[16:19], v[72:75], v[244:247]
    v_exp_f32 v113, v113
    v_mfma_f32_16x16x32_bf16 v[252:255], v[20:23], v[72:75], v[252:255]
    v_add_f32 v14, v14, v113
    v_cvt_pk_bf16_f32 v112, v112, v113
    v_mfma_f32_16x16x32_bf16 v[248:251], v[20:23], v[64:67], v[248:251]
    s_add_u32 s36, s36, 1
    v_mfma_f32_16x16x32_bf16 v[240:243], v[16:19], v[64:67], v[240:243]
    s_waitcnt lgkmcnt(2)
    v_exp_f32 v114, v114
    v_mfma_f32_16x16x32_bf16 v[64:67], v[24:27], a[0:3], v[48:51]
    s_add_u32 s34, s34, 8192
    s_add_u32 s35, s35, 8192
    ds_read_b128 v[40:43], v2 offset:2048
    v_mfma_f32_16x16x32_bf16 v[64:67], v[28:31], a[4:7], v[64:67]
    s_waitcnt lgkmcnt(1)
    s_add_u32 m0, s32, 65536
    ds_read_b128 v[44:47], v3 offset:2048
    v_mfma_f32_16x16x32_bf16 v[64:67], v[32:35], a[8:11], v[64:67]
    buffer_load_dwordx4 v10, s[12:15], s34 offen offset:0 nt lds
    v_mfma_f32_16x16x32_bf16 v[64:67], v[36:39], a[12:15], v[64:67]
    ds_read_b128 v[16:19], v2 offset:3072
    v_add_f32 v14, v14, v114
    v_mfma_f32_16x16x32_bf16 v[72:75], v[36:39], a[44:47], v[52:55]
    ds_read_b128 v[20:23], v3 offset:3072
    v_mfma_f32_16x16x32_bf16 v[72:75], v[32:35], a[40:43], v[72:75]
    v_exp_f32 v115, v115
    v_mfma_f32_16x16x32_bf16 v[72:75], v[28:31], a[36:39], v[72:75]
    v_exp_f32 v116, v116
    v_mfma_f32_16x16x32_bf16 v[72:75], v[24:27], a[32:35], v[72:75]
    s_add_u32 m0, s32, 66432
    v_add_f32 v14, v14, v115
    v_cvt_pk_bf16_f32 v113, v114, v115
    v_mfma_f32_16x16x32_bf16 v[80:83], v[24:27], a[64:67], v[56:59]
    buffer_load_dwordx4 v10, s[12:15], s34 offen offset:128 nt lds
    v_mfma_f32_16x16x32_bf16 v[80:83], v[28:31], a[68:71], v[80:83]
    v_add_f32 v14, v14, v116
    v_mfma_f32_16x16x32_bf16 v[80:83], v[32:35], a[72:75], v[80:83]
    v_exp_f32 v117, v117
    v_mfma_f32_16x16x32_bf16 v[80:83], v[36:39], a[76:79], v[80:83]
    v_add_f32 v14, v14, v117
    v_cvt_pk_bf16_f32 v114, v116, v117
    v_mfma_f32_16x16x32_bf16 v[88:91], v[36:39], a[108:111], v[60:63]
    v_mfma_f32_16x16x32_bf16 v[88:91], v[32:35], a[104:107], v[88:91]
    s_add_u32 m0, s32, 67328
    v_mfma_f32_16x16x32_bf16 v[88:91], v[28:31], a[100:103], v[88:91]
    buffer_load_dwordx4 v10, s[12:15], s34 offen offset:256 nt lds
    v_mfma_f32_16x16x32_bf16 v[88:91], v[24:27], a[96:99], v[88:91]
    s_waitcnt lgkmcnt(0)
    v_exp_f32 v118, v118
    v_mfma_f32_16x16x32_bf16 v[88:91], v[40:43], a[112:115], v[88:91]
    ds_read_b128 v[24:27], v2 offset:8192
    v_add_f32 v14, v14, v118
    v_mfma_f32_16x16x32_bf16 v[88:91], v[44:47], a[116:119], v[88:91]
    ds_read_b128 v[28:31], v3 offset:8192
    v_mfma_f32_16x16x32_bf16 v[88:91], v[16:19], a[120:123], v[88:91]
    v_exp_f32 v119, v119
    v_mfma_f32_16x16x32_bf16 v[88:91], v[20:23], a[124:127], v[88:91]
    ds_read_b128 v[32:35], v2 offset:9216
    v_add_f32 v14, v14, v119
    v_mfma_f32_16x16x32_bf16 v[80:83], v[20:23], a[92:95], v[80:83]
    s_add_u32 m0, s32, 68224
    ds_read_b128 v[36:39], v3 offset:9216
    v_cvt_pk_bf16_f32 v115, v118, v119
    v_mfma_f32_16x16x32_bf16 v[80:83], v[16:19], a[88:91], v[80:83]
    buffer_load_dwordx4 v10, s[12:15], s34 offen offset:384 nt lds
    v_mfma_f32_16x16x32_bf16 v[80:83], v[44:47], a[84:87], v[80:83]
    v_exp_f32 v120, v120
    v_mfma_f32_16x16x32_bf16 v[80:83], v[40:43], a[80:83], v[80:83]
    v_add_f32 v15, v15, v120
    v_mfma_f32_16x16x32_bf16 v[72:75], v[40:43], a[48:51], v[72:75]
    v_mfma_f32_16x16x32_bf16 v[72:75], v[44:47], a[52:55], v[72:75]
    s_add_u32 m0, s32, 69632
    v_exp_f32 v121, v121
    v_mfma_f32_16x16x32_bf16 v[72:75], v[16:19], a[56:59], v[72:75]
    buffer_load_dwordx4 v10, s[12:15], s35 offen offset:0 nt lds
    v_mfma_f32_16x16x32_bf16 v[72:75], v[20:23], a[60:63], v[72:75]
    v_add_f32 v15, v15, v121
    v_cvt_pk_bf16_f32 v120, v120, v121
    v_mfma_f32_16x16x32_bf16 v[64:67], v[20:23], a[28:31], v[64:67]
    v_exp_f32 v122, v122
    v_mfma_f32_16x16x32_bf16 v[64:67], v[16:19], a[24:27], v[64:67]
    v_add_f32 v15, v15, v122
    v_mfma_f32_16x16x32_bf16 v[64:67], v[44:47], a[20:23], v[64:67]
    v_mfma_f32_16x16x32_bf16 v[64:67], v[40:43], a[16:19], v[64:67]
    s_waitcnt lgkmcnt(0)
    v_mfma_f32_16x16x32_bf16 v[68:71], v[24:27], a[0:3], v[48:51]
    ds_read_b128 v[40:43], v2 offset:10240
    v_mfma_f32_16x16x32_bf16 v[68:71], v[28:31], a[4:7], v[68:71]
    s_add_u32 m0, s32, 70528
    ds_read_b128 v[44:47], v3 offset:10240
    v_mfma_f32_16x16x32_bf16 v[68:71], v[32:35], a[8:11], v[68:71]
    buffer_load_dwordx4 v10, s[12:15], s35 offen offset:128 nt lds
    v_mfma_f32_16x16x32_bf16 v[68:71], v[36:39], a[12:15], v[68:71]
    ds_read_b128 v[16:19], v2 offset:11264
    v_mfma_f32_16x16x32_bf16 v[76:79], v[36:39], a[44:47], v[52:55]
    ds_read_b128 v[20:23], v3 offset:11264
    v_mfma_f32_16x16x32_bf16 v[76:79], v[32:35], a[40:43], v[76:79]
    s_add_u32 m0, s32, 71424
    v_exp_f32 v123, v123
    v_mfma_f32_16x16x32_bf16 v[76:79], v[28:31], a[36:39], v[76:79]
    buffer_load_dwordx4 v10, s[12:15], s35 offen offset:256 nt lds
    v_mfma_f32_16x16x32_bf16 v[76:79], v[24:27], a[32:35], v[76:79]
    v_exp_f32 v124, v124
    v_mfma_f32_16x16x32_bf16 v[84:87], v[24:27], a[64:67], v[56:59]
    v_exp_f32 v125, v125
    v_mfma_f32_16x16x32_bf16 v[84:87], v[28:31], a[68:71], v[84:87]
    v_add_f32 v15, v15, v123
    v_cvt_pk_bf16_f32 v121, v122, v123
    v_mfma_f32_16x16x32_bf16 v[84:87], v[32:35], a[72:75], v[84:87]
    v_add_f32 v15, v15, v124
    v_add_f32 v15, v15, v125
    v_mfma_f32_16x16x32_bf16 v[84:87], v[36:39], a[76:79], v[84:87]
    s_add_u32 m0, s32, 72320
    v_exp_f32 v126, v126
    v_mfma_f32_16x16x32_bf16 v[92:95], v[36:39], a[108:111], v[60:63]
    buffer_load_dwordx4 v10, s[12:15], s35 offen offset:384 nt lds
    v_mfma_f32_16x16x32_bf16 v[92:95], v[32:35], a[104:107], v[92:95]
    v_cvt_pk_bf16_f32 v122, v124, v125
    v_add_f32 v15, v15, v126
    v_mfma_f32_16x16x32_bf16 v[92:95], v[28:31], a[100:103], v[92:95]
    v_exp_f32 v127, v127
    v_mfma_f32_16x16x32_bf16 v[92:95], v[24:27], a[96:99], v[92:95]
    s_waitcnt lgkmcnt(0)
    v_add_f32 v15, v15, v127
    v_cvt_pk_bf16_f32 v123, v126, v127
    v_mfma_f32_16x16x32_bf16 v[92:95], v[40:43], a[112:115], v[92:95]
    v_mfma_f32_16x16x32_bf16 v[92:95], v[44:47], a[116:119], v[92:95]
    v_mfma_f32_16x16x32_bf16 v[92:95], v[16:19], a[120:123], v[92:95]
    v_mfma_f32_16x16x32_bf16 v[92:95], v[20:23], a[124:127], v[92:95]
    v_mfma_f32_16x16x32_bf16 v[84:87], v[20:23], a[92:95], v[84:87]
    s_waitcnt vmcnt(16) lgkmcnt(0)
    s_barrier
    v_mfma_f32_16x16x32_bf16 v[84:87], v[16:19], a[88:91], v[84:87]
    ds_read_b64_tr_b16 v[24:25], v4 offset:32768
    v_mfma_f32_16x16x32_bf16 v[84:87], v[44:47], a[84:87], v[84:87]
    ds_read_b64_tr_b16 v[26:27], v4 offset:40960
    v_mfma_f32_16x16x32_bf16 v[84:87], v[40:43], a[80:83], v[84:87]
    ds_read_b64_tr_b16 v[28:29], v5 offset:32768
    v_mfma_f32_16x16x32_bf16 v[76:79], v[40:43], a[48:51], v[76:79]
    ds_read_b64_tr_b16 v[30:31], v5 offset:40960
    v_mfma_f32_16x16x32_bf16 v[76:79], v[44:47], a[52:55], v[76:79]
    ds_read_b64_tr_b16 v[32:33], v6 offset:32768
    v_mfma_f32_16x16x32_bf16 v[76:79], v[16:19], a[56:59], v[76:79]
    ds_read_b64_tr_b16 v[34:35], v6 offset:40960
    v_mfma_f32_16x16x32_bf16 v[76:79], v[20:23], a[60:63], v[76:79]
    v_mfma_f32_16x16x32_bf16 v[68:71], v[20:23], a[28:31], v[68:71]
    ds_read_b64_tr_b16 v[36:37], v7 offset:32768
    v_mfma_f32_16x16x32_bf16 v[68:71], v[16:19], a[24:27], v[68:71]
    ds_read_b64_tr_b16 v[38:39], v7 offset:40960
    v_mfma_f32_16x16x32_bf16 v[68:71], v[44:47], a[20:23], v[68:71]
    v_mfma_f32_16x16x32_bf16 v[68:71], v[40:43], a[16:19], v[68:71]
    s_waitcnt lgkmcnt(4)
    v_mfma_f32_16x16x32_bf16 v[128:131], v[24:27], v[96:99], v[128:131]
    s_add_u32 s33, s33, 8192
    ds_read_b64_tr_b16 v[40:41], v4 offset:33792
    v_mfma_f32_16x16x32_bf16 v[136:139], v[28:31], v[96:99], v[136:139]
    s_add_u32 m0, s32, 0
    ds_read_b64_tr_b16 v[42:43], v4 offset:41984
    v_mfma_f32_16x16x32_bf16 v[140:143], v[28:31], v[104:107], v[140:143]
    buffer_load_dwordx4 v8, s[8:11], s33 offen offset:0 nt lds
    v_mfma_f32_16x16x32_bf16 v[132:135], v[24:27], v[104:107], v[132:135]
    v_exp_f32 v64, v64
    v_mfma_f32_16x16x32_bf16 a[128:131], v[24:27], v[112:115], a[128:131]
    ds_read_b64_tr_b16 v[44:45], v5 offset:33792
    v_add_f32 v12, v12, v64
    v_mfma_f32_16x16x32_bf16 a[136:139], v[28:31], v[112:115], a[136:139]
    ds_read_b64_tr_b16 v[46:47], v5 offset:41984
    v_mfma_f32_16x16x32_bf16 a[140:143], v[28:31], v[120:123], a[140:143]
    v_exp_f32 v65, v65
    v_mfma_f32_16x16x32_bf16 a[132:135], v[24:27], v[120:123], a[132:135]
    s_waitcnt lgkmcnt(4)
    v_exp_f32 v66, v66
    v_mfma_f32_16x16x32_bf16 a[148:151], v[32:35], v[120:123], a[148:151]
    ds_read_b64_tr_b16 v[16:17], v6 offset:33792
    v_add_f32 v12, v12, v65
    v_mfma_f32_16x16x32_bf16 a[156:159], v[36:39], v[120:123], a[156:159]
    s_add_u32 m0, s32, 896
    ds_read_b64_tr_b16 v[18:19], v6 offset:41984
    v_cvt_pk_bf16_f32 v64, v64, v65
    v_mfma_f32_16x16x32_bf16 a[152:155], v[36:39], v[112:115], a[152:155]
    buffer_load_dwordx4 v8, s[8:11], s33 offen offset:128 nt lds
    v_mfma_f32_16x16x32_bf16 a[144:147], v[32:35], v[112:115], a[144:147]
    v_exp_f32 v67, v67
    v_mfma_f32_16x16x32_bf16 v[148:151], v[32:35], v[104:107], v[148:151]
    ds_read_b64_tr_b16 v[20:21], v7 offset:33792
    v_add_f32 v12, v12, v66
    v_mfma_f32_16x16x32_bf16 v[156:159], v[36:39], v[104:107], v[156:159]
    s_add_u32 m0, s32, 1792
    ds_read_b64_tr_b16 v[22:23], v7 offset:41984
    v_add_f32 v12, v12, v67
    v_mfma_f32_16x16x32_bf16 v[152:155], v[36:39], v[96:99], v[152:155]
    buffer_load_dwordx4 v8, s[8:11], s33 offen offset:256 nt lds
    v_mfma_f32_16x16x32_bf16 v[144:147], v[32:35], v[96:99], v[144:147]
    s_waitcnt lgkmcnt(4)
    v_exp_f32 v68, v68
    v_mfma_f32_16x16x32_bf16 v[160:163], v[40:43], v[96:99], v[160:163]
    ds_read_b64_tr_b16 v[24:25], v4 offset:34816
    v_cvt_pk_bf16_f32 v65, v66, v67
    v_mfma_f32_16x16x32_bf16 v[168:171], v[44:47], v[96:99], v[168:171]
    ds_read_b64_tr_b16 v[26:27], v4 offset:43008
    v_add_f32 v12, v12, v68
    v_mfma_f32_16x16x32_bf16 v[172:175], v[44:47], v[104:107], v[172:175]
    v_exp_f32 v69, v69
    v_mfma_f32_16x16x32_bf16 v[164:167], v[40:43], v[104:107], v[164:167]
    v_add_f32 v12, v12, v69
    v_cvt_pk_bf16_f32 v66, v68, v69
    v_mfma_f32_16x16x32_bf16 a[160:163], v[40:43], v[112:115], a[160:163]
    ds_read_b64_tr_b16 v[28:29], v5 offset:34816
    v_mfma_f32_16x16x32_bf16 a[168:171], v[44:47], v[112:115], a[168:171]
    s_add_u32 m0, s32, 2688
    ds_read_b64_tr_b16 v[30:31], v5 offset:43008
    v_mfma_f32_16x16x32_bf16 a[172:175], v[44:47], v[120:123], a[172:175]
    buffer_load_dwordx4 v8, s[8:11], s33 offen offset:384 nt lds
    v_mfma_f32_16x16x32_bf16 a[164:167], v[40:43], v[120:123], a[164:167]
    s_waitcnt lgkmcnt(4)
    v_exp_f32 v70, v70
    v_mfma_f32_16x16x32_bf16 a[180:183], v[16:19], v[120:123], a[180:183]
    ds_read_b64_tr_b16 v[32:33], v6 offset:34816
    v_add_f32 v12, v12, v70
    v_mfma_f32_16x16x32_bf16 a[188:191], v[20:23], v[120:123], a[188:191]
    s_add_u32 m0, s32, 4096
    ds_read_b64_tr_b16 v[34:35], v6 offset:43008
    v_mfma_f32_16x16x32_bf16 a[184:187], v[20:23], v[112:115], a[184:187]
    buffer_load_dwordx4 v9, s[8:11], s33 offen offset:0 nt lds
    v_mfma_f32_16x16x32_bf16 a[176:179], v[16:19], v[112:115], a[176:179]
    v_exp_f32 v71, v71
    v_mfma_f32_16x16x32_bf16 v[180:183], v[16:19], v[104:107], v[180:183]
    ds_read_b64_tr_b16 v[36:37], v7 offset:34816
    v_add_f32 v12, v12, v71
    v_mfma_f32_16x16x32_bf16 v[188:191], v[20:23], v[104:107], v[188:191]
    ds_read_b64_tr_b16 v[38:39], v7 offset:43008
    v_cvt_pk_bf16_f32 v67, v70, v71
    v_mfma_f32_16x16x32_bf16 v[184:187], v[20:23], v[96:99], v[184:187]
    v_exp_f32 v72, v72
    v_mfma_f32_16x16x32_bf16 v[176:179], v[16:19], v[96:99], v[176:179]
    s_waitcnt lgkmcnt(4)
    v_exp_f32 v73, v73
    v_mfma_f32_16x16x32_bf16 v[192:195], v[24:27], v[96:99], v[192:195]
    ds_read_b64_tr_b16 v[40:41], v4 offset:35840
    v_add_f32 v13, v13, v72
    v_mfma_f32_16x16x32_bf16 v[200:203], v[28:31], v[96:99], v[200:203]
    s_add_u32 m0, s32, 4992
    ds_read_b64_tr_b16 v[42:43], v4 offset:44032
    v_add_f32 v13, v13, v73
    v_mfma_f32_16x16x32_bf16 v[204:207], v[28:31], v[104:107], v[204:207]
    buffer_load_dwordx4 v9, s[8:11], s33 offen offset:128 nt lds
    v_mfma_f32_16x16x32_bf16 v[196:199], v[24:27], v[104:107], v[196:199]
    v_exp_f32 v74, v74
    v_mfma_f32_16x16x32_bf16 a[192:195], v[24:27], v[112:115], a[192:195]
    ds_read_b64_tr_b16 v[44:45], v5 offset:35840
    v_cvt_pk_bf16_f32 v72, v72, v73
    v_mfma_f32_16x16x32_bf16 a[200:203], v[28:31], v[112:115], a[200:203]
    s_add_u32 m0, s32, 5888
    ds_read_b64_tr_b16 v[46:47], v5 offset:44032
    v_add_f32 v13, v13, v74
    v_mfma_f32_16x16x32_bf16 a[204:207], v[28:31], v[120:123], a[204:207]
    buffer_load_dwordx4 v9, s[8:11], s33 offen offset:256 nt lds
    v_mfma_f32_16x16x32_bf16 a[196:199], v[24:27], v[120:123], a[196:199]
    s_waitcnt lgkmcnt(4)
    v_exp_f32 v75, v75
    v_mfma_f32_16x16x32_bf16 a[212:215], v[32:35], v[120:123], a[212:215]
    ds_read_b64_tr_b16 v[16:17], v6 offset:35840
    v_add_f32 v13, v13, v75
    v_mfma_f32_16x16x32_bf16 a[220:223], v[36:39], v[120:123], a[220:223]
    ds_read_b64_tr_b16 v[18:19], v6 offset:44032
    v_cvt_pk_bf16_f32 v73, v74, v75
    v_mfma_f32_16x16x32_bf16 a[216:219], v[36:39], v[112:115], a[216:219]
    ds_read_b64_tr_b16 v[20:21], v7 offset:35840
    v_mfma_f32_16x16x32_bf16 a[208:211], v[32:35], v[112:115], a[208:211]
    s_add_u32 m0, s32, 6784
    ds_read_b64_tr_b16 v[22:23], v7 offset:44032
    v_mfma_f32_16x16x32_bf16 v[212:215], v[32:35], v[104:107], v[212:215]
    buffer_load_dwordx4 v9, s[8:11], s33 offen offset:384 nt lds
    v_mfma_f32_16x16x32_bf16 v[220:223], v[36:39], v[104:107], v[220:223]
    v_exp_f32 v76, v76
    v_mfma_f32_16x16x32_bf16 v[216:219], v[36:39], v[96:99], v[216:219]
    v_exp_f32 v77, v77
    v_mfma_f32_16x16x32_bf16 v[208:211], v[32:35], v[96:99], v[208:211]
    s_waitcnt lgkmcnt(4)
    v_add_f32 v13, v13, v76
    v_add_f32 v13, v13, v77
    v_mfma_f32_16x16x32_bf16 v[224:227], v[40:43], v[96:99], v[224:227]
    v_cvt_pk_bf16_f32 v74, v76, v77
    v_mfma_f32_16x16x32_bf16 v[232:235], v[44:47], v[96:99], v[232:235]
    v_exp_f32 v78, v78
    v_mfma_f32_16x16x32_bf16 v[236:239], v[44:47], v[104:107], v[236:239]
    v_add_f32 v13, v13, v78
    v_mfma_f32_16x16x32_bf16 v[228:231], v[40:43], v[104:107], v[228:231]
    v_mfma_f32_16x16x32_bf16 a[224:227], v[40:43], v[112:115], a[224:227]
    s_waitcnt vmcnt(16) lgkmcnt(0)
    s_barrier
    v_mfma_f32_16x16x32_bf16 a[232:235], v[44:47], v[112:115], a[232:235]
    ds_read_b128 v[24:27], v2 offset:32768
    v_mfma_f32_16x16x32_bf16 a[236:239], v[44:47], v[120:123], a[236:239]
    ds_read_b128 v[28:31], v3 offset:32768
    v_mfma_f32_16x16x32_bf16 a[228:231], v[40:43], v[120:123], a[228:231]
    v_exp_f32 v79, v79
    v_mfma_f32_16x16x32_bf16 a[244:247], v[16:19], v[120:123], a[244:247]
    ds_read_b128 v[32:35], v2 offset:33792
    v_add_f32 v13, v13, v79
    v_mfma_f32_16x16x32_bf16 a[252:255], v[20:23], v[120:123], a[252:255]
    ds_read_b128 v[36:39], v3 offset:33792
    v_cvt_pk_bf16_f32 v75, v78, v79
    v_mfma_f32_16x16x32_bf16 a[248:251], v[20:23], v[112:115], a[248:251]
    v_exp_f32 v80, v80
    v_mfma_f32_16x16x32_bf16 a[240:243], v[16:19], v[112:115], a[240:243]
    v_add_f32 v14, v14, v80
    v_mfma_f32_16x16x32_bf16 v[244:247], v[16:19], v[104:107], v[244:247]
    v_exp_f32 v81, v81
    v_mfma_f32_16x16x32_bf16 v[252:255], v[20:23], v[104:107], v[252:255]
    v_add_f32 v14, v14, v81
    v_cvt_pk_bf16_f32 v80, v80, v81
    v_mfma_f32_16x16x32_bf16 v[248:251], v[20:23], v[96:99], v[248:251]
    v_mfma_f32_16x16x32_bf16 v[240:243], v[16:19], v[96:99], v[240:243]
    s_waitcnt lgkmcnt(2)
    s_branch L_loop
L_tail:
    v_lshlrev_b32 v19, 7, v0
    v_and_b32 v20, 0xfff, v19
    v_lshrrev_b32 v19, 5, v0
    v_mul_u32_u24 v19, 229376, v19
    v_add_u32 v19, v19, v20
    buffer_load_dword a127, v19, s[24:27], s70 offen
    v_mfma_f32_16x16x32_bf16 v[128:131], v[24:27], v[64:67], v[128:131]
    v_mfma_f32_16x16x32_bf16 v[132:135], v[24:27], v[72:75], v[132:135]
    v_mfma_f32_16x16x32_bf16 a[128:131], v[24:27], v[80:83], a[128:131]
    ds_read_b64_tr_b16 v[40:41], v4 offset:1024
    ds_read_b64_tr_b16 v[42:43], v4 offset:9216
    v_mfma_f32_16x16x32_bf16 a[132:135], v[24:27], v[88:91], a[132:135]
    v_mfma_f32_16x16x32_bf16 a[140:143], v[28:31], v[88:91], a[140:143]
    v_mfma_f32_16x16x32_bf16 a[136:139], v[28:31], v[80:83], a[136:139]
    s_cmp_eq_u32 s101, 0
    s_cbranch_scc0 L_chk
L_retT:
    v_mfma_f32_16x16x32_bf16 v[140:143], v[28:31], v[72:75], v[140:143]
    ds_read_b64_tr_b16 v[24:25], v5 offset:1024
    ds_read_b64_tr_b16 v[26:27], v5 offset:9216
    v_mfma_f32_16x16x32_bf16 v[136:139], v[28:31], v[64:67], v[136:139]
    s_waitcnt lgkmcnt(6)
    v_exp_f32 v112, v112
    v_mfma_f32_16x16x32_bf16 v[144:147], v[32:35], v[64:67], v[144:147]
    v_exp_f32 v113, v113
    s_lshl_b32 s37, s3, 14
    s_add_u32 s39, s32, 65536
    v_lshlrev_b32 v1, 4, v0
    v_add_u32 v2, s37, v1
    v_add_u32 v3, s39, v1
    v_xor_b32 v8, 0x4000, v2
    v_xor_b32 v9, 0x2000, v3
    s_lshl_b32 s37, s3, 10
    s_add_u32 s37, s37, 131072
    v_add_u32 v11, s37, v1
    v_lshrrev_b32 v10, 3, v0
    v_and_b32 v16, 6, v10
    v_and_b32 v17, 7, v0
    v_mul_u32_u24 v10, 896, v10
    v_xor_b32 v16, v16, v17
    v_lshl_add_u32 v10, v16, 4, v10
    v_mfma_f32_16x16x32_bf16 v[148:151], v[32:35], v[72:75], v[148:151]
    v_exp_f32 v114, v114
    v_mfma_f32_16x16x32_bf16 a[144:147], v[32:35], v[80:83], a[144:147]
    ds_read_b64_tr_b16 v[28:29], v6 offset:1024
    ds_read_b64_tr_b16 v[30:31], v6 offset:9216
    v_mfma_f32_16x16x32_bf16 a[148:151], v[32:35], v[88:91], a[148:151]
    s_waitcnt lgkmcnt(6)
    v_exp_f32 v115, v115
    v_mfma_f32_16x16x32_bf16 a[156:159], v[36:39], v[88:91], a[156:159]
    v_add_f32 v14, v14, v112
    v_add_f32 v14, v14, v113
    v_mfma_f32_16x16x32_bf16 a[152:155], v[36:39], v[80:83], a[152:155]
    v_exp_f32 v116, v116
    v_mfma_f32_16x16x32_bf16 v[156:159], v[36:39], v[72:75], v[156:159]
    ds_read_b64_tr_b16 v[32:33], v7 offset:1024
    ds_read_b64_tr_b16 v[34:35], v7 offset:9216
    v_mfma_f32_16x16x32_bf16 v[152:155], v[36:39], v[64:67], v[152:155]
    s_waitcnt lgkmcnt(6)
    v_exp_f32 v117, v117
    v_mfma_f32_16x16x32_bf16 v[160:163], v[40:43], v[64:67], v[160:163]
    v_cvt_pk_bf16_f32 v112, v112, v113
    v_add_f32 v14, v14, v114
    v_mfma_f32_16x16x32_bf16 v[164:167], v[40:43], v[72:75], v[164:167]
    v_exp_f32 v118, v118
    v_mfma_f32_16x16x32_bf16 a[160:163], v[40:43], v[80:83], a[160:163]
    ds_read_b64_tr_b16 v[36:37], v4 offset:2048
    ds_read_b64_tr_b16 v[38:39], v4 offset:10240
    v_mfma_f32_16x16x32_bf16 a[164:167], v[40:43], v[88:91], a[164:167]
    s_waitcnt lgkmcnt(6)
    v_add_f32 v14, v14, v115
    v_cvt_pk_bf16_f32 v113, v114, v115
    v_mfma_f32_16x16x32_bf16 a[172:175], v[24:27], v[88:91], a[172:175]
    v_exp_f32 v119, v119
    v_mfma_f32_16x16x32_bf16 a[168:171], v[24:27], v[80:83], a[168:171]
    v_add_f32 v14, v14, v116
    v_add_f32 v14, v14, v117
    v_mfma_f32_16x16x32_bf16 v[172:175], v[24:27], v[72:75], v[172:175]
    ds_read_b64_tr_b16 v[40:41], v5 offset:2048
    ds_read_b64_tr_b16 v[42:43], v5 offset:10240
    v_mfma_f32_16x16x32_bf16 v[168:171], v[24:27], v[64:67], v[168:171]
    s_waitcnt lgkmcnt(6)
    v_exp_f32 v120, v120
    v_mfma_f32_16x16x32_bf16 v[176:179], v[28:31], v[64:67], v[176:179]
    v_exp_f32 v121, v121
    v_mfma_f32_16x16x32_bf16 v[180:183], v[28:31], v[72:75], v[180:183]
    v_cvt_pk_bf16_f32 v114, v116, v117
    v_add_f32 v14, v14, v118
    v_mfma_f32_16x16x32_bf16 a[176:179], v[28:31], v[80:83], a[176:179]
    ds_read_b64_tr_b16 v[24:25], v6 offset:2048
    ds_read_b64_tr_b16 v[26:27], v6 offset:10240
    v_mfma_f32_16x16x32_bf16 a[180:183], v[28:31], v[88:91], a[180:183]
    s_waitcnt lgkmcnt(6)
    v_exp_f32 v122, v122
    v_mfma_f32_16x16x32_bf16 a[188:191], v[32:35], v[88:91], a[188:191]
    v_add_f32 v14, v14, v119
    v_cvt_pk_bf16_f32 v115, v118, v119
    v_mfma_f32_16x16x32_bf16 a[184:187], v[32:35], v[80:83], a[184:187]
    v_exp_f32 v123, v123
    v_mfma_f32_16x16x32_bf16 v[188:191], v[32:35], v[72:75], v[188:191]
    ds_read_b64_tr_b16 v[28:29], v7 offset:2048
    ds_read_b64_tr_b16 v[30:31], v7 offset:10240
    v_mfma_f32_16x16x32_bf16 v[184:187], v[32:35], v[64:67], v[184:187]
    s_waitcnt lgkmcnt(6)
    v_add_f32 v15, v15, v120
    v_add_f32 v15, v15, v121
    v_mfma_f32_16x16x32_bf16 v[192:195], v[36:39], v[64:67], v[192:195]
    v_exp_f32 v124, v124
    v_mfma_f32_16x16x32_bf16 v[196:199], v[36:39], v[72:75], v[196:199]
    v_exp_f32 v125, v125
    v_mfma_f32_16x16x32_bf16 a[192:195], v[36:39], v[80:83], a[192:195]
    ds_read_b64_tr_b16 v[32:33], v4 offset:3072
    ds_read_b64_tr_b16 v[34:35], v4 offset:11264
    v_mfma_f32_16x16x32_bf16 a[196:199], v[36:39], v[88:91], a[196:199]
    s_waitcnt lgkmcnt(6)
    v_cvt_pk_bf16_f32 v120, v120, v121
    v_add_f32 v15, v15, v122
    v_mfma_f32_16x16x32_bf16 a[204:207], v[40:43], v[88:91], a[204:207]
    v_exp_f32 v126, v126
    v_mfma_f32_16x16x32_bf16 a[200:203], v[40:43], v[80:83], a[200:203]
    v_add_f32 v15, v15, v123
    v_cvt_pk_bf16_f32 v121, v122, v123
    v_mfma_f32_16x16x32_bf16 v[204:207], v[40:43], v[72:75], v[204:207]
    ds_read_b64_tr_b16 v[36:37], v5 offset:3072
    ds_read_b64_tr_b16 v[38:39], v5 offset:11264
    v_mfma_f32_16x16x32_bf16 v[200:203], v[40:43], v[64:67], v[200:203]
    s_waitcnt lgkmcnt(6)
    v_exp_f32 v127, v127
    v_mfma_f32_16x16x32_bf16 v[208:211], v[24:27], v[64:67], v[208:211]
    v_add_f32 v15, v15, v124
    v_add_f32 v15, v15, v125
    v_mfma_f32_16x16x32_bf16 v[212:215], v[24:27], v[72:75], v[212:215]
    v_exp_f32 v96, v96
    v_mfma_f32_16x16x32_bf16 a[208:211], v[24:27], v[80:83], a[208:211]
    ds_read_b64_tr_b16 v[40:41], v6 offset:3072
    ds_read_b64_tr_b16 v[42:43], v6 offset:11264
    v_mfma_f32_16x16x32_bf16 a[212:215], v[24:27], v[88:91], a[212:215]
    s_waitcnt lgkmcnt(6)
    v_exp_f32 v97, v97
    v_mfma_f32_16x16x32_bf16 a[220:223], v[28:31], v[88:91], a[220:223]
    v_cvt_pk_bf16_f32 v122, v124, v125
    v_add_f32 v15, v15, v126
    v_mfma_f32_16x16x32_bf16 a[216:219], v[28:31], v[80:83], a[216:219]
    v_exp_f32 v98, v98
    v_mfma_f32_16x16x32_bf16 v[220:223], v[28:31], v[72:75], v[220:223]
    ds_read_b64_tr_b16 v[24:25], v7 offset:3072
    ds_read_b64_tr_b16 v[26:27], v7 offset:11264
    v_mfma_f32_16x16x32_bf16 v[216:219], v[28:31], v[64:67], v[216:219]
    s_waitcnt lgkmcnt(6)
    v_add_f32 v15, v15, v127
    v_cvt_pk_bf16_f32 v123, v126, v127
    v_mfma_f32_16x16x32_bf16 v[224:227], v[32:35], v[64:67], v[224:227]
    v_exp_f32 v99, v99
    v_mfma_f32_16x16x32_bf16 v[228:231], v[32:35], v[72:75], v[228:231]
    v_add_f32 v12, v12, v96
    v_add_f32 v12, v12, v97
    v_mfma_f32_16x16x32_bf16 a[224:227], v[32:35], v[80:83], a[224:227]
    v_exp_f32 v100, v100
    v_exp_f32 v101, v101
    v_exp_f32 v102, v102
    v_exp_f32 v103, v103
    v_exp_f32 v104, v104
    v_exp_f32 v105, v105
    v_exp_f32 v106, v106
    v_exp_f32 v107, v107
    v_exp_f32 v108, v108
    v_exp_f32 v109, v109
    v_exp_f32 v110, v110
    v_exp_f32 v111, v111
    v_cvt_pk_bf16_f32 v96, v96, v97
    v_add_f32 v12, v12, v98
    v_add_f32 v12, v12, v99
    v_cvt_pk_bf16_f32 v97, v98, v99
    v_add_f32 v12, v12, v100
    v_add_f32 v12, v12, v101
    v_cvt_pk_bf16_f32 v98, v100, v101
    v_add_f32 v12, v12, v102
    v_add_f32 v12, v12, v103
    v_cvt_pk_bf16_f32 v99, v102, v103
    v_add_f32 v13, v13, v104
    v_add_f32 v13, v13, v105
    v_cvt_pk_bf16_f32 v104, v104, v105
    v_add_f32 v13, v13, v106
    v_add_f32 v13, v13, v107
    v_cvt_pk_bf16_f32 v105, v106, v107
    v_add_f32 v13, v13, v108
    v_add_f32 v13, v13, v109
    v_cvt_pk_bf16_f32 v106, v108, v109
    v_add_f32 v13, v13, v110
    v_add_f32 v13, v13, v111
    v_cvt_pk_bf16_f32 v107, v110, v111
    v_mov_b32 v16, v12
    v_mov_b32 v17, v13
    v_mov_b32 v18, v14
    v_mov_b32 v19, v15
    v_permlane32_swap_b32 v12, v16
    v_permlane32_swap_b32 v13, v17
    v_permlane32_swap_b32 v14, v18
    v_permlane32_swap_b32 v15, v19
    v_add_f32 v12, v12, v16
    v_add_f32 v13, v13, v17
    v_add_f32 v14, v14, v18
    v_add_f32 v15, v15, v19
    v_mov_b32 v16, v12
    v_mov_b32 v17, v13
    v_mov_b32 v18, v14
    v_mov_b32 v19, v15
    v_permlane16_swap_b32 v12, v16
    v_permlane16_swap_b32 v13, v17
    v_permlane16_swap_b32 v14, v18
    v_permlane16_swap_b32 v15, v19
    v_add_f32 v12, v12, v16
    v_add_f32 v13, v13, v17
    v_add_f32 v14, v14, v18
    v_add_f32 v15, v15, v19
    v_mov_b32 v57, v14
    v_mov_b32 v58, v60
    v_mov_b32 v59, v15
    v_add_f32 v17, v12, v13
    v_add_f32 v18, v14, v15
    v_add_f32 v17, v17, v18
    v_cmp_ngt_f32 vcc, 0x4b800000, v17
    s_lshl_b32 s37, s3, 2
    s_add_u32 s37, s37, 135168
    s_cmp_lg_u64 vcc, 0
    s_cselect_b32 s39, 1, 0
    v_mov_b32 v18, s37
    v_mov_b32 v19, s39
    ds_write_b128 v11, v[56:59]
    ds_write_b32 v18, v19
    v_mov_b32 v18, 135168
    v_xor_b32 v11, 1024, v11
    v_mfma_f32_16x16x32_bf16 a[228:231], v[32:35], v[88:91], a[228:231]
    s_waitcnt lgkmcnt(6)
    v_mfma_f32_16x16x32_bf16 a[236:239], v[36:39], v[88:91], a[236:239]
    v_mfma_f32_16x16x32_bf16 a[232:235], v[36:39], v[80:83], a[232:235]
    v_mfma_f32_16x16x32_bf16 v[236:239], v[36:39], v[72:75], v[236:239]
    s_waitcnt vmcnt(1) lgkmcnt(0)
    s_barrier
    v_mfma_f32_16x16x32_bf16 v[232:235], v[36:39], v[64:67], v[232:235]
    ds_read_b64_tr_b16 a[0:1], v4 offset:32768
    ds_read_b64_tr_b16 a[2:3], v4 offset:40960
    v_mfma_f32_16x16x32_bf16 v[240:243], v[40:43], v[64:67], v[240:243]
    ds_read_b64_tr_b16 a[4:5], v5 offset:32768
    ds_read_b64_tr_b16 a[6:7], v5 offset:40960
    v_mfma_f32_16x16x32_bf16 v[244:247], v[40:43], v[72:75], v[244:247]
    ds_read_b64_tr_b16 a[8:9], v6 offset:32768
    ds_read_b64_tr_b16 a[10:11], v6 offset:40960
    v_mfma_f32_16x16x32_bf16 a[240:243], v[40:43], v[80:83], a[240:243]
    ds_read_b64_tr_b16 a[12:13], v7 offset:32768
    ds_read_b64_tr_b16 a[14:15], v7 offset:40960
    v_mfma_f32_16x16x32_bf16 a[244:247], v[40:43], v[88:91], a[244:247]
    ds_read_b64_tr_b16 a[16:17], v4 offset:33792
    ds_read_b64_tr_b16 a[18:19], v4 offset:41984
    v_mfma_f32_16x16x32_bf16 a[252:255], v[24:27], v[88:91], a[252:255]
    ds_read_b64_tr_b16 a[20:21], v5 offset:33792
    ds_read_b64_tr_b16 a[22:23], v5 offset:41984
    v_mfma_f32_16x16x32_bf16 a[248:251], v[24:27], v[80:83], a[248:251]
    ds_read_b64_tr_b16 a[24:25], v6 offset:33792
    ds_read_b64_tr_b16 a[26:27], v6 offset:41984
    v_mfma_f32_16x16x32_bf16 v[252:255], v[24:27], v[72:75], v[252:255]
    ds_read_b64_tr_b16 a[28:29], v7 offset:33792
    ds_read_b64_tr_b16 a[30:31], v7 offset:41984
    v_mfma_f32_16x16x32_bf16 v[248:251], v[24:27], v[64:67], v[248:251]
    s_waitcnt lgkmcnt(14)
    ds_read_b64_tr_b16 a[32:33], v4 offset:34816
    ds_read_b64_tr_b16 a[34:35], v4 offset:43008
    v_mfma_f32_16x16x32_bf16 a[128:131], a[0:3], v[112:115], a[128:131]
    ds_read_b64_tr_b16 a[36:37], v5 offset:34816
    ds_read_b64_tr_b16 a[38:39], v5 offset:43008
    v_mfma_f32_16x16x32_bf16 a[132:135], a[0:3], v[120:123], a[132:135]
    s_waitcnt lgkmcnt(15)
    ds_read_b64_tr_b16 a[40:41], v6 offset:34816
    ds_read_b64_tr_b16 a[42:43], v6 offset:43008
    v_mfma_f32_16x16x32_bf16 a[140:143], a[4:7], v[120:123], a[140:143]
    ds_read_b64_tr_b16 a[44:45], v7 offset:34816
    ds_read_b64_tr_b16 a[46:47], v7 offset:43008
    v_mfma_f32_16x16x32_bf16 a[136:139], a[4:7], v[112:115], a[136:139]
    s_waitcnt lgkmcnt(15)
    ds_read_b64_tr_b16 a[48:49], v4 offset:35840
    ds_read_b64_tr_b16 a[50:51], v4 offset:44032
    v_mfma_f32_16x16x32_bf16 a[144:147], a[8:11], v[112:115], a[144:147]
    ds_read_b64_tr_b16 a[52:53], v5 offset:35840
    ds_read_b64_tr_b16 a[54:55], v5 offset:44032
    v_mfma_f32_16x16x32_bf16 a[148:151], a[8:11], v[120:123], a[148:151]
    ds_read_b64_tr_b16 a[56:57], v6 offset:35840
    ds_read_b64_tr_b16 a[58:59], v6 offset:44032
    v_mfma_f32_16x16x32_bf16 a[156:159], a[12:15], v[120:123], a[156:159]
    ds_read_b64_tr_b16 a[60:61], v7 offset:35840
    ds_read_b64_tr_b16 a[62:63], v7 offset:44032
    v_mfma_f32_16x16x32_bf16 a[152:155], a[12:15], v[112:115], a[152:155]
    s_waitcnt lgkmcnt(15)
    ds_read_b128 v[64:67], v18
    ds_read_b128 v[20:23], v11
    v_mfma_f32_16x16x32_bf16 a[160:163], a[16:19], v[112:115], a[160:163]
    v_mfma_f32_16x16x32_bf16 a[164:167], a[16:19], v[120:123], a[164:167]
    ds_write_b128 v2, a[128:131] offset:0
    v_mfma_f32_16x16x32_bf16 a[172:175], a[20:23], v[120:123], a[172:175]
    v_mfma_f32_16x16x32_bf16 a[168:171], a[20:23], v[112:115], a[168:171]
    ds_write_b128 v2, a[132:135] offset:1024
    v_mfma_f32_16x16x32_bf16 a[176:179], a[24:27], v[112:115], a[176:179]
    v_mfma_f32_16x16x32_bf16 a[180:183], a[24:27], v[120:123], a[180:183]
    ds_write_b128 v2, a[136:139] offset:2048
    v_mfma_f32_16x16x32_bf16 a[188:191], a[28:31], v[120:123], a[188:191]
    v_mfma_f32_16x16x32_bf16 a[184:187], a[28:31], v[112:115], a[184:187]
    s_waitcnt lgkmcnt(15)
    ds_write_b128 v2, a[140:143] offset:3072
    v_mfma_f32_16x16x32_bf16 a[192:195], a[32:35], v[112:115], a[192:195]
    s_waitcnt lgkmcnt(4)
    s_barrier
    v_mfma_f32_16x16x32_bf16 a[196:199], a[32:35], v[120:123], a[196:199]
    ds_write_b128 v2, a[144:147] offset:4096
    v_mfma_f32_16x16x32_bf16 a[204:207], a[36:39], v[120:123], a[204:207]
    v_min_f32 v16, v48, v20
    v_min_f32 v18, v52, v22
    v_mfma_f32_16x16x32_bf16 a[200:203], a[36:39], v[112:115], a[200:203]
    ds_write_b128 v2, a[148:151] offset:5120
    v_mfma_f32_16x16x32_bf16 a[208:211], a[40:43], v[112:115], a[208:211]
    v_sub_f32 v17, v16, v20
    v_sub_f32 v19, v18, v22
    v_mfma_f32_16x16x32_bf16 a[212:215], a[40:43], v[120:123], a[212:215]
    ds_write_b128 v2, a[152:155] offset:6144
    v_mfma_f32_16x16x32_bf16 a[220:223], a[44:47], v[120:123], a[220:223]
    v_sub_f32 v16, v16, v48
    v_sub_f32 v18, v18, v52
    v_mfma_f32_16x16x32_bf16 a[216:219], a[44:47], v[112:115], a[216:219]
    ds_write_b128 v2, a[156:159] offset:7168
    v_mfma_f32_16x16x32_bf16 a[224:227], a[48:51], v[112:115], a[224:227]
    v_exp_f32 v16, v16
    v_mfma_f32_16x16x32_bf16 a[228:231], a[48:51], v[120:123], a[228:231]
    ds_write_b128 v2, a[160:163] offset:8192
    v_mfma_f32_16x16x32_bf16 a[236:239], a[52:55], v[120:123], a[236:239]
    v_exp_f32 v18, v18
    v_mfma_f32_16x16x32_bf16 a[232:235], a[52:55], v[112:115], a[232:235]
    ds_write_b128 v2, a[164:167] offset:9216
    v_mfma_f32_16x16x32_bf16 a[240:243], a[56:59], v[112:115], a[240:243]
    v_exp_f32 v17, v17
    v_mfma_f32_16x16x32_bf16 a[244:247], a[56:59], v[120:123], a[244:247]
    ds_write_b128 v2, a[168:171] offset:10240
    v_mfma_f32_16x16x32_bf16 a[252:255], a[60:63], v[120:123], a[252:255]
    v_exp_f32 v19, v19
    v_mfma_f32_16x16x32_bf16 a[248:251], a[60:63], v[112:115], a[248:251]
    ds_write_b128 v2, a[172:175] offset:11264
    v_mfma_f32_16x16x32_bf16 v[128:131], a[0:3], v[96:99], v[128:131]
    v_mul_f32 v12, v12, v16
    v_mul_f32 v13, v13, v18
    v_mfma_f32_16x16x32_bf16 v[132:135], a[0:3], v[104:107], v[132:135]
    ds_write_b128 v2, a[176:179] offset:12288
    v_mfma_f32_16x16x32_bf16 v[140:143], a[4:7], v[104:107], v[140:143]
    v_fma_f32 v12, v21, v17, v12
    v_fma_f32 v13, v23, v19, v13
    v_mfma_f32_16x16x32_bf16 v[136:139], a[4:7], v[96:99], v[136:139]
    ds_write_b128 v2, a[180:183] offset:13312
    v_mfma_f32_16x16x32_bf16 v[144:147], a[8:11], v[96:99], v[144:147]
    v_rcp_f32 v12, v12
    v_mfma_f32_16x16x32_bf16 v[148:151], a[8:11], v[104:107], v[148:151]
    ds_write_b128 v2, a[184:187] offset:14336
    v_mfma_f32_16x16x32_bf16 v[156:159], a[12:15], v[104:107], v[156:159]
    v_rcp_f32 v13, v13
    v_mfma_f32_16x16x32_bf16 v[152:155], a[12:15], v[96:99], v[152:155]
    ds_write_b128 v2, a[188:191] offset:15360
    v_mfma_f32_16x16x32_bf16 v[160:163], a[16:19], v[96:99], v[160:163]
    v_mul_f32 v56, v16, v12
    v_mul_f32 v58, v18, v13
    v_mfma_f32_16x16x32_bf16 v[164:167], a[16:19], v[104:107], v[164:167]
    ds_write_b128 v3, a[192:195] offset:0
    v_mfma_f32_16x16x32_bf16 v[172:175], a[20:23], v[104:107], v[172:175]
    v_mul_f32 v60, v17, v12
    v_mul_f32 v62, v19, v13
    v_mfma_f32_16x16x32_bf16 v[168:171], a[20:23], v[96:99], v[168:171]
    ds_write_b128 v3, a[196:199] offset:1024
    v_mfma_f32_16x16x32_bf16 v[176:179], a[24:27], v[96:99], v[176:179]
    v_mfma_f32_16x16x32_bf16 v[180:183], a[24:27], v[104:107], v[180:183]
    ds_write_b128 v3, a[200:203] offset:2048
    v_mfma_f32_16x16x32_bf16 v[188:191], a[28:31], v[104:107], v[188:191]
    v_mfma_f32_16x16x32_bf16 v[184:187], a[28:31], v[96:99], v[184:187]
    ds_write_b128 v3, a[204:207] offset:3072
    v_mfma_f32_16x16x32_bf16 v[192:195], a[32:35], v[96:99], v[192:195]
    v_mfma_f32_16x16x32_bf16 v[196:199], a[32:35], v[104:107], v[196:199]
    ds_write_b128 v3, a[208:211] offset:4096
    v_mfma_f32_16x16x32_bf16 v[204:207], a[36:39], v[104:107], v[204:207]
    v_mfma_f32_16x16x32_bf16 v[200:203], a[36:39], v[96:99], v[200:203]
    ds_write_b128 v3, a[212:215] offset:5120
    v_mfma_f32_16x16x32_bf16 v[208:211], a[40:43], v[96:99], v[208:211]
    v_mfma_f32_16x16x32_bf16 v[212:215], a[40:43], v[104:107], v[212:215]
    ds_write_b128 v3, a[216:219] offset:6144
    v_mfma_f32_16x16x32_bf16 v[220:223], a[44:47], v[104:107], v[220:223]
    v_mfma_f32_16x16x32_bf16 v[216:219], a[44:47], v[96:99], v[216:219]
    ds_write_b128 v3, a[220:223] offset:7168
    v_mfma_f32_16x16x32_bf16 v[224:227], a[48:51], v[96:99], v[224:227]
    v_mfma_f32_16x16x32_bf16 v[228:231], a[48:51], v[104:107], v[228:231]
    ds_write_b128 v3, a[224:227] offset:32768
    v_mfma_f32_16x16x32_bf16 v[236:239], a[52:55], v[104:107], v[236:239]
    v_mfma_f32_16x16x32_bf16 v[232:235], a[52:55], v[96:99], v[232:235]
    ds_write_b128 v3, a[228:231] offset:33792
    v_mfma_f32_16x16x32_bf16 v[240:243], a[56:59], v[96:99], v[240:243]
    v_mfma_f32_16x16x32_bf16 v[244:247], a[56:59], v[104:107], v[244:247]
    ds_write_b128 v3, a[232:235] offset:34816
    v_mfma_f32_16x16x32_bf16 v[252:255], a[60:63], v[104:107], v[252:255]
    v_mfma_f32_16x16x32_bf16 v[248:251], a[60:63], v[96:99], v[248:251]
    ds_write_b128 v3, a[236:239] offset:35840
    v_pk_mul_f32 v[128:129], v[128:129], v[56:57] op_sel_hi:[1,0]
    ds_write_b128 v3, a[240:243] offset:36864
    v_pk_mul_f32 v[130:131], v[130:131], v[56:57] op_sel_hi:[1,0]
    v_pk_mul_f32 v[132:133], v[132:133], v[58:59] op_sel_hi:[1,0]
    s_add_u32 m0, s32, 131072
    s_add_u32 s37, s62, 0
    buffer_load_dwordx4 v10, s[24:27], s37 offen offset:0 lds
    v_pk_mul_f32 v[134:135], v[134:135], v[58:59] op_sel_hi:[1,0]
    v_pk_mul_f32 v[136:137], v[136:137], v[56:57] op_sel_hi:[1,0]
    ds_write_b128 v3, a[244:247] offset:37888
    v_pk_mul_f32 v[138:139], v[138:139], v[56:57] op_sel_hi:[1,0]
    v_pk_mul_f32 v[140:141], v[140:141], v[58:59] op_sel_hi:[1,0]
    v_pk_mul_f32 v[142:143], v[142:143], v[58:59] op_sel_hi:[1,0]
    v_pk_mul_f32 v[144:145], v[144:145], v[56:57] op_sel_hi:[1,0]
    ds_write_b128 v3, a[248:251] offset:38912
    v_pk_mul_f32 v[146:147], v[146:147], v[56:57] op_sel_hi:[1,0]
    v_pk_mul_f32 v[148:149], v[148:149], v[58:59] op_sel_hi:[1,0]
    s_add_u32 s37, s62, 6144
    buffer_load_dwordx4 v10, s[24:27], s37 offen offset:1024 lds
    v_pk_mul_f32 v[150:151], v[150:151], v[58:59] op_sel_hi:[1,0]
    v_pk_mul_f32 v[152:153], v[152:153], v[56:57] op_sel_hi:[1,0]
    ds_write_b128 v3, a[252:255] offset:39936
    v_pk_mul_f32 v[154:155], v[154:155], v[56:57] op_sel_hi:[1,0]
    v_pk_mul_f32 v[156:157], v[156:157], v[58:59] op_sel_hi:[1,0]
    v_pk_mul_f32 v[158:159], v[158:159], v[58:59] op_sel_hi:[1,0]
    v_pk_mul_f32 v[160:161], v[160:161], v[56:57] op_sel_hi:[1,0]
    v_pk_mul_f32 v[162:163], v[162:163], v[56:57] op_sel_hi:[1,0]
    v_pk_mul_f32 v[164:165], v[164:165], v[58:59] op_sel_hi:[1,0]
    s_add_u32 s37, s62, 12288
    buffer_load_dwordx4 v10, s[24:27], s37 offen offset:2048 lds
    v_pk_mul_f32 v[166:167], v[166:167], v[58:59] op_sel_hi:[1,0]
    v_pk_mul_f32 v[168:169], v[168:169], v[56:57] op_sel_hi:[1,0]
    v_pk_mul_f32 v[170:171], v[170:171], v[56:57] op_sel_hi:[1,0]
    v_pk_mul_f32 v[172:173], v[172:173], v[58:59] op_sel_hi:[1,0]
    v_pk_mul_f32 v[174:175], v[174:175], v[58:59] op_sel_hi:[1,0]
    v_pk_mul_f32 v[176:177], v[176:177], v[56:57] op_sel_hi:[1,0]
    v_pk_mul_f32 v[178:179], v[178:179], v[56:57] op_sel_hi:[1,0]
    v_pk_mul_f32 v[180:181], v[180:181], v[58:59] op_sel_hi:[1,0]
    s_add_u32 s37, s62, 18432
    buffer_load_dwordx4 v10, s[24:27], s37 offen offset:3072 lds
    v_pk_mul_f32 v[182:183], v[182:183], v[58:59] op_sel_hi:[1,0]
    v_pk_mul_f32 v[184:185], v[184:185], v[56:57] op_sel_hi:[1,0]
    v_pk_mul_f32 v[186:187], v[186:187], v[56:57] op_sel_hi:[1,0]
    v_pk_mul_f32 v[188:189], v[188:189], v[58:59] op_sel_hi:[1,0]
    v_pk_mul_f32 v[190:191], v[190:191], v[58:59] op_sel_hi:[1,0]
    v_pk_mul_f32 v[192:193], v[192:193], v[56:57] op_sel_hi:[1,0]
    v_pk_mul_f32 v[194:195], v[194:195], v[56:57] op_sel_hi:[1,0]
    v_pk_mul_f32 v[196:197], v[196:197], v[58:59] op_sel_hi:[1,0]
    s_add_u32 m0, s32, 135168
    s_add_u32 s37, s62, 28672
    buffer_load_dwordx4 v10, s[24:27], s37 offen offset:0 lds
    v_pk_mul_f32 v[198:199], v[198:199], v[58:59] op_sel_hi:[1,0]
    v_pk_mul_f32 v[200:201], v[200:201], v[56:57] op_sel_hi:[1,0]
    v_pk_mul_f32 v[202:203], v[202:203], v[56:57] op_sel_hi:[1,0]
    v_pk_mul_f32 v[204:205], v[204:205], v[58:59] op_sel_hi:[1,0]
    v_pk_mul_f32 v[206:207], v[206:207], v[58:59] op_sel_hi:[1,0]
    v_pk_mul_f32 v[208:209], v[208:209], v[56:57] op_sel_hi:[1,0]
    v_pk_mul_f32 v[210:211], v[210:211], v[56:57] op_sel_hi:[1,0]
    v_pk_mul_f32 v[212:213], v[212:213], v[58:59] op_sel_hi:[1,0]
    s_add_u32 s37, s62, 34816
    buffer_load_dwordx4 v10, s[24:27], s37 offen offset:1024 lds
    v_pk_mul_f32 v[214:215], v[214:215], v[58:59] op_sel_hi:[1,0]
    v_pk_mul_f32 v[216:217], v[216:217], v[56:57] op_sel_hi:[1,0]
    v_pk_mul_f32 v[218:219], v[218:219], v[56:57] op_sel_hi:[1,0]
    v_pk_mul_f32 v[220:221], v[220:221], v[58:59] op_sel_hi:[1,0]
    v_pk_mul_f32 v[222:223], v[222:223], v[58:59] op_sel_hi:[1,0]
    v_pk_mul_f32 v[224:225], v[224:225], v[56:57] op_sel_hi:[1,0]
    v_pk_mul_f32 v[226:227], v[226:227], v[56:57] op_sel_hi:[1,0]
    v_pk_mul_f32 v[228:229], v[228:229], v[58:59] op_sel_hi:[1,0]
    s_add_u32 s37, s62, 40960
    buffer_load_dwordx4 v10, s[24:27], s37 offen offset:2048 lds
    v_pk_mul_f32 v[230:231], v[230:231], v[58:59] op_sel_hi:[1,0]
    v_pk_mul_f32 v[232:233], v[232:233], v[56:57] op_sel_hi:[1,0]
    v_pk_mul_f32 v[234:235], v[234:235], v[56:57] op_sel_hi:[1,0]
    v_pk_mul_f32 v[236:237], v[236:237], v[58:59] op_sel_hi:[1,0]
    v_pk_mul_f32 v[238:239], v[238:239], v[58:59] op_sel_hi:[1,0]
    v_pk_mul_f32 v[240:241], v[240:241], v[56:57] op_sel_hi:[1,0]
    v_pk_mul_f32 v[242:243], v[242:243], v[56:57] op_sel_hi:[1,0]
    v_pk_mul_f32 v[244:245], v[244:245], v[58:59] op_sel_hi:[1,0]
    s_add_u32 s37, s62, 47104
    buffer_load_dwordx4 v10, s[24:27], s37 offen offset:3072 lds
    v_pk_mul_f32 v[246:247], v[246:247], v[58:59] op_sel_hi:[1,0]
    v_pk_mul_f32 v[248:249], v[248:249], v[56:57] op_sel_hi:[1,0]
    v_pk_mul_f32 v[250:251], v[250:251], v[56:57] op_sel_hi:[1,0]
    v_pk_mul_f32 v[252:253], v[252:253], v[58:59] op_sel_hi:[1,0]
    v_pk_mul_f32 v[254:255], v[254:255], v[58:59] op_sel_hi:[1,0]
    s_waitcnt lgkmcnt(0)
    s_barrier
    v_or3_b32 v64, v64, v65, v66
    v_or_b32 v64, v64, v67
    s_nop 0
    v_readfirstlane_b32 s37, v64
    s_andn2_b32 s37, s37, s101
    s_cbranch_scc1 L_redo
    ds_read_b128 v[96:99], v9 offset:32768
    ds_read_b128 v[100:103], v9 offset:33792
    ds_read_b128 v[104:107], v9 offset:34816
    ds_read_b128 v[108:111], v9 offset:35840
    ds_read_b128 v[112:115], v9 offset:36864
    ds_read_b128 v[116:119], v9 offset:37888
    ds_read_b128 v[120:123], v9 offset:38912
    ds_read_b128 v[124:127], v9 offset:39936
    ds_read_b128 v[64:67], v9 offset:0
    ds_read_b128 v[68:71], v9 offset:1024
    ds_read_b128 v[72:75], v9 offset:2048
    ds_read_b128 v[76:79], v9 offset:3072
    ds_read_b128 v[80:83], v9 offset:4096
    ds_read_b128 v[84:87], v9 offset:5120
    ds_read_b128 v[88:91], v9 offset:6144
    ds_read_b128 v[92:95], v9 offset:7168
    s_waitcnt lgkmcnt(15)
    v_pk_fma_f32 v[224:225], v[96:97], v[60:61], v[224:225] op_sel_hi:[1,0,1]
    v_pk_fma_f32 v[226:227], v[98:99], v[60:61], v[226:227] op_sel_hi:[1,0,1]
    s_waitcnt lgkmcnt(14)
    v_pk_fma_f32 v[228:229], v[100:101], v[62:63], v[228:229] op_sel_hi:[1,0,1]
    v_pk_fma_f32 v[230:231], v[102:103], v[62:63], v[230:231] op_sel_hi:[1,0,1]
    s_waitcnt lgkmcnt(13)
    v_pk_fma_f32 v[232:233], v[104:105], v[60:61], v[232:233] op_sel_hi:[1,0,1]
    v_pk_fma_f32 v[234:235], v[106:107], v[60:61], v[234:235] op_sel_hi:[1,0,1]
    s_waitcnt lgkmcnt(12)
    v_pk_fma_f32 v[236:237], v[108:109], v[62:63], v[236:237] op_sel_hi:[1,0,1]
    v_pk_fma_f32 v[238:239], v[110:111], v[62:63], v[238:239] op_sel_hi:[1,0,1]
    s_waitcnt lgkmcnt(11)
    v_pk_fma_f32 v[240:241], v[112:113], v[60:61], v[240:241] op_sel_hi:[1,0,1]
    v_pk_fma_f32 v[242:243], v[114:115], v[60:61], v[242:243] op_sel_hi:[1,0,1]
    s_waitcnt lgkmcnt(10)
    v_pk_fma_f32 v[244:245], v[116:117], v[62:63], v[244:245] op_sel_hi:[1,0,1]
    v_pk_fma_f32 v[246:247], v[118:119], v[62:63], v[246:247] op_sel_hi:[1,0,1]
    s_waitcnt lgkmcnt(9)
    v_pk_fma_f32 v[248:249], v[120:121], v[60:61], v[248:249] op_sel_hi:[1,0,1]
    v_pk_fma_f32 v[250:251], v[122:123], v[60:61], v[250:251] op_sel_hi:[1,0,1]
    s_waitcnt lgkmcnt(8)
    v_pk_fma_f32 v[252:253], v[124:125], v[62:63], v[252:253] op_sel_hi:[1,0,1]
    v_pk_fma_f32 v[254:255], v[126:127], v[62:63], v[254:255] op_sel_hi:[1,0,1]
    ds_read_b128 v[96:99], v8 offset:8192
    ds_read_b128 v[100:103], v8 offset:9216
    ds_read_b128 v[104:107], v8 offset:10240
    ds_read_b128 v[108:111], v8 offset:11264
    ds_read_b128 v[112:115], v8 offset:12288
    ds_read_b128 v[116:119], v8 offset:13312
    ds_read_b128 v[120:123], v8 offset:14336
    ds_read_b128 v[124:127], v8 offset:15360
    s_waitcnt lgkmcnt(15)
    v_pk_fma_f32 v[192:193], v[64:65], v[60:61], v[192:193] op_sel_hi:[1,0,1]
    v_pk_fma_f32 v[194:195], v[66:67], v[60:61], v[194:195] op_sel_hi:[1,0,1]
    s_waitcnt lgkmcnt(14)
    v_pk_fma_f32 v[196:197], v[68:69], v[62:63], v[196:197] op_sel_hi:[1,0,1]
    v_pk_fma_f32 v[198:199], v[70:71], v[62:63], v[198:199] op_sel_hi:[1,0,1]
    s_waitcnt lgkmcnt(13)
    v_pk_fma_f32 v[200:201], v[72:73], v[60:61], v[200:201] op_sel_hi:[1,0,1]
    v_pk_fma_f32 v[202:203], v[74:75], v[60:61], v[202:203] op_sel_hi:[1,0,1]
    s_waitcnt lgkmcnt(12)
    v_pk_fma_f32 v[204:205], v[76:77], v[62:63], v[204:205] op_sel_hi:[1,0,1]
    v_pk_fma_f32 v[206:207], v[78:79], v[62:63], v[206:207] op_sel_hi:[1,0,1]
    s_waitcnt lgkmcnt(11)
    v_pk_fma_f32 v[208:209], v[80:81], v[60:61], v[208:209] op_sel_hi:[1,0,1]
    v_pk_fma_f32 v[210:211], v[82:83], v[60:61], v[210:211] op_sel_hi:[1,0,1]
    s_waitcnt lgkmcnt(10)
    v_pk_fma_f32 v[212:213], v[84:85], v[62:63], v[212:213] op_sel_hi:[1,0,1]
    v_pk_fma_f32 v[214:215], v[86:87], v[62:63], v[214:215] op_sel_hi:[1,0,1]
    s_waitcnt lgkmcnt(9)
    v_pk_fma_f32 v[216:217], v[88:89], v[60:61], v[216:217] op_sel_hi:[1,0,1]
    v_pk_fma_f32 v[218:219], v[90:91], v[60:61], v[218:219] op_sel_hi:[1,0,1]
    s_waitcnt lgkmcnt(8)
    v_pk_fma_f32 v[220:221], v[92:93], v[62:63], v[220:221] op_sel_hi:[1,0,1]
    v_pk_fma_f32 v[222:223], v[94:95], v[62:63], v[222:223] op_sel_hi:[1,0,1]
    ds_read_b128 v[64:67], v8 offset:0
    ds_read_b128 v[68:71], v8 offset:1024
    ds_read_b128 v[72:75], v8 offset:2048
    ds_read_b128 v[76:79], v8 offset:3072
    ds_read_b128 v[80:83], v8 offset:4096
    ds_read_b128 v[84:87], v8 offset:5120
    ds_read_b128 v[88:91], v8 offset:6144
    ds_read_b128 v[92:95], v8 offset:7168
    v_cvt_pk_bf16_f32 v224, v224, v225
    v_cvt_pk_bf16_f32 v225, v226, v227
    v_cvt_pk_bf16_f32 v226, v232, v233
    v_cvt_pk_bf16_f32 v227, v234, v235
    ds_write_b128 v8, v[224:227] offset:12288
    v_cvt_pk_bf16_f32 v228, v228, v229
    v_cvt_pk_bf16_f32 v229, v230, v231
    v_cvt_pk_bf16_f32 v230, v236, v237
    v_cvt_pk_bf16_f32 v231, v238, v239
    ds_write_b128 v8, v[228:231] offset:13312
    v_cvt_pk_bf16_f32 v240, v240, v241
    v_cvt_pk_bf16_f32 v241, v242, v243
    v_cvt_pk_bf16_f32 v242, v248, v249
    v_cvt_pk_bf16_f32 v243, v250, v251
    ds_write_b128 v8, v[240:243] offset:14336
    v_cvt_pk_bf16_f32 v244, v244, v245
    v_cvt_pk_bf16_f32 v245, v246, v247
    v_cvt_pk_bf16_f32 v246, v252, v253
    v_cvt_pk_bf16_f32 v247, v254, v255
    ds_write_b128 v8, v[244:247] offset:15360
    v_cvt_pk_bf16_f32 v192, v192, v193
    v_cvt_pk_bf16_f32 v193, v194, v195
    v_cvt_pk_bf16_f32 v194, v200, v201
    v_cvt_pk_bf16_f32 v195, v202, v203
    ds_write_b128 v8, v[192:195] offset:8192
    v_cvt_pk_bf16_f32 v196, v196, v197
    v_cvt_pk_bf16_f32 v197, v198, v199
    v_cvt_pk_bf16_f32 v198, v204, v205
    v_cvt_pk_bf16_f32 v199, v206, v207
    ds_write_b128 v8, v[196:199] offset:9216
    v_cvt_pk_bf16_f32 v208, v208, v209
    v_cvt_pk_bf16_f32 v209, v210, v211
    v_cvt_pk_bf16_f32 v210, v216, v217
    v_cvt_pk_bf16_f32 v211, v218, v219
    ds_write_b128 v8, v[208:211] offset:10240
    v_cvt_pk_bf16_f32 v212, v212, v213
    v_cvt_pk_bf16_f32 v213, v214, v215
    v_cvt_pk_bf16_f32 v214, v220, v221
    v_cvt_pk_bf16_f32 v215, v222, v223
    ds_write_b128 v8, v[212:215] offset:11264
    s_waitcnt lgkmcnt(15)
    v_pk_fma_f32 v[160:161], v[96:97], v[60:61], v[160:161] op_sel_hi:[1,0,1]
    v_pk_fma_f32 v[162:163], v[98:99], v[60:61], v[162:163] op_sel_hi:[1,0,1]
    v_pk_fma_f32 v[164:165], v[100:101], v[62:63], v[164:165] op_sel_hi:[1,0,1]
    v_pk_fma_f32 v[166:167], v[102:103], v[62:63], v[166:167] op_sel_hi:[1,0,1]
    v_pk_fma_f32 v[168:169], v[104:105], v[60:61], v[168:169] op_sel_hi:[1,0,1]
    v_pk_fma_f32 v[170:171], v[106:107], v[60:61], v[170:171] op_sel_hi:[1,0,1]
    v_pk_fma_f32 v[172:173], v[108:109], v[62:63], v[172:173] op_sel_hi:[1,0,1]
    v_pk_fma_f32 v[174:175], v[110:111], v[62:63], v[174:175] op_sel_hi:[1,0,1]
    v_pk_fma_f32 v[176:177], v[112:113], v[60:61], v[176:177] op_sel_hi:[1,0,1]
    v_pk_fma_f32 v[178:179], v[114:115], v[60:61], v[178:179] op_sel_hi:[1,0,1]
    v_pk_fma_f32 v[180:181], v[116:117], v[62:63], v[180:181] op_sel_hi:[1,0,1]
    v_pk_fma_f32 v[182:183], v[118:119], v[62:63], v[182:183] op_sel_hi:[1,0,1]
    v_pk_fma_f32 v[184:185], v[120:121], v[60:61], v[184:185] op_sel_hi:[1,0,1]
    v_pk_fma_f32 v[186:187], v[122:123], v[60:61], v[186:187] op_sel_hi:[1,0,1]
    v_pk_fma_f32 v[188:189], v[124:125], v[62:63], v[188:189] op_sel_hi:[1,0,1]
    v_pk_fma_f32 v[190:191], v[126:127], v[62:63], v[190:191] op_sel_hi:[1,0,1]
    v_cvt_pk_bf16_f32 v160, v160, v161
    v_cvt_pk_bf16_f32 v161, v162, v163
    v_cvt_pk_bf16_f32 v162, v168, v169
    v_cvt_pk_bf16_f32 v163, v170, v171
    ds_write_b128 v8, v[160:163] offset:4096
    v_cvt_pk_bf16_f32 v164, v164, v165
    v_cvt_pk_bf16_f32 v165, v166, v167
    v_cvt_pk_bf16_f32 v166, v172, v173
    v_cvt_pk_bf16_f32 v167, v174, v175
    ds_write_b128 v8, v[164:167] offset:5120
    v_cvt_pk_bf16_f32 v176, v176, v177
    v_cvt_pk_bf16_f32 v177, v178, v179
    v_cvt_pk_bf16_f32 v178, v184, v185
    v_cvt_pk_bf16_f32 v179, v186, v187
    ds_write_b128 v8, v[176:179] offset:6144
    v_cvt_pk_bf16_f32 v180, v180, v181
    v_cvt_pk_bf16_f32 v181, v182, v183
    v_cvt_pk_bf16_f32 v182, v188, v189
    v_cvt_pk_bf16_f32 v183, v190, v191
    ds_write_b128 v8, v[180:183] offset:7168
    v_pk_fma_f32 v[128:129], v[64:65], v[60:61], v[128:129] op_sel_hi:[1,0,1]
    v_pk_fma_f32 v[130:131], v[66:67], v[60:61], v[130:131] op_sel_hi:[1,0,1]
    s_waitcnt lgkmcnt(15)
    v_pk_fma_f32 v[132:133], v[68:69], v[62:63], v[132:133] op_sel_hi:[1,0,1]
    v_pk_fma_f32 v[134:135], v[70:71], v[62:63], v[134:135] op_sel_hi:[1,0,1]
    v_pk_fma_f32 v[136:137], v[72:73], v[60:61], v[136:137] op_sel_hi:[1,0,1]
    v_pk_fma_f32 v[138:139], v[74:75], v[60:61], v[138:139] op_sel_hi:[1,0,1]
    v_pk_fma_f32 v[140:141], v[76:77], v[62:63], v[140:141] op_sel_hi:[1,0,1]
    v_pk_fma_f32 v[142:143], v[78:79], v[62:63], v[142:143] op_sel_hi:[1,0,1]
    v_pk_fma_f32 v[144:145], v[80:81], v[60:61], v[144:145] op_sel_hi:[1,0,1]
    v_pk_fma_f32 v[146:147], v[82:83], v[60:61], v[146:147] op_sel_hi:[1,0,1]
    s_waitcnt lgkmcnt(14)
    v_pk_fma_f32 v[148:149], v[84:85], v[62:63], v[148:149] op_sel_hi:[1,0,1]
    v_pk_fma_f32 v[150:151], v[86:87], v[62:63], v[150:151] op_sel_hi:[1,0,1]
    s_waitcnt lgkmcnt(13)
    v_pk_fma_f32 v[152:153], v[88:89], v[60:61], v[152:153] op_sel_hi:[1,0,1]
    v_pk_fma_f32 v[154:155], v[90:91], v[60:61], v[154:155] op_sel_hi:[1,0,1]
    s_waitcnt lgkmcnt(12)
    v_pk_fma_f32 v[156:157], v[92:93], v[62:63], v[156:157] op_sel_hi:[1,0,1]
    v_pk_fma_f32 v[158:159], v[94:95], v[62:63], v[158:159] op_sel_hi:[1,0,1]
    v_cvt_pk_bf16_f32 v128, v128, v129
    v_cvt_pk_bf16_f32 v129, v130, v131
    v_cvt_pk_bf16_f32 v130, v136, v137
    v_cvt_pk_bf16_f32 v131, v138, v139
    ds_write_b128 v8, v[128:131] offset:0
    v_cvt_pk_bf16_f32 v132, v132, v133
    v_cvt_pk_bf16_f32 v133, v134, v135
    v_cvt_pk_bf16_f32 v134, v140, v141
    v_cvt_pk_bf16_f32 v135, v142, v143
    ds_write_b128 v8, v[132:135] offset:1024
    v_cvt_pk_bf16_f32 v144, v144, v145
    v_cvt_pk_bf16_f32 v145, v146, v147
    v_cvt_pk_bf16_f32 v146, v152, v153
    v_cvt_pk_bf16_f32 v147, v154, v155
    ds_write_b128 v8, v[144:147] offset:2048
    v_cvt_pk_bf16_f32 v148, v148, v149
    v_cvt_pk_bf16_f32 v149, v150, v151
    v_cvt_pk_bf16_f32 v150, v156, v157
    v_cvt_pk_bf16_f32 v151, v158, v159
    ds_write_b128 v8, v[148:151] offset:3072
    v_bfe_u32 v16, v0, 2, 3
    v_lshrrev_b32 v17, 1, v16
    v_xor_b32 v17, s3, v17
    v_and_b32 v18, 3, v0
    v_lshlrev_b32 v18, 3, v18
    v_lshl_add_u32 v18, v16, 7, v18
    v_lshl_add_u32 v18, v17, 5, v18
    v_lshrrev_b32 v17, 5, v0
    v_lshl_add_u32 v4, v17, 10, v18
    v_add_u32 v5, 0x10000, v4
    v_add_u32 v6, 0x20000, v4
    v_add_u32 v2, s32, v1
    v_add_u32 v3, 0x10000, v2
    v_add_u32 v7, 0x20000, v2
    s_waitcnt vmcnt(0) lgkmcnt(0)
    s_barrier
    ds_read_b64_tr_b16 v[24:25], v6 offset:0
    ds_read_b64_tr_b16 v[26:27], v6 offset:2048
    ds_read_b128 a[0:3], v1 offset:16384
    ds_read_b128 a[4:7], v1 offset:17408
    ds_read_b128 a[8:11], v1 offset:0
    ds_read_b128 a[12:15], v1 offset:1024
    ds_read_b64_tr_b16 v[28:29], v6 offset:4096
    ds_read_b64_tr_b16 v[30:31], v6 offset:6144
    ds_read_b64_tr_b16 v[32:33], v6 offset:8192
    ds_read_b64_tr_b16 v[34:35], v6 offset:10240
    ds_read_b64_tr_b16 v[36:37], v6 offset:12288
    ds_read_b64_tr_b16 v[38:39], v6 offset:14336
    ds_read_b64_tr_b16 v[40:41], v6 offset:16384
    ds_read_b64_tr_b16 v[42:43], v6 offset:18432
    ds_read_b64_tr_b16 v[44:45], v6 offset:20480
    ds_read_b64_tr_b16 v[46:47], v6 offset:22528
    ds_read_b128 a[16:19], v1 offset:18432
    s_add_u32 m0, s32, 98304
    s_add_u32 s37, s62, 229376
    ds_read_b128 a[20:23], v1 offset:19456
    buffer_load_dwordx4 v10, s[24:27], s37 offen offset:0 lds
    s_add_u32 s37, s62, 235520
    ds_read_b128 a[24:27], v1 offset:2048
    buffer_load_dwordx4 v10, s[24:27], s37 offen offset:1024 lds
    s_add_u32 s37, s62, 241664
    ds_read_b128 a[28:31], v1 offset:3072
    buffer_load_dwordx4 v10, s[24:27], s37 offen offset:2048 lds
    s_add_u32 s37, s62, 247808
    ds_read_b128 a[32:35], v1 offset:20480
    buffer_load_dwordx4 v10, s[24:27], s37 offen offset:3072 lds
    s_add_u32 m0, s32, 102400
    ds_read_b128 a[36:39], v1 offset:21504
    s_add_u32 s37, s62, 258048
    buffer_load_dwordx4 v10, s[24:27], s37 offen offset:0 lds
    ds_read_b128 a[40:43], v1 offset:4096
    s_add_u32 s37, s62, 264192
    buffer_load_dwordx4 v10, s[24:27], s37 offen offset:1024 lds
    ds_read_b128 a[44:47], v1 offset:5120
    s_add_u32 s37, s62, 270336
    buffer_load_dwordx4 v10, s[24:27], s37 offen offset:2048 lds
    ds_read_b128 a[48:51], v1 offset:22528
    s_add_u32 s37, s62, 276480
    buffer_load_dwordx4 v10, s[24:27], s37 offen offset:3072 lds
    ds_read_b128 a[52:55], v1 offset:23552
    s_add_u32 m0, s32, 65536
    s_add_u32 s37, s63, 0
    ds_read_b128 a[56:59], v1 offset:6144
    buffer_load_dwordx4 v10, s[24:27], s37 offen offset:0 lds
    s_add_u32 s37, s63, 6144
    ds_read_b128 a[60:63], v1 offset:7168
    buffer_load_dwordx4 v10, s[24:27], s37 offen offset:1024 lds
    s_add_u32 s37, s63, 12288
    ds_read_b128 a[64:67], v1 offset:24576
    buffer_load_dwordx4 v10, s[24:27], s37 offen offset:2048 lds
    s_add_u32 s37, s63, 18432
    ds_read_b128 a[68:71], v1 offset:25600
    buffer_load_dwordx4 v10, s[24:27], s37 offen offset:3072 lds
    s_add_u32 m0, s32, 69632
    ds_read_b128 a[72:75], v1 offset:8192
    s_add_u32 s37, s63, 28672
    buffer_load_dwordx4 v10, s[24:27], s37 offen offset:0 lds
    ds_read_b128 a[76:79], v1 offset:9216
    s_add_u32 s37, s63, 34816
    buffer_load_dwordx4 v10, s[24:27], s37 offen offset:1024 lds
    ds_read_b128 a[80:83], v1 offset:26624
    s_add_u32 s37, s63, 40960
    buffer_load_dwordx4 v10, s[24:27], s37 offen offset:2048 lds
    ds_read_b128 a[84:87], v1 offset:27648
    s_add_u32 s37, s63, 47104
    buffer_load_dwordx4 v10, s[24:27], s37 offen offset:3072 lds
    ds_read_b128 a[88:91], v1 offset:10240
    ds_read_b128 a[92:95], v1 offset:11264
    s_waitcnt lgkmcnt(15)
    v_mfma_f32_16x16x32_bf16 v[76:79], v[24:27], a[12:15], 0
    ds_read_b64_tr_b16 v[48:49], v6 offset:24576
    ds_read_b64_tr_b16 v[50:51], v6 offset:26624
    v_mfma_f32_16x16x32_bf16 v[72:75], v[24:27], a[8:11], 0
    ds_read_b128 a[96:99], v1 offset:28672
    ds_read_b128 a[100:103], v1 offset:29696
    v_mfma_f32_16x16x32_bf16 v[68:71], v[24:27], a[4:7], 0
    ds_read_b64_tr_b16 v[52:53], v6 offset:28672
    ds_read_b64_tr_b16 v[54:55], v6 offset:30720
    v_mfma_f32_16x16x32_bf16 v[64:67], v[24:27], a[0:3], 0
    ds_read_b128 a[104:107], v1 offset:12288
    ds_read_b128 a[108:111], v1 offset:13312
    v_mfma_f32_16x16x32_bf16 v[64:67], v[28:31], a[16:19], v[64:67]
    ds_read_b128 a[112:115], v1 offset:30720
    ds_read_b128 a[116:119], v1 offset:31744
    v_mfma_f32_16x16x32_bf16 v[68:71], v[28:31], a[20:23], v[68:71]
    ds_read_b128 a[120:123], v1 offset:14336
    ds_read_b128 a[124:127], v1 offset:15360
    v_mfma_f32_16x16x32_bf16 v[72:75], v[28:31], a[24:27], v[72:75]
    ds_read_b128 a[128:131], v1 offset:49152
    ds_read_b128 a[132:135], v1 offset:50176
    v_mfma_f32_16x16x32_bf16 v[76:79], v[28:31], a[28:31], v[76:79]
    s_waitcnt lgkmcnt(15)
    ds_read_b128 a[136:139], v1 offset:32768
    ds_read_b128 a[140:143], v1 offset:33792
    v_mfma_f32_16x16x32_bf16 v[76:79], v[32:35], a[44:47], v[76:79]
    ds_read_b128 a[144:147], v1 offset:51200
    ds_read_b128 a[148:151], v1 offset:52224
    v_mfma_f32_16x16x32_bf16 v[72:75], v[32:35], a[40:43], v[72:75]
    ds_read_b128 a[152:155], v1 offset:34816
    ds_read_b128 a[156:159], v1 offset:35840
    v_mfma_f32_16x16x32_bf16 v[68:71], v[32:35], a[36:39], v[68:71]
    ds_read_b128 a[160:163], v1 offset:53248
    ds_read_b128 a[164:167], v1 offset:54272
    v_mfma_f32_16x16x32_bf16 v[64:67], v[32:35], a[32:35], v[64:67]
    ds_read_b128 a[168:171], v1 offset:36864
    ds_read_b128 a[172:175], v1 offset:37888
    v_mfma_f32_16x16x32_bf16 v[64:67], v[36:39], a[48:51], v[64:67]
    ds_read_b128 a[176:179], v1 offset:55296
    ds_read_b128 a[180:183], v1 offset:56320
    v_mfma_f32_16x16x32_bf16 v[68:71], v[36:39], a[52:55], v[68:71]
    ds_read_b128 a[184:187], v1 offset:38912
    ds_read_b128 a[188:191], v1 offset:39936
    v_mfma_f32_16x16x32_bf16 v[72:75], v[36:39], a[56:59], v[72:75]
    ds_read_b128 a[192:195], v1 offset:57344
    ds_read_b128 a[196:199], v1 offset:58368
    v_mfma_f32_16x16x32_bf16 v[76:79], v[36:39], a[60:63], v[76:79]
    ds_read_b128 a[200:203], v1 offset:40960
    ds_read_b128 a[204:207], v1 offset:41984
    v_mfma_f32_16x16x32_bf16 v[76:79], v[40:43], a[76:79], v[76:79]
    ds_read_b128 a[208:211], v1 offset:59392
    ds_read_b128 a[212:215], v1 offset:60416
    v_mfma_f32_16x16x32_bf16 v[72:75], v[40:43], a[72:75], v[72:75]
    ds_read_b128 a[216:219], v1 offset:43008
    ds_read_b128 a[220:223], v1 offset:44032
    v_mfma_f32_16x16x32_bf16 v[68:71], v[40:43], a[68:71], v[68:71]
    ds_read_b128 a[224:227], v1 offset:61440
    ds_read_b128 a[228:231], v1 offset:62464
    v_mfma_f32_16x16x32_bf16 v[64:67], v[40:43], a[64:67], v[64:67]
    s_waitcnt lgkmcnt(15)
    ds_read_b128 a[232:235], v1 offset:45056
    ds_read_b128 a[236:239], v1 offset:46080
    v_mfma_f32_16x16x32_bf16 v[64:67], v[44:47], a[80:83], v[64:67]
    s_waitcnt vmcnt(8)
    s_barrier
    ds_read_b128 a[240:243], v1 offset:63488
    v_mfma_f32_16x16x32_bf16 v[68:71], v[44:47], a[84:87], v[68:71]
    ds_read_b64_tr_b16 v[24:25], v5 offset:32768
    ds_read_b64_tr_b16 v[26:27], v5 offset:34816
    v_mfma_f32_16x16x32_bf16 v[72:75], v[44:47], a[88:91], v[72:75]
    ds_read_b128 a[244:247], v1 offset:64512
    ds_read_b128 a[248:251], v1 offset:47104
    v_mfma_f32_16x16x32_bf16 v[76:79], v[44:47], a[92:95], v[76:79]
    ds_read_b64_tr_b16 v[28:29], v5 offset:36864
    ds_read_b64_tr_b16 v[30:31], v5 offset:38912
    v_mfma_f32_16x16x32_bf16 v[76:79], v[48:51], a[108:111], v[76:79]
    ds_read_b128 a[252:255], v1 offset:48128
    v_mfma_f32_16x16x32_bf16 v[72:75], v[48:51], a[104:107], v[72:75]
    ds_read_b64_tr_b16 v[32:33], v5 offset:40960
    ds_read_b64_tr_b16 v[34:35], v5 offset:43008
    v_mfma_f32_16x16x32_bf16 v[68:71], v[48:51], a[100:103], v[68:71]
    v_mfma_f32_16x16x32_bf16 v[64:67], v[48:51], a[96:99], v[64:67]
    ds_read_b64_tr_b16 v[36:37], v5 offset:45056
    ds_read_b64_tr_b16 v[38:39], v5 offset:47104
    v_mfma_f32_16x16x32_bf16 v[64:67], v[52:55], a[112:115], v[64:67]
    v_mfma_f32_16x16x32_bf16 v[68:71], v[52:55], a[116:119], v[68:71]
    ds_read_b64_tr_b16 v[40:41], v5 offset:49152
    ds_read_b64_tr_b16 v[42:43], v5 offset:51200
    v_mfma_f32_16x16x32_bf16 v[72:75], v[52:55], a[120:123], v[72:75]
    v_mfma_f32_16x16x32_bf16 v[76:79], v[52:55], a[124:127], v[76:79]
    s_waitcnt lgkmcnt(11)
    ds_read_b64_tr_b16 v[44:45], v5 offset:53248
    ds_read_b64_tr_b16 v[46:47], v5 offset:55296
    v_mfma_f32_16x16x32_bf16 v[76:79], v[24:27], a[140:143], v[76:79]
    v_mfma_f32_16x16x32_bf16 v[72:75], v[24:27], a[136:139], v[72:75]
    ds_read_b64_tr_b16 v[48:49], v5 offset:57344
    ds_read_b64_tr_b16 v[50:51], v5 offset:59392
    v_mfma_f32_16x16x32_bf16 v[68:71], v[24:27], a[132:135], v[68:71]
    v_mfma_f32_16x16x32_bf16 v[64:67], v[24:27], a[128:131], v[64:67]
    s_waitcnt lgkmcnt(11)
    ds_read_b64_tr_b16 v[24:25], v5 offset:61440
    ds_read_b64_tr_b16 v[26:27], v5 offset:63488
    v_mfma_f32_16x16x32_bf16 v[64:67], v[28:31], a[144:147], v[64:67]
    v_mfma_f32_16x16x32_bf16 v[68:71], v[28:31], a[148:151], v[68:71]
    v_mfma_f32_16x16x32_bf16 v[72:75], v[28:31], a[152:155], v[72:75]
    s_waitcnt lgkmcnt(12)
    s_barrier
    v_mfma_f32_16x16x32_bf16 v[76:79], v[28:31], a[156:159], v[76:79]
    s_waitcnt lgkmcnt(10)
    s_add_u32 m0, s32, 0
    v_mfma_f32_16x16x32_bf16 v[76:79], v[32:35], a[172:175], v[76:79]
    s_add_u32 s37, s63, 229376
    buffer_load_dwordx4 v10, s[24:27], s37 offen offset:0 lds
    v_mfma_f32_16x16x32_bf16 v[72:75], v[32:35], a[168:171], v[72:75]
    v_mfma_f32_16x16x32_bf16 v[68:71], v[32:35], a[164:167], v[68:71]
    s_add_u32 s37, s63, 235520
    v_mfma_f32_16x16x32_bf16 v[64:67], v[32:35], a[160:163], v[64:67]
    s_waitcnt lgkmcnt(8)
    buffer_load_dwordx4 v10, s[24:27], s37 offen offset:1024 lds
    v_mfma_f32_16x16x32_bf16 v[64:67], v[36:39], a[176:179], v[64:67]
    v_mfma_f32_16x16x32_bf16 v[68:71], v[36:39], a[180:183], v[68:71]
    v_mfma_f32_16x16x32_bf16 v[72:75], v[36:39], a[184:187], v[72:75]
    s_add_u32 s37, s63, 241664
    buffer_load_dwordx4 v10, s[24:27], s37 offen offset:2048 lds
    v_mfma_f32_16x16x32_bf16 v[76:79], v[36:39], a[188:191], v[76:79]
    s_waitcnt lgkmcnt(6)
    v_mfma_f32_16x16x32_bf16 v[76:79], v[40:43], a[204:207], v[76:79]
    v_mfma_f32_16x16x32_bf16 v[72:75], v[40:43], a[200:203], v[72:75]
    s_add_u32 s37, s63, 247808
    buffer_load_dwordx4 v10, s[24:27], s37 offen offset:3072 lds
    v_mfma_f32_16x16x32_bf16 v[68:71], v[40:43], a[196:199], v[68:71]
    v_mfma_f32_16x16x32_bf16 v[64:67], v[40:43], a[192:195], v[64:67]
    s_waitcnt lgkmcnt(4)
    v_mfma_f32_16x16x32_bf16 v[64:67], v[44:47], a[208:211], v[64:67]
    s_waitcnt vmcnt(4) lgkmcnt(0)
    s_barrier
    v_mfma_f32_16x16x32_bf16 v[68:71], v[44:47], a[212:215], v[68:71]
    s_add_u32 m0, s32, 4096
    ds_read_b64_tr_b16 v[28:29], v5 offset:0
    ds_read_b64_tr_b16 v[30:31], v5 offset:2048
    v_mfma_f32_16x16x32_bf16 v[72:75], v[44:47], a[216:219], v[72:75]
    s_add_u32 s37, s63, 258048
    buffer_load_dwordx4 v10, s[24:27], s37 offen offset:0 lds
    v_mfma_f32_16x16x32_bf16 v[76:79], v[44:47], a[220:223], v[76:79]
    ds_read_b64_tr_b16 v[32:33], v5 offset:4096
    ds_read_b64_tr_b16 v[34:35], v5 offset:6144
    v_mfma_f32_16x16x32_bf16 v[76:79], v[48:51], a[236:239], v[76:79]
    v_mfma_f32_16x16x32_bf16 v[72:75], v[48:51], a[232:235], v[72:75]
    ds_read_b64_tr_b16 v[36:37], v5 offset:8192
    ds_read_b64_tr_b16 v[38:39], v5 offset:10240
    v_mfma_f32_16x16x32_bf16 v[68:71], v[48:51], a[228:231], v[68:71]
    s_add_u32 s37, s63, 264192
    buffer_load_dwordx4 v10, s[24:27], s37 offen offset:1024 lds
    v_mfma_f32_16x16x32_bf16 v[64:67], v[48:51], a[224:227], v[64:67]
    ds_read_b64_tr_b16 v[40:41], v5 offset:12288
    ds_read_b64_tr_b16 v[42:43], v5 offset:14336
    v_mfma_f32_16x16x32_bf16 v[64:67], v[24:27], a[240:243], v[64:67]
    v_mfma_f32_16x16x32_bf16 v[68:71], v[24:27], a[244:247], v[68:71]
    ds_read_b64_tr_b16 v[44:45], v5 offset:16384
    ds_read_b64_tr_b16 v[46:47], v5 offset:18432
    v_mfma_f32_16x16x32_bf16 v[72:75], v[24:27], a[248:251], v[72:75]
    s_add_u32 s37, s63, 270336
    buffer_load_dwordx4 v10, s[24:27], s37 offen offset:2048 lds
    v_mfma_f32_16x16x32_bf16 v[76:79], v[24:27], a[252:255], v[76:79]
    s_waitcnt lgkmcnt(8)
    ds_read_b64_tr_b16 v[24:25], v5 offset:20480
    ds_read_b64_tr_b16 v[26:27], v5 offset:22528
    v_mfma_f32_16x16x32_bf16 v[92:95], v[28:31], a[12:15], 0
    v_mfma_f32_16x16x32_bf16 v[88:91], v[28:31], a[8:11], 0
    ds_read_b64_tr_b16 v[48:49], v5 offset:24576
    ds_read_b64_tr_b16 v[50:51], v5 offset:26624
    v_mfma_f32_16x16x32_bf16 v[84:87], v[28:31], a[4:7], 0
    s_add_u32 s37, s63, 276480
    buffer_load_dwordx4 v10, s[24:27], s37 offen offset:3072 lds
    v_mfma_f32_16x16x32_bf16 v[80:83], v[28:31], a[0:3], 0
    s_waitcnt lgkmcnt(10)
    ds_read_b64_tr_b16 v[28:29], v5 offset:28672
    ds_read_b64_tr_b16 v[30:31], v5 offset:30720
    v_mfma_f32_16x16x32_bf16 v[80:83], v[32:35], a[16:19], v[80:83]
    s_add_u32 m0, s32, 32768
    v_mfma_f32_16x16x32_bf16 v[84:87], v[32:35], a[20:23], v[84:87]
    s_add_u32 s37, s64, 0
    buffer_load_dwordx4 v10, s[24:27], s37 offen offset:0 lds
    v_mfma_f32_16x16x32_bf16 v[88:91], v[32:35], a[24:27], v[88:91]
    v_cvt_pk_bf16_f32 v96, v64, v65
    v_mfma_f32_16x16x32_bf16 v[92:95], v[32:35], a[28:31], v[92:95]
    s_waitcnt lgkmcnt(10)
    v_cvt_pk_bf16_f32 v97, v66, v67
    v_mfma_f32_16x16x32_bf16 v[92:95], v[36:39], a[44:47], v[92:95]
    s_add_u32 s37, s64, 6144
    buffer_load_dwordx4 v10, s[24:27], s37 offen offset:1024 lds
    v_mfma_f32_16x16x32_bf16 v[88:91], v[36:39], a[40:43], v[88:91]
    v_cvt_pk_bf16_f32 v98, v68, v69
    v_mfma_f32_16x16x32_bf16 v[84:87], v[36:39], a[36:39], v[84:87]
    s_add_u32 s37, s64, 12288
    v_cvt_pk_bf16_f32 v99, v70, v71
    v_mfma_f32_16x16x32_bf16 v[80:83], v[36:39], a[32:35], v[80:83]
    s_waitcnt lgkmcnt(8)
    buffer_load_dwordx4 v10, s[24:27], s37 offen offset:2048 lds
    v_mfma_f32_16x16x32_bf16 v[80:83], v[40:43], a[48:51], v[80:83]
    v_cvt_pk_bf16_f32 v100, v72, v73
    v_mfma_f32_16x16x32_bf16 v[84:87], v[40:43], a[52:55], v[84:87]
    v_cvt_pk_bf16_f32 v101, v74, v75
    v_mfma_f32_16x16x32_bf16 v[88:91], v[40:43], a[56:59], v[88:91]
    s_add_u32 s37, s64, 18432
    buffer_load_dwordx4 v10, s[24:27], s37 offen offset:3072 lds
    v_mfma_f32_16x16x32_bf16 v[92:95], v[40:43], a[60:63], v[92:95]
    s_waitcnt lgkmcnt(6)
    v_cvt_pk_bf16_f32 v102, v76, v77
    v_mfma_f32_16x16x32_bf16 v[92:95], v[44:47], a[76:79], v[92:95]
    s_add_u32 m0, s32, 36864
    v_cvt_pk_bf16_f32 v103, v78, v79
    v_mfma_f32_16x16x32_bf16 v[88:91], v[44:47], a[72:75], v[88:91]
    s_add_u32 s37, s64, 28672
    buffer_load_dwordx4 v10, s[24:27], s37 offen offset:0 lds
    v_mfma_f32_16x16x32_bf16 v[84:87], v[44:47], a[68:71], v[84:87]
    v_permlane16_swap_b32 v96, v98
    v_mfma_f32_16x16x32_bf16 v[80:83], v[44:47], a[64:67], v[80:83]
    s_waitcnt lgkmcnt(4)
    v_permlane16_swap_b32 v97, v99
    v_mfma_f32_16x16x32_bf16 v[80:83], v[24:27], a[80:83], v[80:83]
    s_waitcnt vmcnt(5) lgkmcnt(0)
    s_barrier
    v_permlane16_swap_b32 v100, v102
    v_mfma_f32_16x16x32_bf16 v[84:87], v[24:27], a[84:87], v[84:87]
    ds_read_b64_tr_b16 v[32:33], v4 offset:0
    ds_read_b64_tr_b16 v[34:35], v4 offset:2048
    v_mfma_f32_16x16x32_bf16 v[88:91], v[24:27], a[88:91], v[88:91]
    s_add_u32 s37, s64, 34816
    buffer_load_dwordx4 v10, s[24:27], s37 offen offset:1024 lds
    v_mfma_f32_16x16x32_bf16 v[92:95], v[24:27], a[92:95], v[92:95]
    ds_read_b64_tr_b16 v[24:25], v4 offset:4096
    ds_read_b64_tr_b16 v[26:27], v4 offset:6144
    v_mfma_f32_16x16x32_bf16 v[92:95], v[48:51], a[108:111], v[92:95]
    v_permlane16_swap_b32 v101, v103
    v_mfma_f32_16x16x32_bf16 v[88:91], v[48:51], a[104:107], v[88:91]
    s_lshl_b32 s39, s40, 13
    ds_read_b64_tr_b16 v[36:37], v4 offset:8192
    ds_read_b64_tr_b16 v[38:39], v4 offset:10240
    v_mfma_f32_16x16x32_bf16 v[84:87], v[48:51], a[100:103], v[84:87]
    s_add_u32 s37, s64, 40960
    buffer_load_dwordx4 v10, s[24:27], s37 offen offset:2048 lds
    v_mfma_f32_16x16x32_bf16 v[80:83], v[48:51], a[96:99], v[80:83]
    ds_read_b64_tr_b16 v[40:41], v4 offset:12288
    ds_read_b64_tr_b16 v[42:43], v4 offset:14336
    v_mfma_f32_16x16x32_bf16 v[80:83], v[28:31], a[112:115], v[80:83]
    buffer_store_dwordx4 v[96:99], v1, s[28:31], s39 offen offset:0 sc1
    v_mfma_f32_16x16x32_bf16 v[84:87], v[28:31], a[116:119], v[84:87]
    ds_read_b64_tr_b16 v[44:45], v4 offset:16384
    ds_read_b64_tr_b16 v[46:47], v4 offset:18432
    v_mfma_f32_16x16x32_bf16 v[88:91], v[28:31], a[120:123], v[88:91]
    s_add_u32 s37, s64, 47104
    buffer_load_dwordx4 v10, s[24:27], s37 offen offset:3072 lds
    v_mfma_f32_16x16x32_bf16 v[92:95], v[28:31], a[124:127], v[92:95]
    s_waitcnt lgkmcnt(8)
    ds_read_b64_tr_b16 v[28:29], v4 offset:20480
    ds_read_b64_tr_b16 v[30:31], v4 offset:22528
    v_mfma_f32_16x16x32_bf16 v[92:95], v[32:35], a[140:143], v[92:95]
    buffer_store_dwordx4 v[100:103], v1, s[28:31], s39 offen offset:1024 sc1
    v_mfma_f32_16x16x32_bf16 v[88:91], v[32:35], a[136:139], v[88:91]
    s_add_u32 m0, s32, 131072
    ds_read_b64_tr_b16 v[48:49], v4 offset:24576
    ds_read_b64_tr_b16 v[50:51], v4 offset:26624
    v_mfma_f32_16x16x32_bf16 v[84:87], v[32:35], a[132:135], v[84:87]
    s_add_u32 s37, s64, 229376
    buffer_load_dwordx4 v10, s[24:27], s37 offen offset:0 lds
    v_mfma_f32_16x16x32_bf16 v[80:83], v[32:35], a[128:131], v[80:83]
    s_waitcnt lgkmcnt(10)
    ds_read_b64_tr_b16 v[32:33], v4 offset:28672
    ds_read_b64_tr_b16 v[34:35], v4 offset:30720
    v_mfma_f32_16x16x32_bf16 v[80:83], v[24:27], a[144:147], v[80:83]
    v_mfma_f32_16x16x32_bf16 v[84:87], v[24:27], a[148:151], v[84:87]
    s_add_u32 s37, s64, 235520
    buffer_load_dwordx4 v10, s[24:27], s37 offen offset:1024 lds
    v_mfma_f32_16x16x32_bf16 v[88:91], v[24:27], a[152:155], v[88:91]
    v_mfma_f32_16x16x32_bf16 v[92:95], v[24:27], a[156:159], v[92:95]
    s_waitcnt lgkmcnt(10)
    v_mfma_f32_16x16x32_bf16 v[92:95], v[36:39], a[172:175], v[92:95]
    s_add_u32 s37, s64, 241664
    buffer_load_dwordx4 v10, s[24:27], s37 offen offset:2048 lds
    v_mfma_f32_16x16x32_bf16 v[88:91], v[36:39], a[168:171], v[88:91]
    v_mfma_f32_16x16x32_bf16 v[84:87], v[36:39], a[164:167], v[84:87]
    s_add_u32 s37, s64, 247808
    v_mfma_f32_16x16x32_bf16 v[80:83], v[36:39], a[160:163], v[80:83]
    s_waitcnt lgkmcnt(8)
    buffer_load_dwordx4 v10, s[24:27], s37 offen offset:3072 lds
    v_mfma_f32_16x16x32_bf16 v[80:83], v[40:43], a[176:179], v[80:83]
    v_mfma_f32_16x16x32_bf16 v[84:87], v[40:43], a[180:183], v[84:87]
    s_add_u32 m0, s32, 135168
    v_mfma_f32_16x16x32_bf16 v[88:91], v[40:43], a[184:187], v[88:91]
    s_add_u32 s37, s64, 258048
    buffer_load_dwordx4 v10, s[24:27], s37 offen offset:0 lds
    v_mfma_f32_16x16x32_bf16 v[92:95], v[40:43], a[188:191], v[92:95]
    s_waitcnt lgkmcnt(6)
    v_mfma_f32_16x16x32_bf16 v[92:95], v[44:47], a[204:207], v[92:95]
    v_mfma_f32_16x16x32_bf16 v[88:91], v[44:47], a[200:203], v[88:91]
    s_add_u32 s37, s64, 264192
    buffer_load_dwordx4 v10, s[24:27], s37 offen offset:1024 lds
    v_mfma_f32_16x16x32_bf16 v[84:87], v[44:47], a[196:199], v[84:87]
    v_mfma_f32_16x16x32_bf16 v[80:83], v[44:47], a[192:195], v[80:83]
    s_waitcnt lgkmcnt(4)
    v_mfma_f32_16x16x32_bf16 v[80:83], v[28:31], a[208:211], v[80:83]
    s_waitcnt vmcnt(7) lgkmcnt(0)
    s_barrier
    v_mfma_f32_16x16x32_bf16 v[84:87], v[28:31], a[212:215], v[84:87]
    ds_read_b64_tr_b16 v[24:25], v4 offset:32768
    ds_read_b64_tr_b16 v[26:27], v4 offset:34816
    v_mfma_f32_16x16x32_bf16 v[88:91], v[28:31], a[216:219], v[88:91]
    s_add_u32 s37, s64, 270336
    buffer_load_dwordx4 v10, s[24:27], s37 offen offset:2048 lds
    v_mfma_f32_16x16x32_bf16 v[92:95], v[28:31], a[220:223], v[92:95]
    ds_read_b64_tr_b16 v[28:29], v4 offset:36864
    ds_read_b64_tr_b16 v[30:31], v4 offset:38912
    v_mfma_f32_16x16x32_bf16 v[92:95], v[48:51], a[236:239], v[92:95]
    v_mfma_f32_16x16x32_bf16 v[88:91], v[48:51], a[232:235], v[88:91]
    ds_read_b64_tr_b16 v[36:37], v4 offset:40960
    ds_read_b64_tr_b16 v[38:39], v4 offset:43008
    v_mfma_f32_16x16x32_bf16 v[84:87], v[48:51], a[228:231], v[84:87]
    s_add_u32 s37, s64, 276480
    buffer_load_dwordx4 v10, s[24:27], s37 offen offset:3072 lds
    v_mfma_f32_16x16x32_bf16 v[80:83], v[48:51], a[224:227], v[80:83]
    ds_read_b64_tr_b16 v[40:41], v4 offset:45056
    ds_read_b64_tr_b16 v[42:43], v4 offset:47104
    v_mfma_f32_16x16x32_bf16 v[80:83], v[32:35], a[240:243], v[80:83]
    v_mfma_f32_16x16x32_bf16 v[84:87], v[32:35], a[244:247], v[84:87]
    s_add_u32 m0, s32, 98304
    ds_read_b64_tr_b16 v[44:45], v4 offset:49152
    ds_read_b64_tr_b16 v[46:47], v4 offset:51200
    v_mfma_f32_16x16x32_bf16 v[88:91], v[32:35], a[248:251], v[88:91]
    s_add_u32 s37, s65, 0
    buffer_load_dwordx4 v10, s[24:27], s37 offen offset:0 lds
    v_mfma_f32_16x16x32_bf16 v[92:95], v[32:35], a[252:255], v[92:95]
    s_waitcnt lgkmcnt(8)
    ds_read_b64_tr_b16 v[32:33], v4 offset:53248
    ds_read_b64_tr_b16 v[34:35], v4 offset:55296
    v_mfma_f32_16x16x32_bf16 v[76:79], v[24:27], a[12:15], 0
    v_mfma_f32_16x16x32_bf16 v[72:75], v[24:27], a[8:11], 0
    ds_read_b64_tr_b16 v[48:49], v4 offset:57344
    ds_read_b64_tr_b16 v[50:51], v4 offset:59392
    v_mfma_f32_16x16x32_bf16 v[68:71], v[24:27], a[4:7], 0
    s_add_u32 s37, s65, 6144
    buffer_load_dwordx4 v10, s[24:27], s37 offen offset:1024 lds
    v_mfma_f32_16x16x32_bf16 v[64:67], v[24:27], a[0:3], 0
    s_waitcnt lgkmcnt(10)
    ds_read_b64_tr_b16 v[24:25], v4 offset:61440
    ds_read_b64_tr_b16 v[26:27], v4 offset:63488
    v_mfma_f32_16x16x32_bf16 v[64:67], v[28:31], a[16:19], v[64:67]
    v_mfma_f32_16x16x32_bf16 v[68:71], v[28:31], a[20:23], v[68:71]
    s_add_u32 s37, s65, 12288
    buffer_load_dwordx4 v10, s[24:27], s37 offen offset:2048 lds
    v_mfma_f32_16x16x32_bf16 v[72:75], v[28:31], a[24:27], v[72:75]
    v_cvt_pk_bf16_f32 v104, v80, v81
    v_mfma_f32_16x16x32_bf16 v[76:79], v[28:31], a[28:31], v[76:79]
    s_waitcnt lgkmcnt(10)
    v_cvt_pk_bf16_f32 v105, v82, v83
    v_mfma_f32_16x16x32_bf16 v[76:79], v[36:39], a[44:47], v[76:79]
    s_add_u32 s37, s65, 18432
    buffer_load_dwordx4 v10, s[24:27], s37 offen offset:3072 lds
    v_mfma_f32_16x16x32_bf16 v[72:75], v[36:39], a[40:43], v[72:75]
    v_cvt_pk_bf16_f32 v106, v84, v85
    v_mfma_f32_16x16x32_bf16 v[68:71], v[36:39], a[36:39], v[68:71]
    s_add_u32 m0, s32, 102400
    s_add_u32 s37, s65, 28672
    v_cvt_pk_bf16_f32 v107, v86, v87
    v_mfma_f32_16x16x32_bf16 v[64:67], v[36:39], a[32:35], v[64:67]
    s_waitcnt lgkmcnt(8)
    buffer_load_dwordx4 v10, s[24:27], s37 offen offset:0 lds
    v_mfma_f32_16x16x32_bf16 v[64:67], v[40:43], a[48:51], v[64:67]
    v_cvt_pk_bf16_f32 v108, v88, v89
    v_mfma_f32_16x16x32_bf16 v[68:71], v[40:43], a[52:55], v[68:71]
    v_cvt_pk_bf16_f32 v109, v90, v91
    v_mfma_f32_16x16x32_bf16 v[72:75], v[40:43], a[56:59], v[72:75]
    s_add_u32 s37, s65, 34816
    buffer_load_dwordx4 v10, s[24:27], s37 offen offset:1024 lds
    v_mfma_f32_16x16x32_bf16 v[76:79], v[40:43], a[60:63], v[76:79]
    s_waitcnt lgkmcnt(6)
    v_cvt_pk_bf16_f32 v110, v92, v93
    v_mfma_f32_16x16x32_bf16 v[76:79], v[44:47], a[76:79], v[76:79]
    v_cvt_pk_bf16_f32 v111, v94, v95
    v_mfma_f32_16x16x32_bf16 v[72:75], v[44:47], a[72:75], v[72:75]
    s_add_u32 s37, s65, 40960
    buffer_load_dwordx4 v10, s[24:27], s37 offen offset:2048 lds
    v_mfma_f32_16x16x32_bf16 v[68:71], v[44:47], a[68:71], v[68:71]
    v_permlane16_swap_b32 v104, v106
    v_mfma_f32_16x16x32_bf16 v[64:67], v[44:47], a[64:67], v[64:67]
    s_waitcnt lgkmcnt(4)
    v_permlane16_swap_b32 v105, v107
    v_mfma_f32_16x16x32_bf16 v[64:67], v[32:35], a[80:83], v[64:67]
    s_waitcnt vmcnt(7) lgkmcnt(0)
    s_barrier
    v_permlane16_swap_b32 v108, v110
    v_mfma_f32_16x16x32_bf16 v[68:71], v[32:35], a[84:87], v[68:71]
    ds_read_b64_tr_b16 v[28:29], v6 offset:0
    ds_read_b64_tr_b16 v[30:31], v6 offset:2048
    v_mfma_f32_16x16x32_bf16 v[72:75], v[32:35], a[88:91], v[72:75]
    s_add_u32 s37, s65, 47104
    buffer_load_dwordx4 v10, s[24:27], s37 offen offset:3072 lds
    v_mfma_f32_16x16x32_bf16 v[76:79], v[32:35], a[92:95], v[76:79]
    ds_read_b64_tr_b16 v[32:33], v6 offset:4096
    ds_read_b64_tr_b16 v[34:35], v6 offset:6144
    v_mfma_f32_16x16x32_bf16 v[76:79], v[48:51], a[108:111], v[76:79]
    v_permlane16_swap_b32 v109, v111
    v_mfma_f32_16x16x32_bf16 v[72:75], v[48:51], a[104:107], v[72:75]
    s_add_u32 m0, s32, 65536
    ds_read_b64_tr_b16 v[36:37], v6 offset:8192
    ds_read_b64_tr_b16 v[38:39], v6 offset:10240
    v_mfma_f32_16x16x32_bf16 v[68:71], v[48:51], a[100:103], v[68:71]
    s_add_u32 s37, s65, 229376
    buffer_load_dwordx4 v10, s[24:27], s37 offen offset:0 lds
    v_mfma_f32_16x16x32_bf16 v[64:67], v[48:51], a[96:99], v[64:67]
    ds_read_b64_tr_b16 v[40:41], v6 offset:12288
    ds_read_b64_tr_b16 v[42:43], v6 offset:14336
    v_mfma_f32_16x16x32_bf16 v[64:67], v[24:27], a[112:115], v[64:67]
    s_lshl_b32 s39, s41, 13
    v_mfma_f32_16x16x32_bf16 v[68:71], v[24:27], a[116:119], v[68:71]
    ds_read_b64_tr_b16 v[44:45], v6 offset:16384
    ds_read_b64_tr_b16 v[46:47], v6 offset:18432
    v_mfma_f32_16x16x32_bf16 v[72:75], v[24:27], a[120:123], v[72:75]
    s_add_u32 s37, s65, 235520
    buffer_load_dwordx4 v10, s[24:27], s37 offen offset:1024 lds
    v_mfma_f32_16x16x32_bf16 v[76:79], v[24:27], a[124:127], v[76:79]
    s_waitcnt lgkmcnt(8)
    ds_read_b64_tr_b16 v[24:25], v6 offset:20480
    ds_read_b64_tr_b16 v[26:27], v6 offset:22528
    v_mfma_f32_16x16x32_bf16 v[76:79], v[28:31], a[140:143], v[76:79]
    buffer_store_dwordx4 v[104:107], v1, s[28:31], s39 offen offset:0 sc1
    v_mfma_f32_16x16x32_bf16 v[72:75], v[28:31], a[136:139], v[72:75]
    ds_read_b64_tr_b16 v[48:49], v6 offset:24576
    ds_read_b64_tr_b16 v[50:51], v6 offset:26624
    v_mfma_f32_16x16x32_bf16 v[68:71], v[28:31], a[132:135], v[68:71]
    s_add_u32 s37, s65, 241664
    buffer_load_dwordx4 v10, s[24:27], s37 offen offset:2048 lds
    v_mfma_f32_16x16x32_bf16 v[64:67], v[28:31], a[128:131], v[64:67]
    s_waitcnt lgkmcnt(10)
    ds_read_b64_tr_b16 v[28:29], v6 offset:28672
    ds_read_b64_tr_b16 v[30:31], v6 offset:30720
    v_mfma_f32_16x16x32_bf16 v[64:67], v[32:35], a[144:147], v[64:67]
    buffer_store_dwordx4 v[108:111], v1, s[28:31], s39 offen offset:1024 sc1
    v_mfma_f32_16x16x32_bf16 v[68:71], v[32:35], a[148:151], v[68:71]
    s_add_u32 s37, s65, 247808
    buffer_load_dwordx4 v10, s[24:27], s37 offen offset:3072 lds
    v_mfma_f32_16x16x32_bf16 v[72:75], v[32:35], a[152:155], v[72:75]
    v_mfma_f32_16x16x32_bf16 v[76:79], v[32:35], a[156:159], v[76:79]
    s_waitcnt lgkmcnt(10)
    s_add_u32 m0, s32, 69632
    v_mfma_f32_16x16x32_bf16 v[76:79], v[36:39], a[172:175], v[76:79]
    s_add_u32 s37, s65, 258048
    buffer_load_dwordx4 v10, s[24:27], s37 offen offset:0 lds
    v_mfma_f32_16x16x32_bf16 v[72:75], v[36:39], a[168:171], v[72:75]
    v_mfma_f32_16x16x32_bf16 v[68:71], v[36:39], a[164:167], v[68:71]
    s_add_u32 s37, s65, 264192
    v_mfma_f32_16x16x32_bf16 v[64:67], v[36:39], a[160:163], v[64:67]
    s_waitcnt lgkmcnt(8)
    buffer_load_dwordx4 v10, s[24:27], s37 offen offset:1024 lds
    v_mfma_f32_16x16x32_bf16 v[64:67], v[40:43], a[176:179], v[64:67]
    v_mfma_f32_16x16x32_bf16 v[68:71], v[40:43], a[180:183], v[68:71]
    v_mfma_f32_16x16x32_bf16 v[72:75], v[40:43], a[184:187], v[72:75]
    s_add_u32 s37, s65, 270336
    buffer_load_dwordx4 v10, s[24:27], s37 offen offset:2048 lds
    v_mfma_f32_16x16x32_bf16 v[76:79], v[40:43], a[188:191], v[76:79]
    s_waitcnt lgkmcnt(6)
    v_mfma_f32_16x16x32_bf16 v[76:79], v[44:47], a[204:207], v[76:79]
    v_mfma_f32_16x16x32_bf16 v[72:75], v[44:47], a[200:203], v[72:75]
    s_add_u32 s37, s65, 276480
    buffer_load_dwordx4 v10, s[24:27], s37 offen offset:3072 lds
    v_mfma_f32_16x16x32_bf16 v[68:71], v[44:47], a[196:199], v[68:71]
    v_mfma_f32_16x16x32_bf16 v[64:67], v[44:47], a[192:195], v[64:67]
    s_waitcnt lgkmcnt(4)
    v_mfma_f32_16x16x32_bf16 v[64:67], v[24:27], a[208:211], v[64:67]
    s_waitcnt vmcnt(10) lgkmcnt(0)
    s_barrier
    v_mfma_f32_16x16x32_bf16 v[68:71], v[24:27], a[212:215], v[68:71]
    s_add_u32 m0, s32, 0
    ds_read_b64_tr_b16 v[32:33], v5 offset:32768
    ds_read_b64_tr_b16 v[34:35], v5 offset:34816
    v_mfma_f32_16x16x32_bf16 v[72:75], v[24:27], a[216:219], v[72:75]
    s_add_u32 s37, s66, 0
    buffer_load_dwordx4 v10, s[24:27], s37 offen offset:0 lds
    v_mfma_f32_16x16x32_bf16 v[76:79], v[24:27], a[220:223], v[76:79]
    ds_read_b64_tr_b16 v[24:25], v5 offset:36864
    ds_read_b64_tr_b16 v[26:27], v5 offset:38912
    v_mfma_f32_16x16x32_bf16 v[76:79], v[48:51], a[236:239], v[76:79]
    v_mfma_f32_16x16x32_bf16 v[72:75], v[48:51], a[232:235], v[72:75]
    ds_read_b64_tr_b16 v[36:37], v5 offset:40960
    ds_read_b64_tr_b16 v[38:39], v5 offset:43008
    v_mfma_f32_16x16x32_bf16 v[68:71], v[48:51], a[228:231], v[68:71]
    s_add_u32 s37, s66, 6144
    buffer_load_dwordx4 v10, s[24:27], s37 offen offset:1024 lds
    v_mfma_f32_16x16x32_bf16 v[64:67], v[48:51], a[224:227], v[64:67]
    ds_read_b64_tr_b16 v[40:41], v5 offset:45056
    ds_read_b64_tr_b16 v[42:43], v5 offset:47104
    v_mfma_f32_16x16x32_bf16 v[64:67], v[28:31], a[240:243], v[64:67]
    v_mfma_f32_16x16x32_bf16 v[68:71], v[28:31], a[244:247], v[68:71]
    ds_read_b64_tr_b16 v[44:45], v5 offset:49152
    ds_read_b64_tr_b16 v[46:47], v5 offset:51200
    v_mfma_f32_16x16x32_bf16 v[72:75], v[28:31], a[248:251], v[72:75]
    s_add_u32 s37, s66, 12288
    buffer_load_dwordx4 v10, s[24:27], s37 offen offset:2048 lds
    v_mfma_f32_16x16x32_bf16 v[76:79], v[28:31], a[252:255], v[76:79]
    s_waitcnt lgkmcnt(8)
    ds_read_b64_tr_b16 v[28:29], v5 offset:53248
    ds_read_b64_tr_b16 v[30:31], v5 offset:55296
    v_mfma_f32_16x16x32_bf16 v[92:95], v[32:35], a[12:15], 0
    v_mfma_f32_16x16x32_bf16 v[88:91], v[32:35], a[8:11], 0
    ds_read_b64_tr_b16 v[48:49], v5 offset:57344
    ds_read_b64_tr_b16 v[50:51], v5 offset:59392
    v_mfma_f32_16x16x32_bf16 v[84:87], v[32:35], a[4:7], 0
    s_add_u32 s37, s66, 18432
    buffer_load_dwordx4 v10, s[24:27], s37 offen offset:3072 lds
    v_mfma_f32_16x16x32_bf16 v[80:83], v[32:35], a[0:3], 0
    s_waitcnt lgkmcnt(10)
    ds_read_b64_tr_b16 v[32:33], v5 offset:61440
    ds_read_b64_tr_b16 v[34:35], v5 offset:63488
    v_mfma_f32_16x16x32_bf16 v[80:83], v[24:27], a[16:19], v[80:83]
    s_add_u32 m0, s32, 4096
    v_mfma_f32_16x16x32_bf16 v[84:87], v[24:27], a[20:23], v[84:87]
    s_add_u32 s37, s66, 28672
    buffer_load_dwordx4 v10, s[24:27], s37 offen offset:0 lds
    v_mfma_f32_16x16x32_bf16 v[88:91], v[24:27], a[24:27], v[88:91]
    v_cvt_pk_bf16_f32 v96, v64, v65
    v_mfma_f32_16x16x32_bf16 v[92:95], v[24:27], a[28:31], v[92:95]
    s_waitcnt lgkmcnt(10)
    v_cvt_pk_bf16_f32 v97, v66, v67
    v_mfma_f32_16x16x32_bf16 v[92:95], v[36:39], a[44:47], v[92:95]
    s_add_u32 s37, s66, 34816
    buffer_load_dwordx4 v10, s[24:27], s37 offen offset:1024 lds
    v_mov_b32 v16, 0
    s_mov_b64 exec, 1
    global_load_dword v121, v16, s[76:77]
    s_mov_b64 exec, -1
    v_mfma_f32_16x16x32_bf16 v[88:91], v[36:39], a[40:43], v[88:91]
    v_cvt_pk_bf16_f32 v98, v68, v69
    v_mfma_f32_16x16x32_bf16 v[84:87], v[36:39], a[36:39], v[84:87]
    s_add_u32 s37, s66, 40960
    v_cvt_pk_bf16_f32 v99, v70, v71
    v_mfma_f32_16x16x32_bf16 v[80:83], v[36:39], a[32:35], v[80:83]
    s_waitcnt lgkmcnt(8)
    buffer_load_dwordx4 v10, s[24:27], s37 offen offset:2048 lds
    v_mfma_f32_16x16x32_bf16 v[80:83], v[40:43], a[48:51], v[80:83]
    v_cvt_pk_bf16_f32 v100, v72, v73
    v_mfma_f32_16x16x32_bf16 v[84:87], v[40:43], a[52:55], v[84:87]
    v_cvt_pk_bf16_f32 v101, v74, v75
    v_mfma_f32_16x16x32_bf16 v[88:91], v[40:43], a[56:59], v[88:91]
    s_add_u32 s37, s66, 47104
    buffer_load_dwordx4 v10, s[24:27], s37 offen offset:3072 lds
    v_mfma_f32_16x16x32_bf16 v[92:95], v[40:43], a[60:63], v[92:95]
    s_waitcnt lgkmcnt(6)
    v_cvt_pk_bf16_f32 v102, v76, v77
    v_mfma_f32_16x16x32_bf16 v[92:95], v[44:47], a[76:79], v[92:95]
    s_add_u32 m0, s32, 32768
    v_cvt_pk_bf16_f32 v103, v78, v79
    v_mfma_f32_16x16x32_bf16 v[88:91], v[44:47], a[72:75], v[88:91]
    s_add_u32 s37, s66, 229376
    buffer_load_dwordx4 v10, s[24:27], s37 offen offset:0 lds
    v_mfma_f32_16x16x32_bf16 v[84:87], v[44:47], a[68:71], v[84:87]
    v_permlane16_swap_b32 v96, v98
    v_mfma_f32_16x16x32_bf16 v[80:83], v[44:47], a[64:67], v[80:83]
    s_waitcnt lgkmcnt(4)
    v_permlane16_swap_b32 v97, v99
    v_mfma_f32_16x16x32_bf16 v[80:83], v[28:31], a[80:83], v[80:83]
    s_waitcnt vmcnt(10) lgkmcnt(0)
    s_barrier
    v_permlane16_swap_b32 v100, v102
    v_mfma_f32_16x16x32_bf16 v[84:87], v[28:31], a[84:87], v[84:87]
    ds_read_b64_tr_b16 v[24:25], v5 offset:0
    ds_read_b64_tr_b16 v[26:27], v5 offset:2048
    v_mfma_f32_16x16x32_bf16 v[88:91], v[28:31], a[88:91], v[88:91]
    s_add_u32 s37, s66, 235520
    buffer_load_dwordx4 v10, s[24:27], s37 offen offset:1024 lds
    v_mfma_f32_16x16x32_bf16 v[92:95], v[28:31], a[92:95], v[92:95]
    ds_read_b64_tr_b16 v[28:29], v5 offset:4096
    ds_read_b64_tr_b16 v[30:31], v5 offset:6144
    v_mfma_f32_16x16x32_bf16 v[92:95], v[48:51], a[108:111], v[92:95]
    v_permlane16_swap_b32 v101, v103
    v_mfma_f32_16x16x32_bf16 v[88:91], v[48:51], a[104:107], v[88:91]
    s_lshl_b32 s39, s42, 13
    ds_read_b64_tr_b16 v[36:37], v5 offset:8192
    ds_read_b64_tr_b16 v[38:39], v5 offset:10240
    v_mfma_f32_16x16x32_bf16 v[84:87], v[48:51], a[100:103], v[84:87]
    s_add_u32 s37, s66, 241664
    buffer_load_dwordx4 v10, s[24:27], s37 offen offset:2048 lds
    v_mfma_f32_16x16x32_bf16 v[80:83], v[48:51], a[96:99], v[80:83]
    ds_read_b64_tr_b16 v[40:41], v5 offset:12288
    ds_read_b64_tr_b16 v[42:43], v5 offset:14336
    v_mfma_f32_16x16x32_bf16 v[80:83], v[32:35], a[112:115], v[80:83]
    buffer_store_dwordx4 v[96:99], v1, s[28:31], s39 offen offset:0 sc1
    v_mfma_f32_16x16x32_bf16 v[84:87], v[32:35], a[116:119], v[84:87]
    ds_read_b64_tr_b16 v[44:45], v5 offset:16384
    ds_read_b64_tr_b16 v[46:47], v5 offset:18432
    v_mfma_f32_16x16x32_bf16 v[88:91], v[32:35], a[120:123], v[88:91]
    s_add_u32 s37, s66, 247808
    buffer_load_dwordx4 v10, s[24:27], s37 offen offset:3072 lds
    v_mfma_f32_16x16x32_bf16 v[92:95], v[32:35], a[124:127], v[92:95]
    s_waitcnt lgkmcnt(8)
    ds_read_b64_tr_b16 v[32:33], v5 offset:20480
    ds_read_b64_tr_b16 v[34:35], v5 offset:22528
    v_mfma_f32_16x16x32_bf16 v[92:95], v[24:27], a[140:143], v[92:95]
    buffer_store_dwordx4 v[100:103], v1, s[28:31], s39 offen offset:1024 sc1
    v_mfma_f32_16x16x32_bf16 v[88:91], v[24:27], a[136:139], v[88:91]
    s_add_u32 m0, s32, 36864
    ds_read_b64_tr_b16 v[48:49], v5 offset:24576
    ds_read_b64_tr_b16 v[50:51], v5 offset:26624
    v_mfma_f32_16x16x32_bf16 v[84:87], v[24:27], a[132:135], v[84:87]
    s_add_u32 s37, s66, 258048
    buffer_load_dwordx4 v10, s[24:27], s37 offen offset:0 lds
    v_mfma_f32_16x16x32_bf16 v[80:83], v[24:27], a[128:131], v[80:83]
    s_waitcnt lgkmcnt(10)
    ds_read_b64_tr_b16 v[24:25], v5 offset:28672
    ds_read_b64_tr_b16 v[26:27], v5 offset:30720
    v_mfma_f32_16x16x32_bf16 v[80:83], v[28:31], a[144:147], v[80:83]
    v_mfma_f32_16x16x32_bf16 v[84:87], v[28:31], a[148:151], v[84:87]
    s_add_u32 s37, s66, 264192
    buffer_load_dwordx4 v10, s[24:27], s37 offen offset:1024 lds
    v_mfma_f32_16x16x32_bf16 v[88:91], v[28:31], a[152:155], v[88:91]
    v_mfma_f32_16x16x32_bf16 v[92:95], v[28:31], a[156:159], v[92:95]
    s_waitcnt lgkmcnt(10)
    v_mfma_f32_16x16x32_bf16 v[92:95], v[36:39], a[172:175], v[92:95]
    s_add_u32 s37, s66, 270336
    buffer_load_dwordx4 v10, s[24:27], s37 offen offset:2048 lds
    v_mfma_f32_16x16x32_bf16 v[88:91], v[36:39], a[168:171], v[88:91]
    v_mfma_f32_16x16x32_bf16 v[84:87], v[36:39], a[164:167], v[84:87]
    s_add_u32 s37, s66, 276480
    v_mfma_f32_16x16x32_bf16 v[80:83], v[36:39], a[160:163], v[80:83]
    s_waitcnt lgkmcnt(8)
    buffer_load_dwordx4 v10, s[24:27], s37 offen offset:3072 lds
    v_mfma_f32_16x16x32_bf16 v[80:83], v[40:43], a[176:179], v[80:83]
    v_mfma_f32_16x16x32_bf16 v[84:87], v[40:43], a[180:183], v[84:87]
    s_add_u32 m0, s32, 131072
    v_mfma_f32_16x16x32_bf16 v[88:91], v[40:43], a[184:187], v[88:91]
    s_add_u32 s37, s67, 0
    buffer_load_dwordx4 v10, s[24:27], s37 offen offset:0 lds
    v_mfma_f32_16x16x32_bf16 v[92:95], v[40:43], a[188:191], v[92:95]
    s_waitcnt lgkmcnt(6)
    v_mfma_f32_16x16x32_bf16 v[92:95], v[44:47], a[204:207], v[92:95]
    v_mfma_f32_16x16x32_bf16 v[88:91], v[44:47], a[200:203], v[88:91]
    s_add_u32 s37, s67, 6144
    buffer_load_dwordx4 v10, s[24:27], s37 offen offset:1024 lds
    v_mfma_f32_16x16x32_bf16 v[84:87], v[44:47], a[196:199], v[84:87]
    v_mfma_f32_16x16x32_bf16 v[80:83], v[44:47], a[192:195], v[80:83]
    s_waitcnt lgkmcnt(4)
    v_mfma_f32_16x16x32_bf16 v[80:83], v[32:35], a[208:211], v[80:83]
    s_waitcnt vmcnt(12) lgkmcnt(0)
    s_barrier
    v_mfma_f32_16x16x32_bf16 v[84:87], v[32:35], a[212:215], v[84:87]
    ds_read_b64_tr_b16 v[28:29], v4 offset:0
    ds_read_b64_tr_b16 v[30:31], v4 offset:2048
    v_mfma_f32_16x16x32_bf16 v[88:91], v[32:35], a[216:219], v[88:91]
    s_add_u32 s37, s67, 12288
    buffer_load_dwordx4 v10, s[24:27], s37 offen offset:2048 lds
    v_mfma_f32_16x16x32_bf16 v[92:95], v[32:35], a[220:223], v[92:95]
    ds_read_b64_tr_b16 v[32:33], v4 offset:4096
    ds_read_b64_tr_b16 v[34:35], v4 offset:6144
    v_mfma_f32_16x16x32_bf16 v[92:95], v[48:51], a[236:239], v[92:95]
    v_mfma_f32_16x16x32_bf16 v[88:91], v[48:51], a[232:235], v[88:91]
    ds_read_b64_tr_b16 v[36:37], v4 offset:8192
    ds_read_b64_tr_b16 v[38:39], v4 offset:10240
    v_mfma_f32_16x16x32_bf16 v[84:87], v[48:51], a[228:231], v[84:87]
    s_add_u32 s37, s67, 18432
    buffer_load_dwordx4 v10, s[24:27], s37 offen offset:3072 lds
    v_mfma_f32_16x16x32_bf16 v[80:83], v[48:51], a[224:227], v[80:83]
    ds_read_b64_tr_b16 v[40:41], v4 offset:12288
    ds_read_b64_tr_b16 v[42:43], v4 offset:14336
    v_mfma_f32_16x16x32_bf16 v[80:83], v[24:27], a[240:243], v[80:83]
    v_mfma_f32_16x16x32_bf16 v[84:87], v[24:27], a[244:247], v[84:87]
    s_add_u32 m0, s32, 135168
    ds_read_b64_tr_b16 v[44:45], v4 offset:16384
    ds_read_b64_tr_b16 v[46:47], v4 offset:18432
    v_mfma_f32_16x16x32_bf16 v[88:91], v[24:27], a[248:251], v[88:91]
    s_add_u32 s37, s67, 28672
    buffer_load_dwordx4 v10, s[24:27], s37 offen offset:0 lds
    v_mfma_f32_16x16x32_bf16 v[92:95], v[24:27], a[252:255], v[92:95]
    s_waitcnt lgkmcnt(8)
    ds_read_b64_tr_b16 v[24:25], v4 offset:20480
    ds_read_b64_tr_b16 v[26:27], v4 offset:22528
    v_mfma_f32_16x16x32_bf16 v[76:79], v[28:31], a[12:15], 0
    v_mfma_f32_16x16x32_bf16 v[72:75], v[28:31], a[8:11], 0
    ds_read_b64_tr_b16 v[48:49], v4 offset:24576
    ds_read_b64_tr_b16 v[50:51], v4 offset:26624
    v_mfma_f32_16x16x32_bf16 v[68:71], v[28:31], a[4:7], 0
    s_add_u32 s37, s67, 34816
    buffer_load_dwordx4 v10, s[24:27], s37 offen offset:1024 lds
    v_mfma_f32_16x16x32_bf16 v[64:67], v[28:31], a[0:3], 0
    s_waitcnt lgkmcnt(10)
    ds_read_b64_tr_b16 v[28:29], v4 offset:28672
    ds_read_b64_tr_b16 v[30:31], v4 offset:30720
    v_mfma_f32_16x16x32_bf16 v[64:67], v[32:35], a[16:19], v[64:67]
    v_mfma_f32_16x16x32_bf16 v[68:71], v[32:35], a[20:23], v[68:71]
    s_add_u32 s37, s67, 40960
    buffer_load_dwordx4 v10, s[24:27], s37 offen offset:2048 lds
    v_mfma_f32_16x16x32_bf16 v[72:75], v[32:35], a[24:27], v[72:75]
    v_cvt_pk_bf16_f32 v104, v80, v81
    v_mfma_f32_16x16x32_bf16 v[76:79], v[32:35], a[28:31], v[76:79]
    s_waitcnt lgkmcnt(10)
    v_cvt_pk_bf16_f32 v105, v82, v83
    v_mfma_f32_16x16x32_bf16 v[76:79], v[36:39], a[44:47], v[76:79]
    s_add_u32 s37, s67, 47104
    buffer_load_dwordx4 v10, s[24:27], s37 offen offset:3072 lds
    v_mfma_f32_16x16x32_bf16 v[72:75], v[36:39], a[40:43], v[72:75]
    v_cvt_pk_bf16_f32 v106, v84, v85
    v_mfma_f32_16x16x32_bf16 v[68:71], v[36:39], a[36:39], v[68:71]
    s_add_u32 m0, s32, 98304
    s_add_u32 s37, s67, 229376
    v_cvt_pk_bf16_f32 v107, v86, v87
    v_mfma_f32_16x16x32_bf16 v[64:67], v[36:39], a[32:35], v[64:67]
    s_waitcnt lgkmcnt(8)
    buffer_load_dwordx4 v10, s[24:27], s37 offen offset:0 lds
    v_mfma_f32_16x16x32_bf16 v[64:67], v[40:43], a[48:51], v[64:67]
    v_cvt_pk_bf16_f32 v108, v88, v89
    v_mfma_f32_16x16x32_bf16 v[68:71], v[40:43], a[52:55], v[68:71]
    v_cvt_pk_bf16_f32 v109, v90, v91
    v_mfma_f32_16x16x32_bf16 v[72:75], v[40:43], a[56:59], v[72:75]
    s_add_u32 s37, s67, 235520
    buffer_load_dwordx4 v10, s[24:27], s37 offen offset:1024 lds
    v_mfma_f32_16x16x32_bf16 v[76:79], v[40:43], a[60:63], v[76:79]
    s_waitcnt lgkmcnt(6)
    v_cvt_pk_bf16_f32 v110, v92, v93
    v_mfma_f32_16x16x32_bf16 v[76:79], v[44:47], a[76:79], v[76:79]
    v_cvt_pk_bf16_f32 v111, v94, v95
    v_mfma_f32_16x16x32_bf16 v[72:75], v[44:47], a[72:75], v[72:75]
    s_add_u32 s37, s67, 241664
    buffer_load_dwordx4 v10, s[24:27], s37 offen offset:2048 lds
    v_mfma_f32_16x16x32_bf16 v[68:71], v[44:47], a[68:71], v[68:71]
    v_permlane16_swap_b32 v104, v106
    v_mfma_f32_16x16x32_bf16 v[64:67], v[44:47], a[64:67], v[64:67]
    s_waitcnt lgkmcnt(4)
    v_permlane16_swap_b32 v105, v107
    v_mfma_f32_16x16x32_bf16 v[64:67], v[24:27], a[80:83], v[64:67]
    s_waitcnt vmcnt(11) lgkmcnt(0)
    s_barrier
    v_permlane16_swap_b32 v108, v110
    v_mfma_f32_16x16x32_bf16 v[68:71], v[24:27], a[84:87], v[68:71]
    ds_read_b64_tr_b16 v[32:33], v4 offset:32768
    ds_read_b64_tr_b16 v[34:35], v4 offset:34816
    v_mfma_f32_16x16x32_bf16 v[72:75], v[24:27], a[88:91], v[72:75]
    s_add_u32 s37, s67, 247808
    buffer_load_dwordx4 v10, s[24:27], s37 offen offset:3072 lds
    v_mfma_f32_16x16x32_bf16 v[76:79], v[24:27], a[92:95], v[76:79]
    ds_read_b64_tr_b16 v[24:25], v4 offset:36864
    ds_read_b64_tr_b16 v[26:27], v4 offset:38912
    v_mfma_f32_16x16x32_bf16 v[76:79], v[48:51], a[108:111], v[76:79]
    v_permlane16_swap_b32 v109, v111
    v_mfma_f32_16x16x32_bf16 v[72:75], v[48:51], a[104:107], v[72:75]
    s_add_u32 m0, s32, 102400
    ds_read_b64_tr_b16 v[36:37], v4 offset:40960
    ds_read_b64_tr_b16 v[38:39], v4 offset:43008
    v_mfma_f32_16x16x32_bf16 v[68:71], v[48:51], a[100:103], v[68:71]
    s_add_u32 s37, s67, 258048
    buffer_load_dwordx4 v10, s[24:27], s37 offen offset:0 lds
    v_mfma_f32_16x16x32_bf16 v[64:67], v[48:51], a[96:99], v[64:67]
    ds_read_b64_tr_b16 v[40:41], v4 offset:45056
    ds_read_b64_tr_b16 v[42:43], v4 offset:47104
    v_mfma_f32_16x16x32_bf16 v[64:67], v[28:31], a[112:115], v[64:67]
    s_lshl_b32 s39, s43, 13
    v_mfma_f32_16x16x32_bf16 v[68:71], v[28:31], a[116:119], v[68:71]
    ds_read_b64_tr_b16 v[44:45], v4 offset:49152
    ds_read_b64_tr_b16 v[46:47], v4 offset:51200
    v_mfma_f32_16x16x32_bf16 v[72:75], v[28:31], a[120:123], v[72:75]
    s_add_u32 s37, s67, 264192
    buffer_load_dwordx4 v10, s[24:27], s37 offen offset:1024 lds
    v_mfma_f32_16x16x32_bf16 v[76:79], v[28:31], a[124:127], v[76:79]
    s_waitcnt lgkmcnt(8)
    ds_read_b64_tr_b16 v[28:29], v4 offset:53248
    ds_read_b64_tr_b16 v[30:31], v4 offset:55296
    v_mfma_f32_16x16x32_bf16 v[76:79], v[32:35], a[140:143], v[76:79]
    buffer_store_dwordx4 v[104:107], v1, s[28:31], s39 offen offset:0 sc1
    v_mfma_f32_16x16x32_bf16 v[72:75], v[32:35], a[136:139], v[72:75]
    ds_read_b64_tr_b16 v[48:49], v4 offset:57344
    ds_read_b64_tr_b16 v[50:51], v4 offset:59392
    v_mfma_f32_16x16x32_bf16 v[68:71], v[32:35], a[132:135], v[68:71]
    s_add_u32 s37, s67, 270336
    buffer_load_dwordx4 v10, s[24:27], s37 offen offset:2048 lds
    v_readfirstlane_b32 s51, v121
    s_cmp_eq_u32 s51, 0
    s_cbranch_scc1 L_non_slow
L_non_ok:
    v_mfma_f32_16x16x32_bf16 v[64:67], v[32:35], a[128:131], v[64:67]
    s_waitcnt lgkmcnt(10)
    ds_read_b64_tr_b16 v[32:33], v4 offset:61440
    ds_read_b64_tr_b16 v[34:35], v4 offset:63488
    v_mfma_f32_16x16x32_bf16 v[64:67], v[24:27], a[144:147], v[64:67]
    buffer_store_dwordx4 v[108:111], v1, s[28:31], s39 offen offset:1024 sc1
    v_mfma_f32_16x16x32_bf16 v[68:71], v[24:27], a[148:151], v[68:71]
    s_add_u32 s37, s67, 276480
    buffer_load_dwordx4 v10, s[24:27], s37 offen offset:3072 lds
    v_mfma_f32_16x16x32_bf16 v[72:75], v[24:27], a[152:155], v[72:75]
    v_mfma_f32_16x16x32_bf16 v[76:79], v[24:27], a[156:159], v[76:79]
    s_waitcnt lgkmcnt(10)
    s_add_u32 m0, s32, 65536
    v_mfma_f32_16x16x32_bf16 v[76:79], v[36:39], a[172:175], v[76:79]
    s_add_u32 s37, s68, 0
    buffer_load_dwordx4 v10, s[24:27], s37 offen offset:0 lds
    v_mfma_f32_16x16x32_bf16 v[72:75], v[36:39], a[168:171], v[72:75]
    v_mfma_f32_16x16x32_bf16 v[68:71], v[36:39], a[164:167], v[68:71]
    s_add_u32 s37, s68, 6144
    v_mfma_f32_16x16x32_bf16 v[64:67], v[36:39], a[160:163], v[64:67]
    s_waitcnt lgkmcnt(8)
    buffer_load_dwordx4 v10, s[24:27], s37 offen offset:1024 lds
    v_mfma_f32_16x16x32_bf16 v[64:67], v[40:43], a[176:179], v[64:67]
    v_and_b32 v115, 7, v0
    v_lshrrev_b32 v116, 3, v0
    v_lshrrev_b32 v117, 1, v115
    v_lshlrev_b32 v112, 11, v117
    v_and_b32 v117, 1, v115
    v_lshl_add_u32 v112, v117, 9, v112
    v_lshl_add_u32 v112, v116, 4, v112
    s_lshr_b32 s70, s47, 2
    s_lshl_b32 s70, s70, 10
    s_and_b32 s71, s47, 3
    s_lshl_b32 s71, s71, 7
    s_add_u32 s70, s70, s71
    s_add_u32 s70, s70, s32
    v_add_u32 v112, s70, v112
    s_lshr_b32 s36, s2, 3
    s_mul_i32 s70, s36, 458752
    s_add_u32 s8, s74, s70
    s_addc_u32 s9, s75, 0
    s_mov_b32 s10, 458752
    v_mfma_f32_16x16x32_bf16 v[68:71], v[40:43], a[180:183], v[68:71]
    v_mfma_f32_16x16x32_bf16 v[72:75], v[40:43], a[184:187], v[72:75]
    s_add_u32 s37, s68, 12288
    buffer_load_dwordx4 v10, s[24:27], s37 offen offset:2048 lds
    v_mfma_f32_16x16x32_bf16 v[76:79], v[40:43], a[188:191], v[76:79]
    s_waitcnt lgkmcnt(6)
    v_mfma_f32_16x16x32_bf16 v[76:79], v[44:47], a[204:207], v[76:79]
    v_mfma_f32_16x16x32_bf16 v[72:75], v[44:47], a[200:203], v[72:75]
    s_add_u32 s37, s68, 18432
    buffer_load_dwordx4 v10, s[24:27], s37 offen offset:3072 lds
    v_mfma_f32_16x16x32_bf16 v[68:71], v[44:47], a[196:199], v[68:71]
    v_mfma_f32_16x16x32_bf16 v[64:67], v[44:47], a[192:195], v[64:67]
    s_waitcnt lgkmcnt(4)
    v_mfma_f32_16x16x32_bf16 v[64:67], v[28:31], a[208:211], v[64:67]
    s_waitcnt vmcnt(14) lgkmcnt(0)
    s_barrier
    v_mfma_f32_16x16x32_bf16 v[68:71], v[28:31], a[212:215], v[68:71]
    s_add_u32 m0, s32, 69632
    ds_read_b64_tr_b16 v[24:25], v6 offset:0
    ds_read_b64_tr_b16 v[26:27], v6 offset:2048
    v_mfma_f32_16x16x32_bf16 v[72:75], v[28:31], a[216:219], v[72:75]
    s_add_u32 s37, s68, 28672
    buffer_load_dwordx4 v10, s[24:27], s37 offen offset:0 lds
    v_mfma_f32_16x16x32_bf16 v[76:79], v[28:31], a[220:223], v[76:79]
    ds_read_b64_tr_b16 v[28:29], v6 offset:4096
    ds_read_b64_tr_b16 v[30:31], v6 offset:6144
    v_mfma_f32_16x16x32_bf16 v[76:79], v[48:51], a[236:239], v[76:79]
    v_mfma_f32_16x16x32_bf16 v[72:75], v[48:51], a[232:235], v[72:75]
    ds_read_b64_tr_b16 v[36:37], v6 offset:8192
    ds_read_b64_tr_b16 v[38:39], v6 offset:10240
    v_mfma_f32_16x16x32_bf16 v[68:71], v[48:51], a[228:231], v[68:71]
    s_add_u32 s37, s68, 34816
    buffer_load_dwordx4 v10, s[24:27], s37 offen offset:1024 lds
    v_mfma_f32_16x16x32_bf16 v[64:67], v[48:51], a[224:227], v[64:67]
    ds_read_b64_tr_b16 v[40:41], v6 offset:12288
    ds_read_b64_tr_b16 v[42:43], v6 offset:14336
    v_mfma_f32_16x16x32_bf16 v[64:67], v[32:35], a[240:243], v[64:67]
    v_mfma_f32_16x16x32_bf16 v[68:71], v[32:35], a[244:247], v[68:71]
    ds_read_b64_tr_b16 v[44:45], v6 offset:16384
    ds_read_b64_tr_b16 v[46:47], v6 offset:18432
    v_mfma_f32_16x16x32_bf16 v[72:75], v[32:35], a[248:251], v[72:75]
    s_add_u32 s37, s68, 40960
    buffer_load_dwordx4 v10, s[24:27], s37 offen offset:2048 lds
    v_mfma_f32_16x16x32_bf16 v[76:79], v[32:35], a[252:255], v[76:79]
    s_waitcnt lgkmcnt(8)
    ds_read_b64_tr_b16 v[32:33], v6 offset:20480
    ds_read_b64_tr_b16 v[34:35], v6 offset:22528
    v_mfma_f32_16x16x32_bf16 v[92:95], v[24:27], a[12:15], 0
    s_and_b32 s70, s36, 15
    s_lshl_b32 s70, s70, 3
    s_add_u32 s70, s70, s47
    s_mul_i32 s70, s70, 14336
    s_lshr_b32 s71, s36, 4
    s_mul_i32 s71, s71, 896
    s_add_u32 s70, s70, s71
    s_lshl_b32 s71, s3, 7
    s_add_u32 s70, s70, s71
    s_add_u32 s12, s78, s70
    s_addc_u32 s13, s79, 0
    s_sub_u32 s14, 1835008, s70
    v_mul_u32_u24 v113, 1792, v116
    v_lshl_add_u32 v113, v115, 4, v113
    s_lshl_b32 s70, s36, 10
    s_add_u32 s70, s70, 58720256
    v_lshlrev_b32 v114, 7, v0
    v_add_u32 v114, s70, v114
    s_lshl_b32 s71, s47, 7
    s_add_u32 s70, s70, s71
    v_mov_b32 v118, s70
    v_mov_b32 v119, s51
    v_mfma_f32_16x16x32_bf16 v[88:91], v[24:27], a[8:11], 0
    ds_read_b64_tr_b16 v[48:49], v6 offset:24576
    ds_read_b64_tr_b16 v[50:51], v6 offset:26624
    v_mfma_f32_16x16x32_bf16 v[84:87], v[24:27], a[4:7], 0
    s_add_u32 s37, s68, 47104
    buffer_load_dwordx4 v10, s[24:27], s37 offen offset:3072 lds
    v_mfma_f32_16x16x32_bf16 v[80:83], v[24:27], a[0:3], 0
    s_waitcnt lgkmcnt(10)
    ds_read_b64_tr_b16 v[24:25], v6 offset:28672
    ds_read_b64_tr_b16 v[26:27], v6 offset:30720
    v_mfma_f32_16x16x32_bf16 v[80:83], v[28:31], a[16:19], v[80:83]
    s_add_u32 m0, s32, 0
    v_mfma_f32_16x16x32_bf16 v[84:87], v[28:31], a[20:23], v[84:87]
    s_add_u32 s37, s68, 229376
    buffer_load_dwordx4 v10, s[24:27], s37 offen offset:0 lds
    v_mfma_f32_16x16x32_bf16 v[88:91], v[28:31], a[24:27], v[88:91]
    v_cvt_pk_bf16_f32 v96, v64, v65
    v_mfma_f32_16x16x32_bf16 v[92:95], v[28:31], a[28:31], v[92:95]
    s_waitcnt lgkmcnt(10)
    v_cvt_pk_bf16_f32 v97, v66, v67
    v_mfma_f32_16x16x32_bf16 v[92:95], v[36:39], a[44:47], v[92:95]
    s_add_u32 s37, s68, 235520
    buffer_load_dwordx4 v10, s[24:27], s37 offen offset:1024 lds
    v_mfma_f32_16x16x32_bf16 v[88:91], v[36:39], a[40:43], v[88:91]
    v_cvt_pk_bf16_f32 v98, v68, v69
    v_mfma_f32_16x16x32_bf16 v[84:87], v[36:39], a[36:39], v[84:87]
    s_add_u32 s37, s68, 241664
    v_cvt_pk_bf16_f32 v99, v70, v71
    v_mfma_f32_16x16x32_bf16 v[80:83], v[36:39], a[32:35], v[80:83]
    s_waitcnt lgkmcnt(8)
    buffer_load_dwordx4 v10, s[24:27], s37 offen offset:2048 lds
    v_mfma_f32_16x16x32_bf16 v[80:83], v[40:43], a[48:51], v[80:83]
    v_cvt_pk_bf16_f32 v100, v72, v73
    v_mfma_f32_16x16x32_bf16 v[84:87], v[40:43], a[52:55], v[84:87]
    v_cvt_pk_bf16_f32 v101, v74, v75
    v_mfma_f32_16x16x32_bf16 v[88:91], v[40:43], a[56:59], v[88:91]
    s_add_u32 s37, s68, 247808
    buffer_load_dwordx4 v10, s[24:27], s37 offen offset:3072 lds
    v_mfma_f32_16x16x32_bf16 v[92:95], v[40:43], a[60:63], v[92:95]
    s_waitcnt lgkmcnt(6)
    v_cvt_pk_bf16_f32 v102, v76, v77
    v_mfma_f32_16x16x32_bf16 v[92:95], v[44:47], a[76:79], v[92:95]
    s_add_u32 m0, s32, 4096
    v_cvt_pk_bf16_f32 v103, v78, v79
    v_mfma_f32_16x16x32_bf16 v[88:91], v[44:47], a[72:75], v[88:91]
    s_add_u32 s37, s68, 258048
    buffer_load_dwordx4 v10, s[24:27], s37 offen offset:0 lds
    v_mfma_f32_16x16x32_bf16 v[84:87], v[44:47], a[68:71], v[84:87]
    v_permlane16_swap_b32 v96, v98
    v_mfma_f32_16x16x32_bf16 v[80:83], v[44:47], a[64:67], v[80:83]
    s_waitcnt lgkmcnt(4)
    v_permlane16_swap_b32 v97, v99
    v_mfma_f32_16x16x32_bf16 v[80:83], v[32:35], a[80:83], v[80:83]
    s_waitcnt vmcnt(13) lgkmcnt(0)
    s_barrier
    v_permlane16_swap_b32 v100, v102
    v_add_u32 v117, 32768, v112
    s_mov_b32 s60, 0
    s_mov_b32 s52, 0
    s_mov_b32 s53, 57344
    s_mov_b32 s54, 114688
    s_mov_b32 s55, 172032
    s_mov_b32 s56, 229376
    s_mov_b32 s57, 286720
    s_mov_b32 s58, 344064
    s_mov_b32 s59, 401408
    v_mfma_f32_16x16x32_bf16 v[84:87], v[32:35], a[84:87], v[84:87]
    ds_read_b64_tr_b16 v[28:29], v5 offset:32768
    ds_read_b64_tr_b16 v[30:31], v5 offset:34816
    v_mfma_f32_16x16x32_bf16 v[88:91], v[32:35], a[88:91], v[88:91]
    s_add_u32 s37, s68, 264192
    buffer_load_dwordx4 v10, s[24:27], s37 offen offset:1024 lds
    v_mfma_f32_16x16x32_bf16 v[92:95], v[32:35], a[92:95], v[92:95]
    ds_read_b64_tr_b16 v[32:33], v5 offset:36864
    ds_read_b64_tr_b16 v[34:35], v5 offset:38912
    v_mfma_f32_16x16x32_bf16 v[92:95], v[48:51], a[108:111], v[92:95]
    v_permlane16_swap_b32 v101, v103
    v_mfma_f32_16x16x32_bf16 v[88:91], v[48:51], a[104:107], v[88:91]
    s_lshl_b32 s39, s44, 13
    ds_read_b64_tr_b16 v[36:37], v5 offset:40960
    ds_read_b64_tr_b16 v[38:39], v5 offset:43008
    v_mfma_f32_16x16x32_bf16 v[84:87], v[48:51], a[100:103], v[84:87]
    s_add_u32 s37, s68, 270336
    buffer_load_dwordx4 v10, s[24:27], s37 offen offset:2048 lds
    v_mfma_f32_16x16x32_bf16 v[80:83], v[48:51], a[96:99], v[80:83]
    ds_read_b64_tr_b16 v[40:41], v5 offset:45056
    ds_read_b64_tr_b16 v[42:43], v5 offset:47104
    v_mfma_f32_16x16x32_bf16 v[80:83], v[24:27], a[112:115], v[80:83]
    buffer_store_dwordx4 v[96:99], v1, s[28:31], s39 offen offset:0 sc1
    v_mfma_f32_16x16x32_bf16 v[84:87], v[24:27], a[116:119], v[84:87]
    ds_read_b64_tr_b16 v[44:45], v5 offset:49152
    ds_read_b64_tr_b16 v[46:47], v5 offset:51200
    v_mfma_f32_16x16x32_bf16 v[88:91], v[24:27], a[120:123], v[88:91]
    s_add_u32 s37, s68, 276480
    buffer_load_dwordx4 v10, s[24:27], s37 offen offset:3072 lds
    v_mfma_f32_16x16x32_bf16 v[92:95], v[24:27], a[124:127], v[92:95]
    s_waitcnt lgkmcnt(8)
    ds_read_b64_tr_b16 v[24:25], v5 offset:53248
    ds_read_b64_tr_b16 v[26:27], v5 offset:55296
    v_mfma_f32_16x16x32_bf16 v[92:95], v[28:31], a[140:143], v[92:95]
    buffer_store_dwordx4 v[100:103], v1, s[28:31], s39 offen offset:1024 sc1
    v_mfma_f32_16x16x32_bf16 v[88:91], v[28:31], a[136:139], v[88:91]
    ds_read_b64_tr_b16 v[48:49], v5 offset:57344
    ds_read_b64_tr_b16 v[50:51], v5 offset:59392
    v_mfma_f32_16x16x32_bf16 v[84:87], v[28:31], a[132:135], v[84:87]
    v_mfma_f32_16x16x32_bf16 v[80:83], v[28:31], a[128:131], v[80:83]
    s_waitcnt lgkmcnt(10)
    ds_read_b64_tr_b16 v[28:29], v5 offset:61440
    ds_read_b64_tr_b16 v[30:31], v5 offset:63488
    v_mfma_f32_16x16x32_bf16 v[80:83], v[32:35], a[144:147], v[80:83]
    v_mfma_f32_16x16x32_bf16 v[84:87], v[32:35], a[148:151], v[84:87]
    v_mfma_f32_16x16x32_bf16 v[88:91], v[32:35], a[152:155], v[88:91]
    v_mfma_f32_16x16x32_bf16 v[92:95], v[32:35], a[156:159], v[92:95]
    s_waitcnt lgkmcnt(10)
    v_mfma_f32_16x16x32_bf16 v[92:95], v[36:39], a[172:175], v[92:95]
    v_mfma_f32_16x16x32_bf16 v[88:91], v[36:39], a[168:171], v[88:91]
    v_mfma_f32_16x16x32_bf16 v[84:87], v[36:39], a[164:167], v[84:87]
    v_mfma_f32_16x16x32_bf16 v[80:83], v[36:39], a[160:163], v[80:83]
    s_waitcnt lgkmcnt(8)
    v_mfma_f32_16x16x32_bf16 v[80:83], v[40:43], a[176:179], v[80:83]
    v_mfma_f32_16x16x32_bf16 v[84:87], v[40:43], a[180:183], v[84:87]
    v_mfma_f32_16x16x32_bf16 v[88:91], v[40:43], a[184:187], v[88:91]
    v_mfma_f32_16x16x32_bf16 v[92:95], v[40:43], a[188:191], v[92:95]
    s_waitcnt lgkmcnt(6)
    v_mfma_f32_16x16x32_bf16 v[92:95], v[44:47], a[204:207], v[92:95]
    v_mfma_f32_16x16x32_bf16 v[88:91], v[44:47], a[200:203], v[88:91]
    v_mfma_f32_16x16x32_bf16 v[84:87], v[44:47], a[196:199], v[84:87]
    v_mfma_f32_16x16x32_bf16 v[80:83], v[44:47], a[192:195], v[80:83]
    s_waitcnt lgkmcnt(4)
    v_mfma_f32_16x16x32_bf16 v[80:83], v[24:27], a[208:211], v[80:83]
    s_waitcnt vmcnt(10) lgkmcnt(0)
    s_barrier
    v_mfma_f32_16x16x32_bf16 v[84:87], v[24:27], a[212:215], v[84:87]
    ds_read_b64_tr_b16 v[32:33], v5 offset:0
    ds_read_b64_tr_b16 v[34:35], v5 offset:2048
    v_mfma_f32_16x16x32_bf16 v[88:91], v[24:27], a[216:219], v[88:91]
    v_mfma_f32_16x16x32_bf16 v[92:95], v[24:27], a[220:223], v[92:95]
    ds_read_b64_tr_b16 v[24:25], v5 offset:4096
    ds_read_b64_tr_b16 v[26:27], v5 offset:6144
    v_mfma_f32_16x16x32_bf16 v[92:95], v[48:51], a[236:239], v[92:95]
    v_mfma_f32_16x16x32_bf16 v[88:91], v[48:51], a[232:235], v[88:91]
    ds_read_b64_tr_b16 v[36:37], v5 offset:8192
    ds_read_b64_tr_b16 v[38:39], v5 offset:10240
    v_mfma_f32_16x16x32_bf16 v[84:87], v[48:51], a[228:231], v[84:87]
    v_mfma_f32_16x16x32_bf16 v[80:83], v[48:51], a[224:227], v[80:83]
    ds_read_b64_tr_b16 v[40:41], v5 offset:12288
    ds_read_b64_tr_b16 v[42:43], v5 offset:14336
    v_mfma_f32_16x16x32_bf16 v[80:83], v[28:31], a[240:243], v[80:83]
    v_mfma_f32_16x16x32_bf16 v[84:87], v[28:31], a[244:247], v[84:87]
    ds_read_b64_tr_b16 v[44:45], v5 offset:16384
    ds_read_b64_tr_b16 v[46:47], v5 offset:18432
    v_mfma_f32_16x16x32_bf16 v[88:91], v[28:31], a[248:251], v[88:91]
    v_mfma_f32_16x16x32_bf16 v[92:95], v[28:31], a[252:255], v[92:95]
    s_waitcnt lgkmcnt(8)
    ds_read_b64_tr_b16 v[28:29], v5 offset:20480
    ds_read_b64_tr_b16 v[30:31], v5 offset:22528
    v_mfma_f32_16x16x32_bf16 v[76:79], v[32:35], a[12:15], 0
    v_mfma_f32_16x16x32_bf16 v[72:75], v[32:35], a[8:11], 0
    ds_read_b64_tr_b16 v[48:49], v5 offset:24576
    ds_read_b64_tr_b16 v[50:51], v5 offset:26624
    v_mfma_f32_16x16x32_bf16 v[68:71], v[32:35], a[4:7], 0
    v_mfma_f32_16x16x32_bf16 v[64:67], v[32:35], a[0:3], 0
    s_waitcnt lgkmcnt(10)
    ds_read_b64_tr_b16 v[32:33], v5 offset:28672
    ds_read_b64_tr_b16 v[34:35], v5 offset:30720
    v_mfma_f32_16x16x32_bf16 v[64:67], v[24:27], a[16:19], v[64:67]
    v_mfma_f32_16x16x32_bf16 v[68:71], v[24:27], a[20:23], v[68:71]
    v_mfma_f32_16x16x32_bf16 v[72:75], v[24:27], a[24:27], v[72:75]
    v_cvt_pk_bf16_f32 v104, v80, v81
    v_mfma_f32_16x16x32_bf16 v[76:79], v[24:27], a[28:31], v[76:79]
    s_waitcnt lgkmcnt(10)
    v_cvt_pk_bf16_f32 v105, v82, v83
    v_mfma_f32_16x16x32_bf16 v[76:79], v[36:39], a[44:47], v[76:79]
    v_cvt_pk_bf16_f32 v106, v84, v85
    v_mfma_f32_16x16x32_bf16 v[72:75], v[36:39], a[40:43], v[72:75]
    v_cvt_pk_bf16_f32 v107, v86, v87
    v_mfma_f32_16x16x32_bf16 v[68:71], v[36:39], a[36:39], v[68:71]
    v_cvt_pk_bf16_f32 v108, v88, v89
    v_mfma_f32_16x16x32_bf16 v[64:67], v[36:39], a[32:35], v[64:67]
    s_waitcnt lgkmcnt(8)
    v_cvt_pk_bf16_f32 v109, v90, v91
    v_mfma_f32_16x16x32_bf16 v[64:67], v[40:43], a[48:51], v[64:67]
    v_cvt_pk_bf16_f32 v110, v92, v93
    v_mfma_f32_16x16x32_bf16 v[68:71], v[40:43], a[52:55], v[68:71]
    v_cvt_pk_bf16_f32 v111, v94, v95
    v_mfma_f32_16x16x32_bf16 v[72:75], v[40:43], a[56:59], v[72:75]
    v_permlane16_swap_b32 v104, v106
    v_mfma_f32_16x16x32_bf16 v[76:79], v[40:43], a[60:63], v[76:79]
    s_waitcnt lgkmcnt(6)
    v_permlane16_swap_b32 v105, v107
    v_mfma_f32_16x16x32_bf16 v[76:79], v[44:47], a[76:79], v[76:79]
    v_permlane16_swap_b32 v108, v110
    v_mfma_f32_16x16x32_bf16 v[72:75], v[44:47], a[72:75], v[72:75]
    v_permlane16_swap_b32 v109, v111
    v_mfma_f32_16x16x32_bf16 v[68:71], v[44:47], a[68:71], v[68:71]
    s_lshl_b32 s39, s45, 13
    v_mfma_f32_16x16x32_bf16 v[64:67], v[44:47], a[64:67], v[64:67]
    s_waitcnt lgkmcnt(4)
    buffer_store_dwordx4 v[104:107], v1, s[28:31], s39 offen offset:0 sc1
    v_mfma_f32_16x16x32_bf16 v[64:67], v[28:31], a[80:83], v[64:67]
    s_waitcnt vmcnt(2) lgkmcnt(0)
    s_barrier
    v_mfma_f32_16x16x32_bf16 v[68:71], v[28:31], a[84:87], v[68:71]
    ds_read_b64_tr_b16 v[24:25], v4 offset:0
    ds_read_b64_tr_b16 v[26:27], v4 offset:2048
    v_mfma_f32_16x16x32_bf16 v[72:75], v[28:31], a[88:91], v[72:75]
    buffer_store_dwordx4 v[108:111], v1, s[28:31], s39 offen offset:1024 sc1
    v_mfma_f32_16x16x32_bf16 v[76:79], v[28:31], a[92:95], v[76:79]
    ds_read_b64_tr_b16 v[28:29], v4 offset:4096
    ds_read_b64_tr_b16 v[30:31], v4 offset:6144
    v_mfma_f32_16x16x32_bf16 v[76:79], v[48:51], a[108:111], v[76:79]
    v_mfma_f32_16x16x32_bf16 v[72:75], v[48:51], a[104:107], v[72:75]
    ds_read_b64_tr_b16 v[36:37], v4 offset:8192
    ds_read_b64_tr_b16 v[38:39], v4 offset:10240
    v_mfma_f32_16x16x32_bf16 v[68:71], v[48:51], a[100:103], v[68:71]
    v_mfma_f32_16x16x32_bf16 v[64:67], v[48:51], a[96:99], v[64:67]
    ds_read_b64_tr_b16 v[40:41], v4 offset:12288
    ds_read_b64_tr_b16 v[42:43], v4 offset:14336
    v_mfma_f32_16x16x32_bf16 v[64:67], v[32:35], a[112:115], v[64:67]
    v_mfma_f32_16x16x32_bf16 v[68:71], v[32:35], a[116:119], v[68:71]
    ds_read_b64_tr_b16 v[44:45], v4 offset:16384
    ds_read_b64_tr_b16 v[46:47], v4 offset:18432
    v_mfma_f32_16x16x32_bf16 v[72:75], v[32:35], a[120:123], v[72:75]
    v_mfma_f32_16x16x32_bf16 v[76:79], v[32:35], a[124:127], v[76:79]
    s_waitcnt lgkmcnt(8)
    ds_read_b64_tr_b16 v[32:33], v4 offset:20480
    ds_read_b64_tr_b16 v[34:35], v4 offset:22528
    v_mfma_f32_16x16x32_bf16 v[76:79], v[24:27], a[140:143], v[76:79]
    v_mfma_f32_16x16x32_bf16 v[72:75], v[24:27], a[136:139], v[72:75]
    ds_read_b64_tr_b16 v[48:49], v4 offset:24576
    ds_read_b64_tr_b16 v[50:51], v4 offset:26624
    v_mfma_f32_16x16x32_bf16 v[68:71], v[24:27], a[132:135], v[68:71]
    v_mfma_f32_16x16x32_bf16 v[64:67], v[24:27], a[128:131], v[64:67]
    s_waitcnt lgkmcnt(10)
    ds_read_b64_tr_b16 v[24:25], v4 offset:28672
    ds_read_b64_tr_b16 v[26:27], v4 offset:30720
    v_mfma_f32_16x16x32_bf16 v[64:67], v[28:31], a[144:147], v[64:67]
    v_mfma_f32_16x16x32_bf16 v[68:71], v[28:31], a[148:151], v[68:71]
    v_mfma_f32_16x16x32_bf16 v[72:75], v[28:31], a[152:155], v[72:75]
    v_mfma_f32_16x16x32_bf16 v[76:79], v[28:31], a[156:159], v[76:79]
    s_waitcnt lgkmcnt(10)
    v_mfma_f32_16x16x32_bf16 v[76:79], v[36:39], a[172:175], v[76:79]
    v_mfma_f32_16x16x32_bf16 v[72:75], v[36:39], a[168:171], v[72:75]
    v_mfma_f32_16x16x32_bf16 v[68:71], v[36:39], a[164:167], v[68:71]
    v_mfma_f32_16x16x32_bf16 v[64:67], v[36:39], a[160:163], v[64:67]
    s_waitcnt lgkmcnt(8)
    v_mfma_f32_16x16x32_bf16 v[64:67], v[40:43], a[176:179], v[64:67]
    v_mfma_f32_16x16x32_bf16 v[68:71], v[40:43], a[180:183], v[68:71]
    v_mfma_f32_16x16x32_bf16 v[72:75], v[40:43], a[184:187], v[72:75]
    v_mfma_f32_16x16x32_bf16 v[76:79], v[40:43], a[188:191], v[76:79]
    s_waitcnt lgkmcnt(6)
    v_mfma_f32_16x16x32_bf16 v[76:79], v[44:47], a[204:207], v[76:79]
    v_mfma_f32_16x16x32_bf16 v[72:75], v[44:47], a[200:203], v[72:75]
    v_mfma_f32_16x16x32_bf16 v[68:71], v[44:47], a[196:199], v[68:71]
    v_mfma_f32_16x16x32_bf16 v[64:67], v[44:47], a[192:195], v[64:67]
    s_waitcnt lgkmcnt(4)
    v_mfma_f32_16x16x32_bf16 v[64:67], v[32:35], a[208:211], v[64:67]
    v_mfma_f32_16x16x32_bf16 v[68:71], v[32:35], a[212:215], v[68:71]
    v_mfma_f32_16x16x32_bf16 v[72:75], v[32:35], a[216:219], v[72:75]
    v_mfma_f32_16x16x32_bf16 v[76:79], v[32:35], a[220:223], v[76:79]
    s_waitcnt lgkmcnt(2)
    v_mfma_f32_16x16x32_bf16 v[76:79], v[48:51], a[236:239], v[76:79]
    v_mfma_f32_16x16x32_bf16 v[72:75], v[48:51], a[232:235], v[72:75]
    v_mfma_f32_16x16x32_bf16 v[68:71], v[48:51], a[228:231], v[68:71]
    v_mfma_f32_16x16x32_bf16 v[64:67], v[48:51], a[224:227], v[64:67]
    s_waitcnt lgkmcnt(0)
    v_mfma_f32_16x16x32_bf16 v[64:67], v[24:27], a[240:243], v[64:67]
    v_mfma_f32_16x16x32_bf16 v[68:71], v[24:27], a[244:247], v[68:71]
    v_mfma_f32_16x16x32_bf16 v[72:75], v[24:27], a[248:251], v[72:75]
    v_mfma_f32_16x16x32_bf16 v[76:79], v[24:27], a[252:255], v[76:79]
    s_nop 4
    v_cvt_pk_bf16_f32 v96, v64, v65
    v_cvt_pk_bf16_f32 v97, v66, v67
    v_cvt_pk_bf16_f32 v98, v68, v69
    v_cvt_pk_bf16_f32 v99, v70, v71
    v_cvt_pk_bf16_f32 v100, v72, v73
    v_cvt_pk_bf16_f32 v101, v74, v75
    v_cvt_pk_bf16_f32 v102, v76, v77
    v_cvt_pk_bf16_f32 v103, v78, v79
    v_permlane16_swap_b32 v96, v98
    v_permlane16_swap_b32 v97, v99
    v_permlane16_swap_b32 v100, v102
    v_permlane16_swap_b32 v101, v103
    s_lshl_b32 s39, s46, 13
    buffer_store_dwordx4 v[96:99], v1, s[28:31], s39 offen offset:0 sc1
    buffer_store_dwordx4 v[100:103], v1, s[28:31], s39 offen offset:1024 sc1
    s_mov_b64 exec, 0xff
    global_load_dword v120, v114, s[74:75] sc1
    s_mov_b64 exec, -1
    s_waitcnt vmcnt(0)
    s_barrier
    s_cmp_lg_u32 s3, 0
    s_cbranch_scc1 L_r1
    s_mov_b64 exec, 1
    global_store_dword v118, v119, s[74:75] sc1
    s_mov_b64 exec, -1
L_r1:
    s_mov_b32 s69, 0
    v_cmp_eq_u32 vcc, s51, v120
    s_nop 0
    s_and_b32 s61, vcc_lo, 0xff
    s_andn2_b32 s61, s61, s60
    s_bitset1_b32 s61, s47
L_r2:
    s_or_b32 s60, s60, s61
    s_bitcmp1_b32 s61, 0
    s_cbranch_scc0 L_f_0
    buffer_load_dwordx4 v[160:163], v112, s[8:11], s52 offen sc1
    buffer_load_dwordx4 v[192:195], v117, s[8:11], s52 offen sc1
L_f_0:
    s_bitcmp1_b32 s61, 1
    s_cbranch_scc0 L_f_1
    buffer_load_dwordx4 v[164:167], v112, s[8:11], s53 offen sc1
    buffer_load_dwordx4 v[196:199], v117, s[8:11], s53 offen sc1
L_f_1:
    s_bitcmp1_b32 s61, 2
    s_cbranch_scc0 L_f_2
    buffer_load_dwordx4 v[168:171], v112, s[8:11], s54 offen sc1
    buffer_load_dwordx4 v[200:203], v117, s[8:11], s54 offen sc1
L_f_2:
    s_bitcmp1_b32 s61, 3
    s_cbranch_scc0 L_f_3
    buffer_load_dwordx4 v[172:175], v112, s[8:11], s55 offen sc1
    buffer_load_dwordx4 v[204:207], v117, s[8:11], s55 offen sc1
L_f_3:
    s_bitcmp1_b32 s61, 4
    s_cbranch_scc0 L_f_4
    buffer_load_dwordx4 v[176:179], v112, s[8:11], s56 offen sc1
    buffer_load_dwordx4 v[208:211], v117, s[8:11], s56 offen sc1
L_f_4:
    s_bitcmp1_b32 s61, 5
    s_cbranch_scc0 L_f_5
    buffer_load_dwordx4 v[180:183], v112, s[8:11], s57 offen sc1
    buffer_load_dwordx4 v[212:215], v117, s[8:11], s57 offen sc1
L_f_5:
    s_bitcmp1_b32 s61, 6
    s_cbranch_scc0 L_f_6
    buffer_load_dwordx4 v[184:187], v112, s[8:11], s58 offen sc1
    buffer_load_dwordx4 v[216:219], v117, s[8:11], s58 offen sc1
L_f_6:
    s_bitcmp1_b32 s61, 7
    s_cbranch_scc0 L_f_7
    buffer_load_dwordx4 v[188:191], v112, s[8:11], s59 offen sc1
    buffer_load_dwordx4 v[220:223], v117, s[8:11], s59 offen sc1
L_f_7:
    s_cmp_eq_u32 s60, 0xff
    s_cbranch_scc1 L_r3
    s_add_u32 s69, s69, 1
    s_cmp_ge_u32 s69, 0x40000
    s_cbranch_scc1 L_r3
    s_mov_b64 exec, 0xff
    global_load_dword v120, v114, s[74:75] sc1
    s_mov_b64 exec, -1
    s_waitcnt vmcnt(0)
    v_cmp_eq_u32 vcc, s51, v120
    s_nop 0
    s_and_b32 s61, vcc_lo, 0xff
    s_andn2_b32 s61, s61, s60
    s_branch L_r2
L_r3:
    s_waitcnt vmcnt(0)
    v_lshlrev_b32 v140, 16, v160
    v_and_b32 v141, 0xffff0000, v160
    v_lshlrev_b32 v142, 16, v161
    v_and_b32 v143, 0xffff0000, v161
    v_lshlrev_b32 v144, 16, v162
    v_and_b32 v145, 0xffff0000, v162
    v_lshlrev_b32 v146, 16, v163
    v_and_b32 v147, 0xffff0000, v163
    v_lshlrev_b32 v148, 16, v164
    v_and_b32 v149, 0xffff0000, v164
    v_pk_add_f32 v[140:141], v[140:141], v[148:149]
    v_lshlrev_b32 v150, 16, v165
    v_and_b32 v151, 0xffff0000, v165
    v_pk_add_f32 v[142:143], v[142:143], v[150:151]
    v_lshlrev_b32 v152, 16, v166
    v_and_b32 v153, 0xffff0000, v166
    v_pk_add_f32 v[144:145], v[144:145], v[152:153]
    v_lshlrev_b32 v154, 16, v167
    v_and_b32 v155, 0xffff0000, v167
    v_pk_add_f32 v[146:147], v[146:147], v[154:155]
    v_lshlrev_b32 v148, 16, v168
    v_and_b32 v149, 0xffff0000, v168
    v_pk_add_f32 v[140:141], v[140:141], v[148:149]
    v_lshlrev_b32 v150, 16, v169
    v_and_b32 v151, 0xffff0000, v169
    v_pk_add_f32 v[142:143], v[142:143], v[150:151]
    v_lshlrev_b32 v152, 16, v170
    v_and_b32 v153, 0xffff0000, v170
    v_pk_add_f32 v[144:145], v[144:145], v[152:153]
    v_lshlrev_b32 v154, 16, v171
    v_and_b32 v155, 0xffff0000, v171
    v_pk_add_f32 v[146:147], v[146:147], v[154:155]
    v_lshlrev_b32 v148, 16, v172
    v_and_b32 v149, 0xffff0000, v172
    v_pk_add_f32 v[140:141], v[140:141], v[148:149]
    v_lshlrev_b32 v150, 16, v173
    v_and_b32 v151, 0xffff0000, v173
    v_pk_add_f32 v[142:143], v[142:143], v[150:151]
    v_lshlrev_b32 v152, 16, v174
    v_and_b32 v153, 0xffff0000, v174
    v_pk_add_f32 v[144:145], v[144:145], v[152:153]
    v_lshlrev_b32 v154, 16, v175
    v_and_b32 v155, 0xffff0000, v175
    v_pk_add_f32 v[146:147], v[146:147], v[154:155]
    v_lshlrev_b32 v148, 16, v176
    v_and_b32 v149, 0xffff0000, v176
    v_pk_add_f32 v[140:141], v[140:141], v[148:149]
    v_lshlrev_b32 v150, 16, v177
    v_and_b32 v151, 0xffff0000, v177
    v_pk_add_f32 v[142:143], v[142:143], v[150:151]
    v_lshlrev_b32 v152, 16, v178
    v_and_b32 v153, 0xffff0000, v178
    v_pk_add_f32 v[144:145], v[144:145], v[152:153]
    v_lshlrev_b32 v154, 16, v179
    v_and_b32 v155, 0xffff0000, v179
    v_pk_add_f32 v[146:147], v[146:147], v[154:155]
    v_lshlrev_b32 v148, 16, v180
    v_and_b32 v149, 0xffff0000, v180
    v_pk_add_f32 v[140:141], v[140:141], v[148:149]
    v_lshlrev_b32 v150, 16, v181
    v_and_b32 v151, 0xffff0000, v181
    v_pk_add_f32 v[142:143], v[142:143], v[150:151]
    v_lshlrev_b32 v152, 16, v182
    v_and_b32 v153, 0xffff0000, v182
    v_pk_add_f32 v[144:145], v[144:145], v[152:153]
    v_lshlrev_b32 v154, 16, v183
    v_and_b32 v155, 0xffff0000, v183
    v_pk_add_f32 v[146:147], v[146:147], v[154:155]
    v_lshlrev_b32 v148, 16, v184
    v_and_b32 v149, 0xffff0000, v184
    v_pk_add_f32 v[140:141], v[140:141], v[148:149]
    v_lshlrev_b32 v150, 16, v185
    v_and_b32 v151, 0xffff0000, v185
    v_pk_add_f32 v[142:143], v[142:143], v[150:151]
    v_lshlrev_b32 v152, 16, v186
    v_and_b32 v153, 0xffff0000, v186
    v_pk_add_f32 v[144:145], v[144:145], v[152:153]
    v_lshlrev_b32 v154, 16, v187
    v_and_b32 v155, 0xffff0000, v187
    v_pk_add_f32 v[146:147], v[146:147], v[154:155]
    v_lshlrev_b32 v148, 16, v188
    v_and_b32 v149, 0xffff0000, v188
    v_pk_add_f32 v[140:141], v[140:141], v[148:149]
    v_lshlrev_b32 v150, 16, v189
    v_and_b32 v151, 0xffff0000, v189
    v_pk_add_f32 v[142:143], v[142:143], v[150:151]
    v_lshlrev_b32 v152, 16, v190
    v_and_b32 v153, 0xffff0000, v190
    v_pk_add_f32 v[144:145], v[144:145], v[152:153]
    v_lshlrev_b32 v154, 16, v191
    v_and_b32 v155, 0xffff0000, v191
    v_pk_add_f32 v[146:147], v[146:147], v[154:155]
    v_cvt_pk_bf16_f32 v156, v140, v141
    v_cvt_pk_bf16_f32 v157, v142, v143
    v_cvt_pk_bf16_f32 v158, v144, v145
    v_cvt_pk_bf16_f32 v159, v146, v147
    buffer_store_dwordx4 v[156:159], v113, s[12:15], 0 offen offset:0
    s_cmp_eq_u32 s3, 3
    s_cbranch_scc1 L_r5
    v_lshlrev_b32 v140, 16, v192
    v_and_b32 v141, 0xffff0000, v192
    v_lshlrev_b32 v142, 16, v193
    v_and_b32 v143, 0xffff0000, v193
    v_lshlrev_b32 v144, 16, v194
    v_and_b32 v145, 0xffff0000, v194
    v_lshlrev_b32 v146, 16, v195
    v_and_b32 v147, 0xffff0000, v195
    v_lshlrev_b32 v148, 16, v196
    v_and_b32 v149, 0xffff0000, v196
    v_pk_add_f32 v[140:141], v[140:141], v[148:149]
    v_lshlrev_b32 v150, 16, v197
    v_and_b32 v151, 0xffff0000, v197
    v_pk_add_f32 v[142:143], v[142:143], v[150:151]
    v_lshlrev_b32 v152, 16, v198
    v_and_b32 v153, 0xffff0000, v198
    v_pk_add_f32 v[144:145], v[144:145], v[152:153]
    v_lshlrev_b32 v154, 16, v199
    v_and_b32 v155, 0xffff0000, v199
    v_pk_add_f32 v[146:147], v[146:147], v[154:155]
    v_lshlrev_b32 v148, 16, v200
    v_and_b32 v149, 0xffff0000, v200
    v_pk_add_f32 v[140:141], v[140:141], v[148:149]
    v_lshlrev_b32 v150, 16, v201
    v_and_b32 v151, 0xffff0000, v201
    v_pk_add_f32 v[142:143], v[142:143], v[150:151]
    v_lshlrev_b32 v152, 16, v202
    v_and_b32 v153, 0xffff0000, v202
    v_pk_add_f32 v[144:145], v[144:145], v[152:153]
    v_lshlrev_b32 v154, 16, v203
    v_and_b32 v155, 0xffff0000, v203
    v_pk_add_f32 v[146:147], v[146:147], v[154:155]
    v_lshlrev_b32 v148, 16, v204
    v_and_b32 v149, 0xffff0000, v204
    v_pk_add_f32 v[140:141], v[140:141], v[148:149]
    v_lshlrev_b32 v150, 16, v205
    v_and_b32 v151, 0xffff0000, v205
    v_pk_add_f32 v[142:143], v[142:143], v[150:151]
    v_lshlrev_b32 v152, 16, v206
    v_and_b32 v153, 0xffff0000, v206
    v_pk_add_f32 v[144:145], v[144:145], v[152:153]
    v_lshlrev_b32 v154, 16, v207
    v_and_b32 v155, 0xffff0000, v207
    v_pk_add_f32 v[146:147], v[146:147], v[154:155]
    v_lshlrev_b32 v148, 16, v208
    v_and_b32 v149, 0xffff0000, v208
    v_pk_add_f32 v[140:141], v[140:141], v[148:149]
    v_lshlrev_b32 v150, 16, v209
    v_and_b32 v151, 0xffff0000, v209
    v_pk_add_f32 v[142:143], v[142:143], v[150:151]
    v_lshlrev_b32 v152, 16, v210
    v_and_b32 v153, 0xffff0000, v210
    v_pk_add_f32 v[144:145], v[144:145], v[152:153]
    v_lshlrev_b32 v154, 16, v211
    v_and_b32 v155, 0xffff0000, v211
    v_pk_add_f32 v[146:147], v[146:147], v[154:155]
    v_lshlrev_b32 v148, 16, v212
    v_and_b32 v149, 0xffff0000, v212
    v_pk_add_f32 v[140:141], v[140:141], v[148:149]
    v_lshlrev_b32 v150, 16, v213
    v_and_b32 v151, 0xffff0000, v213
    v_pk_add_f32 v[142:143], v[142:143], v[150:151]
    v_lshlrev_b32 v152, 16, v214
    v_and_b32 v153, 0xffff0000, v214
    v_pk_add_f32 v[144:145], v[144:145], v[152:153]
    v_lshlrev_b32 v154, 16, v215
    v_and_b32 v155, 0xffff0000, v215
    v_pk_add_f32 v[146:147], v[146:147], v[154:155]
    v_lshlrev_b32 v148, 16, v216
    v_and_b32 v149, 0xffff0000, v216
    v_pk_add_f32 v[140:141], v[140:141], v[148:149]
    v_lshlrev_b32 v150, 16, v217
    v_and_b32 v151, 0xffff0000, v217
    v_pk_add_f32 v[142:143], v[142:143], v[150:151]
    v_lshlrev_b32 v152, 16, v218
    v_and_b32 v153, 0xffff0000, v218
    v_pk_add_f32 v[144:145], v[144:145], v[152:153]
    v_lshlrev_b32 v154, 16, v219
    v_and_b32 v155, 0xffff0000, v219
    v_pk_add_f32 v[146:147], v[146:147], v[154:155]
    v_lshlrev_b32 v148, 16, v220
    v_and_b32 v149, 0xffff0000, v220
    v_pk_add_f32 v[140:141], v[140:141], v[148:149]
    v_lshlrev_b32 v150, 16, v221
    v_and_b32 v151, 0xffff0000, v221
    v_pk_add_f32 v[142:143], v[142:143], v[150:151]
    v_lshlrev_b32 v152, 16, v222
    v_and_b32 v153, 0xffff0000, v222
    v_pk_add_f32 v[144:145], v[144:145], v[152:153]
    v_lshlrev_b32 v154, 16, v223
    v_and_b32 v155, 0xffff0000, v223
    v_pk_add_f32 v[146:147], v[146:147], v[154:155]
    v_cvt_pk_bf16_f32 v156, v140, v141
    v_cvt_pk_bf16_f32 v157, v142, v143
    v_cvt_pk_bf16_f32 v158, v144, v145
    v_cvt_pk_bf16_f32 v159, v146, v147
    buffer_store_dwordx4 v[156:159], v113, s[12:15], 0 offen offset:512
L_r5:
L_end:
    s_endpgm
L_tr0:
    s_call_b64 s[72:73], L_rare1
    s_branch L_ret0
L_tr1:
    s_call_b64 s[72:73], L_rare0
    s_branch L_ret1
L_tr2:
    s_call_b64 s[72:73], L_rare1
    s_branch L_ret2
L_tr3:
    s_call_b64 s[72:73], L_rare0
    s_branch L_ret3
L_chk:
    s_nop 7
    v_max3_f32 v11, v96, v97, v98
    v_max3_f32 v11, v11, v99, v104
    v_max3_f32 v11, v11, v105, v106
    v_max3_f32 v11, v11, v107, v112
    v_max3_f32 v11, v11, v113, v114
    v_max3_f32 v11, v11, v115, v120
    v_max3_f32 v11, v11, v121, v122
    v_max3_f32 v11, v11, v123, v100
    v_max3_f32 v11, v11, v101, v102
    v_max3_f32 v11, v11, v103, v108
    v_max3_f32 v11, v11, v109, v110
    v_max3_f32 v11, v11, v111, v116
    v_max3_f32 v11, v11, v117, v118
    v_max3_f32 v11, v11, v119, v124
    v_max3_f32 v11, v11, v125, v126
    v_max3_f32 v11, v11, v127, v127
    v_cmp_lt_f32 vcc, 0x41200000, v11
    s_nop 1
    s_cbranch_vccz L_retT
    s_call_b64 s[72:73], L_rare1
    s_branch L_retT
L_redo:
    s_waitcnt vmcnt(0) lgkmcnt(0)
    s_barrier
    s_mov_b32 s101, 1
    s_mov_b32 s2, s100
    s_lshl_b32 s37, s3, 6
    v_add_u32 v0, s37, v0
    s_branch L_again
L_non_slow:
    v_mov_b32 v16, 0
    s_mov_b32 s69, 0
    s_mov_b64 exec, 1
L_non_spin:
    global_load_dword v121, v16, s[76:77] sc1
    s_add_u32 s69, s69, 1
    s_waitcnt vmcnt(0)
    v_readfirstlane_b32 s51, v121
    s_cmp_ge_u32 s69, 0x40000
    s_cbranch_scc1 L_non_out
    s_cmp_eq_u32 s51, 0
    s_cbranch_scc1 L_non_spin
L_non_out:
    s_mov_b64 exec, -1
    s_branch L_non_ok
L_rare0:
    s_nop 7
    s_nop 1
    v_max3_f32 v16, v64, v65, v66
    v_max3_f32 v16, v16, v67, v68
    v_max3_f32 v16, v16, v69, v70
    v_max_f32 v16, v16, v71
    v_max3_f32 v17, v72, v73, v74
    v_max3_f32 v17, v17, v75, v76
    v_max3_f32 v17, v17, v77, v78
    v_max_f32 v17, v17, v79
    v_max3_f32 v18, v80, v81, v82
    v_max3_f32 v18, v18, v83, v84
    v_max3_f32 v18, v18, v85, v86
    v_max_f32 v18, v18, v87
    v_max3_f32 v19, v88, v89, v90
    v_max3_f32 v19, v19, v91, v92
    v_max3_f32 v19, v19, v93, v94
    v_max_f32 v19, v19, v95
    v_mov_b32 v20, v16
    v_mov_b32 v21, v17
    v_mov_b32 v22, v18
    v_mov_b32 v23, v19
    v_permlane32_swap_b32 v16, v20
    v_permlane32_swap_b32 v17, v21
    v_permlane32_swap_b32 v18, v22
    v_permlane32_swap_b32 v19, v23
    v_max_f32 v16, v16, v20
    v_max_f32 v17, v17, v21
    v_max_f32 v18, v18, v22
    v_max_f32 v19, v19, v23
    v_mov_b32 v20, v16
    v_mov_b32 v21, v17
    v_mov_b32 v22, v18
    v_mov_b32 v23, v19
    v_permlane16_swap_b32 v16, v20
    v_permlane16_swap_b32 v17, v21
    v_permlane16_swap_b32 v18, v22
    v_permlane16_swap_b32 v19, v23
    v_max_f32 v16, v16, v20
    v_max_f32 v17, v17, v21
    v_max_f32 v18, v18, v22
    v_max_f32 v19, v19, v23
    v_max_f32 v16, 0, v16
    v_ceil_f32 v16, v16
    v_exp_f32 v20, -v16
    v_max_f32 v17, 0, v17
    v_ceil_f32 v17, v17
    v_exp_f32 v21, -v17
    v_max_f32 v18, 0, v18
    v_ceil_f32 v18, v18
    v_exp_f32 v22, -v18
    v_max_f32 v19, 0, v19
    v_ceil_f32 v19, v19
    v_exp_f32 v23, -v19
    v_sub_f32 v64, v64, v16
    v_sub_f32 v65, v65, v16
    v_sub_f32 v66, v66, v16
    v_sub_f32 v67, v67, v16
    v_sub_f32 v68, v68, v16
    v_sub_f32 v69, v69, v16
    v_sub_f32 v70, v70, v16
    v_sub_f32 v71, v71, v16
    v_sub_f32 v48, v48, v16
    v_sub_f32 v49, v49, v16
    v_sub_f32 v50, v50, v16
    v_sub_f32 v51, v51, v16
    v_mul_f32 v12, v12, v20
    v_sub_f32 v72, v72, v17
    v_sub_f32 v73, v73, v17
    v_sub_f32 v74, v74, v17
    v_sub_f32 v75, v75, v17
    v_sub_f32 v76, v76, v17
    v_sub_f32 v77, v77, v17
    v_sub_f32 v78, v78, v17
    v_sub_f32 v79, v79, v17
    v_sub_f32 v52, v52, v17
    v_sub_f32 v53, v53, v17
    v_sub_f32 v54, v54, v17
    v_sub_f32 v55, v55, v17
    v_mul_f32 v13, v13, v21
    v_sub_f32 v80, v80, v18
    v_sub_f32 v81, v81, v18
    v_sub_f32 v82, v82, v18
    v_sub_f32 v83, v83, v18
    v_sub_f32 v84, v84, v18
    v_sub_f32 v85, v85, v18
    v_sub_f32 v86, v86, v18
    v_sub_f32 v87, v87, v18
    v_sub_f32 v56, v56, v18
    v_sub_f32 v57, v57, v18
    v_sub_f32 v58, v58, v18
    v_sub_f32 v59, v59, v18
    v_mul_f32 v14, v14, v22
    v_sub_f32 v88, v88, v19
    v_sub_f32 v89, v89, v19
    v_sub_f32 v90, v90, v19
    v_sub_f32 v91, v91, v19
    v_sub_f32 v92, v92, v19
    v_sub_f32 v93, v93, v19
    v_sub_f32 v94, v94, v19
    v_sub_f32 v95, v95, v19
    v_sub_f32 v60, v60, v19
    v_sub_f32 v61, v61, v19
    v_sub_f32 v62, v62, v19
    v_sub_f32 v63, v63, v19
    v_mul_f32 v15, v15, v23
    v_lshlrev_b32 v16, 16, v96
    v_and_b32 v17, 0xffff0000, v96
    v_mul_f32 v16, v16, v20
    v_mul_f32 v17, v17, v20
    v_cvt_pk_bf16_f32 v96, v16, v17
    v_lshlrev_b32 v16, 16, v97
    v_and_b32 v17, 0xffff0000, v97
    v_mul_f32 v16, v16, v20
    v_mul_f32 v17, v17, v20
    v_cvt_pk_bf16_f32 v97, v16, v17
    v_lshlrev_b32 v16, 16, v98
    v_and_b32 v17, 0xffff0000, v98
    v_mul_f32 v16, v16, v20
    v_mul_f32 v17, v17, v20
    v_cvt_pk_bf16_f32 v98, v16, v17
    v_lshlrev_b32 v16, 16, v99
    v_and_b32 v17, 0xffff0000, v99
    v_mul_f32 v16, v16, v20
    v_mul_f32 v17, v17, v20
    v_cvt_pk_bf16_f32 v99, v16, v17
    v_lshlrev_b32 v16, 16, v104
    v_and_b32 v17, 0xffff0000, v104
    v_mul_f32 v16, v16, v21
    v_mul_f32 v17, v17, v21
    v_cvt_pk_bf16_f32 v104, v16, v17
    v_lshlrev_b32 v16, 16, v105
    v_and_b32 v17, 0xffff0000, v105
    v_mul_f32 v16, v16, v21
    v_mul_f32 v17, v17, v21
    v_cvt_pk_bf16_f32 v105, v16, v17
    v_lshlrev_b32 v16, 16, v106
    v_and_b32 v17, 0xffff0000, v106
    v_mul_f32 v16, v16, v21
    v_mul_f32 v17, v17, v21
    v_cvt_pk_bf16_f32 v106, v16, v17
    v_lshlrev_b32 v16, 16, v107
    v_and_b32 v17, 0xffff0000, v107
    v_mul_f32 v16, v16, v21
    v_mul_f32 v17, v17, v21
    v_cvt_pk_bf16_f32 v107, v16, v17
    v_lshlrev_b32 v16, 16, v112
    v_and_b32 v17, 0xffff0000, v112
    v_mul_f32 v16, v16, v22
    v_mul_f32 v17, v17, v22
    v_cvt_pk_bf16_f32 v112, v16, v17
    v_lshlrev_b32 v16, 16, v113
    v_and_b32 v17, 0xffff0000, v113
    v_mul_f32 v16, v16, v22
    v_mul_f32 v17, v17, v22
    v_cvt_pk_bf16_f32 v113, v16, v17
    v_lshlrev_b32 v16, 16, v114
    v_and_b32 v17, 0xffff0000, v114
    v_mul_f32 v16, v16, v22
    v_mul_f32 v17, v17, v22
    v_cvt_pk_bf16_f32 v114, v16, v17
    v_lshlrev_b32 v16, 16, v115
    v_and_b32 v17, 0xffff0000, v115
    v_mul_f32 v16, v16, v22
    v_mul_f32 v17, v17, v22
    v_cvt_pk_bf16_f32 v115, v16, v17
    v_lshlrev_b32 v16, 16, v120
    v_and_b32 v17, 0xffff0000, v120
    v_mul_f32 v16, v16, v23
    v_mul_f32 v17, v17, v23
    v_cvt_pk_bf16_f32 v120, v16, v17
    v_lshlrev_b32 v16, 16, v121
    v_and_b32 v17, 0xffff0000, v121
    v_mul_f32 v16, v16, v23
    v_mul_f32 v17, v17, v23
    v_cvt_pk_bf16_f32 v121, v16, v17
    v_lshlrev_b32 v16, 16, v122
    v_and_b32 v17, 0xffff0000, v122
    v_mul_f32 v16, v16, v23
    v_mul_f32 v17, v17, v23
    v_cvt_pk_bf16_f32 v122, v16, v17
    v_lshlrev_b32 v16, 16, v123
    v_and_b32 v17, 0xffff0000, v123
    v_mul_f32 v16, v16, v23
    v_mul_f32 v17, v17, v23
    v_cvt_pk_bf16_f32 v123, v16, v17
    v_mul_f32 v128, v128, v20
    v_mul_f32 v129, v129, v20
    v_mul_f32 v130, v130, v20
    v_mul_f32 v131, v131, v20
    v_mul_f32 v132, v132, v21
    v_mul_f32 v133, v133, v21
    v_mul_f32 v134, v134, v21
    v_mul_f32 v135, v135, v21
    v_accvgpr_read_b32 v16, a128
    v_mul_f32 v16, v16, v22
    v_accvgpr_write_b32 a128, v16
    v_accvgpr_read_b32 v17, a129
    v_mul_f32 v17, v17, v22
    v_accvgpr_write_b32 a129, v17
    v_accvgpr_read_b32 v18, a130
    v_mul_f32 v18, v18, v22
    v_accvgpr_write_b32 a130, v18
    v_accvgpr_read_b32 v19, a131
    v_mul_f32 v19, v19, v22
    v_accvgpr_write_b32 a131, v19
    v_accvgpr_read_b32 v16, a132
    v_mul_f32 v16, v16, v23
    v_accvgpr_write_b32 a132, v16
    v_accvgpr_read_b32 v17, a133
    v_mul_f32 v17, v17, v23
    v_accvgpr_write_b32 a133, v17
    v_accvgpr_read_b32 v18, a134
    v_mul_f32 v18, v18, v23
    v_accvgpr_write_b32 a134, v18
    v_accvgpr_read_b32 v19, a135
    v_mul_f32 v19, v19, v23
    v_accvgpr_write_b32 a135, v19
    v_mul_f32 v136, v136, v20
    v_mul_f32 v137, v137, v20
    v_mul_f32 v138, v138, v20
    v_mul_f32 v139, v139, v20
    v_mul_f32 v140, v140, v21
    v_mul_f32 v141, v141, v21
    v_mul_f32 v142, v142, v21
    v_mul_f32 v143, v143, v21
    v_accvgpr_read_b32 v16, a136
    v_mul_f32 v16, v16, v22
    v_accvgpr_write_b32 a136, v16
    v_accvgpr_read_b32 v17, a137
    v_mul_f32 v17, v17, v22
    v_accvgpr_write_b32 a137, v17
    v_accvgpr_read_b32 v18, a138
    v_mul_f32 v18, v18, v22
    v_accvgpr_write_b32 a138, v18
    v_accvgpr_read_b32 v19, a139
    v_mul_f32 v19, v19, v22
    v_accvgpr_write_b32 a139, v19
    v_accvgpr_read_b32 v16, a140
    v_mul_f32 v16, v16, v23
    v_accvgpr_write_b32 a140, v16
    v_accvgpr_read_b32 v17, a141
    v_mul_f32 v17, v17, v23
    v_accvgpr_write_b32 a141, v17
    v_accvgpr_read_b32 v18, a142
    v_mul_f32 v18, v18, v23
    v_accvgpr_write_b32 a142, v18
    v_accvgpr_read_b32 v19, a143
    v_mul_f32 v19, v19, v23
    v_accvgpr_write_b32 a143, v19
    v_mul_f32 v144, v144, v20
    v_mul_f32 v145, v145, v20
    v_mul_f32 v146, v146, v20
    v_mul_f32 v147, v147, v20
    v_mul_f32 v148, v148, v21
    v_mul_f32 v149, v149, v21
    v_mul_f32 v150, v150, v21
    v_mul_f32 v151, v151, v21
    v_accvgpr_read_b32 v16, a144
    v_mul_f32 v16, v16, v22
    v_accvgpr_write_b32 a144, v16
    v_accvgpr_read_b32 v17, a145
    v_mul_f32 v17, v17, v22
    v_accvgpr_write_b32 a145, v17
    v_accvgpr_read_b32 v18, a146
    v_mul_f32 v18, v18, v22
    v_accvgpr_write_b32 a146, v18
    v_accvgpr_read_b32 v19, a147
    v_mul_f32 v19, v19, v22
    v_accvgpr_write_b32 a147, v19
    v_accvgpr_read_b32 v16, a148
    v_mul_f32 v16, v16, v23
    v_accvgpr_write_b32 a148, v16
    v_accvgpr_read_b32 v17, a149
    v_mul_f32 v17, v17, v23
    v_accvgpr_write_b32 a149, v17
    v_accvgpr_read_b32 v18, a150
    v_mul_f32 v18, v18, v23
    v_accvgpr_write_b32 a150, v18
    v_accvgpr_read_b32 v19, a151
    v_mul_f32 v19, v19, v23
    v_accvgpr_write_b32 a151, v19
    v_mul_f32 v152, v152, v20
    v_mul_f32 v153, v153, v20
    v_mul_f32 v154, v154, v20
    v_mul_f32 v155, v155, v20
    v_mul_f32 v156, v156, v21
    v_mul_f32 v157, v157, v21
    v_mul_f32 v158, v158, v21
    v_mul_f32 v159, v159, v21
    v_accvgpr_read_b32 v16, a152
    v_mul_f32 v16, v16, v22
    v_accvgpr_write_b32 a152, v16
    v_accvgpr_read_b32 v17, a153
    v_mul_f32 v17, v17, v22
    v_accvgpr_write_b32 a153, v17
    v_accvgpr_read_b32 v18, a154
    v_mul_f32 v18, v18, v22
    v_accvgpr_write_b32 a154, v18
    v_accvgpr_read_b32 v19, a155
    v_mul_f32 v19, v19, v22
    v_accvgpr_write_b32 a155, v19
    v_accvgpr_read_b32 v16, a156
    v_mul_f32 v16, v16, v23
    v_accvgpr_write_b32 a156, v16
    v_accvgpr_read_b32 v17, a157
    v_mul_f32 v17, v17, v23
    v_accvgpr_write_b32 a157, v17
    v_accvgpr_read_b32 v18, a158
    v_mul_f32 v18, v18, v23
    v_accvgpr_write_b32 a158, v18
    v_accvgpr_read_b32 v19, a159
    v_mul_f32 v19, v19, v23
    v_accvgpr_write_b32 a159, v19
    v_mul_f32 v160, v160, v20
    v_mul_f32 v161, v161, v20
    v_mul_f32 v162, v162, v20
    v_mul_f32 v163, v163, v20
    v_mul_f32 v164, v164, v21
    v_mul_f32 v165, v165, v21
    v_mul_f32 v166, v166, v21
    v_mul_f32 v167, v167, v21
    v_accvgpr_read_b32 v16, a160
    v_mul_f32 v16, v16, v22
    v_accvgpr_write_b32 a160, v16
    v_accvgpr_read_b32 v17, a161
    v_mul_f32 v17, v17, v22
    v_accvgpr_write_b32 a161, v17
    v_accvgpr_read_b32 v18, a162
    v_mul_f32 v18, v18, v22
    v_accvgpr_write_b32 a162, v18
    v_accvgpr_read_b32 v19, a163
    v_mul_f32 v19, v19, v22
    v_accvgpr_write_b32 a163, v19
    v_accvgpr_read_b32 v16, a164
    v_mul_f32 v16, v16, v23
    v_accvgpr_write_b32 a164, v16
    v_accvgpr_read_b32 v17, a165
    v_mul_f32 v17, v17, v23
    v_accvgpr_write_b32 a165, v17
    v_accvgpr_read_b32 v18, a166
    v_mul_f32 v18, v18, v23
    v_accvgpr_write_b32 a166, v18
    v_accvgpr_read_b32 v19, a167
    v_mul_f32 v19, v19, v23
    v_accvgpr_write_b32 a167, v19
    v_mul_f32 v168, v168, v20
    v_mul_f32 v169, v169, v20
    v_mul_f32 v170, v170, v20
    v_mul_f32 v171, v171, v20
    v_mul_f32 v172, v172, v21
    v_mul_f32 v173, v173, v21
    v_mul_f32 v174, v174, v21
    v_mul_f32 v175, v175, v21
    v_accvgpr_read_b32 v16, a168
    v_mul_f32 v16, v16, v22
    v_accvgpr_write_b32 a168, v16
    v_accvgpr_read_b32 v17, a169
    v_mul_f32 v17, v17, v22
    v_accvgpr_write_b32 a169, v17
    v_accvgpr_read_b32 v18, a170
    v_mul_f32 v18, v18, v22
    v_accvgpr_write_b32 a170, v18
    v_accvgpr_read_b32 v19, a171
    v_mul_f32 v19, v19, v22
    v_accvgpr_write_b32 a171, v19
    v_accvgpr_read_b32 v16, a172
    v_mul_f32 v16, v16, v23
    v_accvgpr_write_b32 a172, v16
    v_accvgpr_read_b32 v17, a173
    v_mul_f32 v17, v17, v23
    v_accvgpr_write_b32 a173, v17
    v_accvgpr_read_b32 v18, a174
    v_mul_f32 v18, v18, v23
    v_accvgpr_write_b32 a174, v18
    v_accvgpr_read_b32 v19, a175
    v_mul_f32 v19, v19, v23
    v_accvgpr_write_b32 a175, v19
    v_mul_f32 v176, v176, v20
    v_mul_f32 v177, v177, v20
    v_mul_f32 v178, v178, v20
    v_mul_f32 v179, v179, v20
    v_mul_f32 v180, v180, v21
    v_mul_f32 v181, v181, v21
    v_mul_f32 v182, v182, v21
    v_mul_f32 v183, v183, v21
    v_accvgpr_read_b32 v16, a176
    v_mul_f32 v16, v16, v22
    v_accvgpr_write_b32 a176, v16
    v_accvgpr_read_b32 v17, a177
    v_mul_f32 v17, v17, v22
    v_accvgpr_write_b32 a177, v17
    v_accvgpr_read_b32 v18, a178
    v_mul_f32 v18, v18, v22
    v_accvgpr_write_b32 a178, v18
    v_accvgpr_read_b32 v19, a179
    v_mul_f32 v19, v19, v22
    v_accvgpr_write_b32 a179, v19
    v_accvgpr_read_b32 v16, a180
    v_mul_f32 v16, v16, v23
    v_accvgpr_write_b32 a180, v16
    v_accvgpr_read_b32 v17, a181
    v_mul_f32 v17, v17, v23
    v_accvgpr_write_b32 a181, v17
    v_accvgpr_read_b32 v18, a182
    v_mul_f32 v18, v18, v23
    v_accvgpr_write_b32 a182, v18
    v_accvgpr_read_b32 v19, a183
    v_mul_f32 v19, v19, v23
    v_accvgpr_write_b32 a183, v19
    v_mul_f32 v184, v184, v20
    v_mul_f32 v185, v185, v20
    v_mul_f32 v186, v186, v20
    v_mul_f32 v187, v187, v20
    v_mul_f32 v188, v188, v21
    v_mul_f32 v189, v189, v21
    v_mul_f32 v190, v190, v21
    v_mul_f32 v191, v191, v21
    v_accvgpr_read_b32 v16, a184
    v_mul_f32 v16, v16, v22
    v_accvgpr_write_b32 a184, v16
    v_accvgpr_read_b32 v17, a185
    v_mul_f32 v17, v17, v22
    v_accvgpr_write_b32 a185, v17
    v_accvgpr_read_b32 v18, a186
    v_mul_f32 v18, v18, v22
    v_accvgpr_write_b32 a186, v18
    v_accvgpr_read_b32 v19, a187
    v_mul_f32 v19, v19, v22
    v_accvgpr_write_b32 a187, v19
    v_accvgpr_read_b32 v16, a188
    v_mul_f32 v16, v16, v23
    v_accvgpr_write_b32 a188, v16
    v_accvgpr_read_b32 v17, a189
    v_mul_f32 v17, v17, v23
    v_accvgpr_write_b32 a189, v17
    v_accvgpr_read_b32 v18, a190
    v_mul_f32 v18, v18, v23
    v_accvgpr_write_b32 a190, v18
    v_accvgpr_read_b32 v19, a191
    v_mul_f32 v19, v19, v23
    v_accvgpr_write_b32 a191, v19
    v_mul_f32 v192, v192, v20
    v_mul_f32 v193, v193, v20
    v_mul_f32 v194, v194, v20
    v_mul_f32 v195, v195, v20
    v_mul_f32 v196, v196, v21
    v_mul_f32 v197, v197, v21
    v_mul_f32 v198, v198, v21
    v_mul_f32 v199, v199, v21
    v_accvgpr_read_b32 v16, a192
    v_mul_f32 v16, v16, v22
    v_accvgpr_write_b32 a192, v16
    v_accvgpr_read_b32 v17, a193
    v_mul_f32 v17, v17, v22
    v_accvgpr_write_b32 a193, v17
    v_accvgpr_read_b32 v18, a194
    v_mul_f32 v18, v18, v22
    v_accvgpr_write_b32 a194, v18
    v_accvgpr_read_b32 v19, a195
    v_mul_f32 v19, v19, v22
    v_accvgpr_write_b32 a195, v19
    v_accvgpr_read_b32 v16, a196
    v_mul_f32 v16, v16, v23
    v_accvgpr_write_b32 a196, v16
    v_accvgpr_read_b32 v17, a197
    v_mul_f32 v17, v17, v23
    v_accvgpr_write_b32 a197, v17
    v_accvgpr_read_b32 v18, a198
    v_mul_f32 v18, v18, v23
    v_accvgpr_write_b32 a198, v18
    v_accvgpr_read_b32 v19, a199
    v_mul_f32 v19, v19, v23
    v_accvgpr_write_b32 a199, v19
    v_mul_f32 v200, v200, v20
    v_mul_f32 v201, v201, v20
    v_mul_f32 v202, v202, v20
    v_mul_f32 v203, v203, v20
    v_mul_f32 v204, v204, v21
    v_mul_f32 v205, v205, v21
    v_mul_f32 v206, v206, v21
    v_mul_f32 v207, v207, v21
    v_accvgpr_read_b32 v16, a200
    v_mul_f32 v16, v16, v22
    v_accvgpr_write_b32 a200, v16
    v_accvgpr_read_b32 v17, a201
    v_mul_f32 v17, v17, v22
    v_accvgpr_write_b32 a201, v17
    v_accvgpr_read_b32 v18, a202
    v_mul_f32 v18, v18, v22
    v_accvgpr_write_b32 a202, v18
    v_accvgpr_read_b32 v19, a203
    v_mul_f32 v19, v19, v22
    v_accvgpr_write_b32 a203, v19
    v_accvgpr_read_b32 v16, a204
    v_mul_f32 v16, v16, v23
    v_accvgpr_write_b32 a204, v16
    v_accvgpr_read_b32 v17, a205
    v_mul_f32 v17, v17, v23
    v_accvgpr_write_b32 a205, v17
    v_accvgpr_read_b32 v18, a206
    v_mul_f32 v18, v18, v23
    v_accvgpr_write_b32 a206, v18
    v_accvgpr_read_b32 v19, a207
    v_mul_f32 v19, v19, v23
    v_accvgpr_write_b32 a207, v19
    v_mul_f32 v208, v208, v20
    v_mul_f32 v209, v209, v20
    v_mul_f32 v210, v210, v20
    v_mul_f32 v211, v211, v20
    v_mul_f32 v212, v212, v21
    v_mul_f32 v213, v213, v21
    v_mul_f32 v214, v214, v21
    v_mul_f32 v215, v215, v21
    v_accvgpr_read_b32 v16, a208
    v_mul_f32 v16, v16, v22
    v_accvgpr_write_b32 a208, v16
    v_accvgpr_read_b32 v17, a209
    v_mul_f32 v17, v17, v22
    v_accvgpr_write_b32 a209, v17
    v_accvgpr_read_b32 v18, a210
    v_mul_f32 v18, v18, v22
    v_accvgpr_write_b32 a210, v18
    v_accvgpr_read_b32 v19, a211
    v_mul_f32 v19, v19, v22
    v_accvgpr_write_b32 a211, v19
    v_accvgpr_read_b32 v16, a212
    v_mul_f32 v16, v16, v23
    v_accvgpr_write_b32 a212, v16
    v_accvgpr_read_b32 v17, a213
    v_mul_f32 v17, v17, v23
    v_accvgpr_write_b32 a213, v17
    v_accvgpr_read_b32 v18, a214
    v_mul_f32 v18, v18, v23
    v_accvgpr_write_b32 a214, v18
    v_accvgpr_read_b32 v19, a215
    v_mul_f32 v19, v19, v23
    v_accvgpr_write_b32 a215, v19
    v_mul_f32 v216, v216, v20
    v_mul_f32 v217, v217, v20
    v_mul_f32 v218, v218, v20
    v_mul_f32 v219, v219, v20
    v_mul_f32 v220, v220, v21
    v_mul_f32 v221, v221, v21
    v_mul_f32 v222, v222, v21
    v_mul_f32 v223, v223, v21
    v_accvgpr_read_b32 v16, a216
    v_mul_f32 v16, v16, v22
    v_accvgpr_write_b32 a216, v16
    v_accvgpr_read_b32 v17, a217
    v_mul_f32 v17, v17, v22
    v_accvgpr_write_b32 a217, v17
    v_accvgpr_read_b32 v18, a218
    v_mul_f32 v18, v18, v22
    v_accvgpr_write_b32 a218, v18
    v_accvgpr_read_b32 v19, a219
    v_mul_f32 v19, v19, v22
    v_accvgpr_write_b32 a219, v19
    v_accvgpr_read_b32 v16, a220
    v_mul_f32 v16, v16, v23
    v_accvgpr_write_b32 a220, v16
    v_accvgpr_read_b32 v17, a221
    v_mul_f32 v17, v17, v23
    v_accvgpr_write_b32 a221, v17
    v_accvgpr_read_b32 v18, a222
    v_mul_f32 v18, v18, v23
    v_accvgpr_write_b32 a222, v18
    v_accvgpr_read_b32 v19, a223
    v_mul_f32 v19, v19, v23
    v_accvgpr_write_b32 a223, v19
    v_mul_f32 v224, v224, v20
    v_mul_f32 v225, v225, v20
    v_mul_f32 v226, v226, v20
    v_mul_f32 v227, v227, v20
    v_mul_f32 v228, v228, v21
    v_mul_f32 v229, v229, v21
    v_mul_f32 v230, v230, v21
    v_mul_f32 v231, v231, v21
    v_accvgpr_read_b32 v16, a224
    v_mul_f32 v16, v16, v22
    v_accvgpr_write_b32 a224, v16
    v_accvgpr_read_b32 v17, a225
    v_mul_f32 v17, v17, v22
    v_accvgpr_write_b32 a225, v17
    v_accvgpr_read_b32 v18, a226
    v_mul_f32 v18, v18, v22
    v_accvgpr_write_b32 a226, v18
    v_accvgpr_read_b32 v19, a227
    v_mul_f32 v19, v19, v22
    v_accvgpr_write_b32 a227, v19
    v_accvgpr_read_b32 v16, a228
    v_mul_f32 v16, v16, v23
    v_accvgpr_write_b32 a228, v16
    v_accvgpr_read_b32 v17, a229
    v_mul_f32 v17, v17, v23
    v_accvgpr_write_b32 a229, v17
    v_accvgpr_read_b32 v18, a230
    v_mul_f32 v18, v18, v23
    v_accvgpr_write_b32 a230, v18
    v_accvgpr_read_b32 v19, a231
    v_mul_f32 v19, v19, v23
    v_accvgpr_write_b32 a231, v19
    v_mul_f32 v232, v232, v20
    v_mul_f32 v233, v233, v20
    v_mul_f32 v234, v234, v20
    v_mul_f32 v235, v235, v20
    v_mul_f32 v236, v236, v21
    v_mul_f32 v237, v237, v21
    v_mul_f32 v238, v238, v21
    v_mul_f32 v239, v239, v21
    v_accvgpr_read_b32 v16, a232
    v_mul_f32 v16, v16, v22
    v_accvgpr_write_b32 a232, v16
    v_accvgpr_read_b32 v17, a233
    v_mul_f32 v17, v17, v22
    v_accvgpr_write_b32 a233, v17
    v_accvgpr_read_b32 v18, a234
    v_mul_f32 v18, v18, v22
    v_accvgpr_write_b32 a234, v18
    v_accvgpr_read_b32 v19, a235
    v_mul_f32 v19, v19, v22
    v_accvgpr_write_b32 a235, v19
    v_accvgpr_read_b32 v16, a236
    v_mul_f32 v16, v16, v23
    v_accvgpr_write_b32 a236, v16
    v_accvgpr_read_b32 v17, a237
    v_mul_f32 v17, v17, v23
    v_accvgpr_write_b32 a237, v17
    v_accvgpr_read_b32 v18, a238
    v_mul_f32 v18, v18, v23
    v_accvgpr_write_b32 a238, v18
    v_accvgpr_read_b32 v19, a239
    v_mul_f32 v19, v19, v23
    v_accvgpr_write_b32 a239, v19
    v_mul_f32 v240, v240, v20
    v_mul_f32 v241, v241, v20
    v_mul_f32 v242, v242, v20
    v_mul_f32 v243, v243, v20
    v_mul_f32 v244, v244, v21
    v_mul_f32 v245, v245, v21
    v_mul_f32 v246, v246, v21
    v_mul_f32 v247, v247, v21
    v_accvgpr_read_b32 v16, a240
    v_mul_f32 v16, v16, v22
    v_accvgpr_write_b32 a240, v16
    v_accvgpr_read_b32 v17, a241
    v_mul_f32 v17, v17, v22
    v_accvgpr_write_b32 a241, v17
    v_accvgpr_read_b32 v18, a242
    v_mul_f32 v18, v18, v22
    v_accvgpr_write_b32 a242, v18
    v_accvgpr_read_b32 v19, a243
    v_mul_f32 v19, v19, v22
    v_accvgpr_write_b32 a243, v19
    v_accvgpr_read_b32 v16, a244
    v_mul_f32 v16, v16, v23
    v_accvgpr_write_b32 a244, v16
    v_accvgpr_read_b32 v17, a245
    v_mul_f32 v17, v17, v23
    v_accvgpr_write_b32 a245, v17
    v_accvgpr_read_b32 v18, a246
    v_mul_f32 v18, v18, v23
    v_accvgpr_write_b32 a246, v18
    v_accvgpr_read_b32 v19, a247
    v_mul_f32 v19, v19, v23
    v_accvgpr_write_b32 a247, v19
    v_mul_f32 v248, v248, v20
    v_mul_f32 v249, v249, v20
    v_mul_f32 v250, v250, v20
    v_mul_f32 v251, v251, v20
    v_mul_f32 v252, v252, v21
    v_mul_f32 v253, v253, v21
    v_mul_f32 v254, v254, v21
    v_mul_f32 v255, v255, v21
    v_accvgpr_read_b32 v16, a248
    v_mul_f32 v16, v16, v22
    v_accvgpr_write_b32 a248, v16
    v_accvgpr_read_b32 v17, a249
    v_mul_f32 v17, v17, v22
    v_accvgpr_write_b32 a249, v17
    v_accvgpr_read_b32 v18, a250
    v_mul_f32 v18, v18, v22
    v_accvgpr_write_b32 a250, v18
    v_accvgpr_read_b32 v19, a251
    v_mul_f32 v19, v19, v22
    v_accvgpr_write_b32 a251, v19
    v_accvgpr_read_b32 v16, a252
    v_mul_f32 v16, v16, v23
    v_accvgpr_write_b32 a252, v16
    v_accvgpr_read_b32 v17, a253
    v_mul_f32 v17, v17, v23
    v_accvgpr_write_b32 a253, v17
    v_accvgpr_read_b32 v18, a254
    v_mul_f32 v18, v18, v23
    v_accvgpr_write_b32 a254, v18
    v_accvgpr_read_b32 v19, a255
    v_mul_f32 v19, v19, v23
    v_accvgpr_write_b32 a255, v19
    s_nop 1
    s_setpc_b64 s[72:73]
L_rare1:
    s_nop 7
    s_nop 1
    v_max3_f32 v16, v96, v97, v98
    v_max3_f32 v16, v16, v99, v100
    v_max3_f32 v16, v16, v101, v102
    v_max_f32 v16, v16, v103
    v_max3_f32 v17, v104, v105, v106
    v_max3_f32 v17, v17, v107, v108
    v_max3_f32 v17, v17, v109, v110
    v_max_f32 v17, v17, v111
    v_max3_f32 v18, v112, v113, v114
    v_max3_f32 v18, v18, v115, v116
    v_max3_f32 v18, v18, v117, v118
    v_max_f32 v18, v18, v119
    v_max3_f32 v19, v120, v121, v122
    v_max3_f32 v19, v19, v123, v124
    v_max3_f32 v19, v19, v125, v126
    v_max_f32 v19, v19, v127
    v_mov_b32 v20, v16
    v_mov_b32 v21, v17
    v_mov_b32 v22, v18
    v_mov_b32 v23, v19
    v_permlane32_swap_b32 v16, v20
    v_permlane32_swap_b32 v17, v21
    v_permlane32_swap_b32 v18, v22
    v_permlane32_swap_b32 v19, v23
    v_max_f32 v16, v16, v20
    v_max_f32 v17, v17, v21
    v_max_f32 v18, v18, v22
    v_max_f32 v19, v19, v23
    v_mov_b32 v20, v16
    v_mov_b32 v21, v17
    v_mov_b32 v22, v18
    v_mov_b32 v23, v19
    v_permlane16_swap_b32 v16, v20
    v_permlane16_swap_b32 v17, v21
    v_permlane16_swap_b32 v18, v22
    v_permlane16_swap_b32 v19, v23
    v_max_f32 v16, v16, v20
    v_max_f32 v17, v17, v21
    v_max_f32 v18, v18, v22
    v_max_f32 v19, v19, v23
    v_max_f32 v16, 0, v16
    v_ceil_f32 v16, v16
    v_exp_f32 v20, -v16
    v_max_f32 v17, 0, v17
    v_ceil_f32 v17, v17
    v_exp_f32 v21, -v17
    v_max_f32 v18, 0, v18
    v_ceil_f32 v18, v18
    v_exp_f32 v22, -v18
    v_max_f32 v19, 0, v19
    v_ceil_f32 v19, v19
    v_exp_f32 v23, -v19
    v_sub_f32 v96, v96, v16
    v_sub_f32 v97, v97, v16
    v_sub_f32 v98, v98, v16
    v_sub_f32 v99, v99, v16
    v_sub_f32 v100, v100, v16
    v_sub_f32 v101, v101, v16
    v_sub_f32 v102, v102, v16
    v_sub_f32 v103, v103, v16
    v_sub_f32 v48, v48, v16
    v_sub_f32 v49, v49, v16
    v_sub_f32 v50, v50, v16
    v_sub_f32 v51, v51, v16
    v_mul_f32 v12, v12, v20
    v_sub_f32 v104, v104, v17
    v_sub_f32 v105, v105, v17
    v_sub_f32 v106, v106, v17
    v_sub_f32 v107, v107, v17
    v_sub_f32 v108, v108, v17
    v_sub_f32 v109, v109, v17
    v_sub_f32 v110, v110, v17
    v_sub_f32 v111, v111, v17
    v_sub_f32 v52, v52, v17
    v_sub_f32 v53, v53, v17
    v_sub_f32 v54, v54, v17
    v_sub_f32 v55, v55, v17
    v_mul_f32 v13, v13, v21
    v_sub_f32 v112, v112, v18
    v_sub_f32 v113, v113, v18
    v_sub_f32 v114, v114, v18
    v_sub_f32 v115, v115, v18
    v_sub_f32 v116, v116, v18
    v_sub_f32 v117, v117, v18
    v_sub_f32 v118, v118, v18
    v_sub_f32 v119, v119, v18
    v_sub_f32 v56, v56, v18
    v_sub_f32 v57, v57, v18
    v_sub_f32 v58, v58, v18
    v_sub_f32 v59, v59, v18
    v_mul_f32 v14, v14, v22
    v_sub_f32 v120, v120, v19
    v_sub_f32 v121, v121, v19
    v_sub_f32 v122, v122, v19
    v_sub_f32 v123, v123, v19
    v_sub_f32 v124, v124, v19
    v_sub_f32 v125, v125, v19
    v_sub_f32 v126, v126, v19
    v_sub_f32 v127, v127, v19
    v_sub_f32 v60, v60, v19
    v_sub_f32 v61, v61, v19
    v_sub_f32 v62, v62, v19
    v_sub_f32 v63, v63, v19
    v_mul_f32 v15, v15, v23
    v_lshlrev_b32 v16, 16, v64
    v_and_b32 v17, 0xffff0000, v64
    v_mul_f32 v16, v16, v20
    v_mul_f32 v17, v17, v20
    v_cvt_pk_bf16_f32 v64, v16, v17
    v_lshlrev_b32 v16, 16, v65
    v_and_b32 v17, 0xffff0000, v65
    v_mul_f32 v16, v16, v20
    v_mul_f32 v17, v17, v20
    v_cvt_pk_bf16_f32 v65, v16, v17
    v_lshlrev_b32 v16, 16, v66
    v_and_b32 v17, 0xffff0000, v66
    v_mul_f32 v16, v16, v20
    v_mul_f32 v17, v17, v20
    v_cvt_pk_bf16_f32 v66, v16, v17
    v_lshlrev_b32 v16, 16, v67
    v_and_b32 v17, 0xffff0000, v67
    v_mul_f32 v16, v16, v20
    v_mul_f32 v17, v17, v20
    v_cvt_pk_bf16_f32 v67, v16, v17
    v_lshlrev_b32 v16, 16, v72
    v_and_b32 v17, 0xffff0000, v72
    v_mul_f32 v16, v16, v21
    v_mul_f32 v17, v17, v21
    v_cvt_pk_bf16_f32 v72, v16, v17
    v_lshlrev_b32 v16, 16, v73
    v_and_b32 v17, 0xffff0000, v73
    v_mul_f32 v16, v16, v21
    v_mul_f32 v17, v17, v21
    v_cvt_pk_bf16_f32 v73, v16, v17
    v_lshlrev_b32 v16, 16, v74
    v_and_b32 v17, 0xffff0000, v74
    v_mul_f32 v16, v16, v21
    v_mul_f32 v17, v17, v21
    v_cvt_pk_bf16_f32 v74, v16, v17
    v_lshlrev_b32 v16, 16, v75
    v_and_b32 v17, 0xffff0000, v75
    v_mul_f32 v16, v16, v21
    v_mul_f32 v17, v17, v21
    v_cvt_pk_bf16_f32 v75, v16, v17
    v_lshlrev_b32 v16, 16, v80
    v_and_b32 v17, 0xffff0000, v80
    v_mul_f32 v16, v16, v22
    v_mul_f32 v17, v17, v22
    v_cvt_pk_bf16_f32 v80, v16, v17
    v_lshlrev_b32 v16, 16, v81
    v_and_b32 v17, 0xffff0000, v81
    v_mul_f32 v16, v16, v22
    v_mul_f32 v17, v17, v22
    v_cvt_pk_bf16_f32 v81, v16, v17
    v_lshlrev_b32 v16, 16, v82
    v_and_b32 v17, 0xffff0000, v82
    v_mul_f32 v16, v16, v22
    v_mul_f32 v17, v17, v22
    v_cvt_pk_bf16_f32 v82, v16, v17
    v_lshlrev_b32 v16, 16, v83
    v_and_b32 v17, 0xffff0000, v83
    v_mul_f32 v16, v16, v22
    v_mul_f32 v17, v17, v22
    v_cvt_pk_bf16_f32 v83, v16, v17
    v_lshlrev_b32 v16, 16, v88
    v_and_b32 v17, 0xffff0000, v88
    v_mul_f32 v16, v16, v23
    v_mul_f32 v17, v17, v23
    v_cvt_pk_bf16_f32 v88, v16, v17
    v_lshlrev_b32 v16, 16, v89
    v_and_b32 v17, 0xffff0000, v89
    v_mul_f32 v16, v16, v23
    v_mul_f32 v17, v17, v23
    v_cvt_pk_bf16_f32 v89, v16, v17
    v_lshlrev_b32 v16, 16, v90
    v_and_b32 v17, 0xffff0000, v90
    v_mul_f32 v16, v16, v23
    v_mul_f32 v17, v17, v23
    v_cvt_pk_bf16_f32 v90, v16, v17
    v_lshlrev_b32 v16, 16, v91
    v_and_b32 v17, 0xffff0000, v91
    v_mul_f32 v16, v16, v23
    v_mul_f32 v17, v17, v23
    v_cvt_pk_bf16_f32 v91, v16, v17
    v_mul_f32 v128, v128, v20
    v_mul_f32 v129, v129, v20
    v_mul_f32 v130, v130, v20
    v_mul_f32 v131, v131, v20
    v_mul_f32 v132, v132, v21
    v_mul_f32 v133, v133, v21
    v_mul_f32 v134, v134, v21
    v_mul_f32 v135, v135, v21
    v_accvgpr_read_b32 v16, a128
    v_mul_f32 v16, v16, v22
    v_accvgpr_write_b32 a128, v16
    v_accvgpr_read_b32 v17, a129
    v_mul_f32 v17, v17, v22
    v_accvgpr_write_b32 a129, v17
    v_accvgpr_read_b32 v18, a130
    v_mul_f32 v18, v18, v22
    v_accvgpr_write_b32 a130, v18
    v_accvgpr_read_b32 v19, a131
    v_mul_f32 v19, v19, v22
    v_accvgpr_write_b32 a131, v19
    v_accvgpr_read_b32 v16, a132
    v_mul_f32 v16, v16, v23
    v_accvgpr_write_b32 a132, v16
    v_accvgpr_read_b32 v17, a133
    v_mul_f32 v17, v17, v23
    v_accvgpr_write_b32 a133, v17
    v_accvgpr_read_b32 v18, a134
    v_mul_f32 v18, v18, v23
    v_accvgpr_write_b32 a134, v18
    v_accvgpr_read_b32 v19, a135
    v_mul_f32 v19, v19, v23
    v_accvgpr_write_b32 a135, v19
    v_mul_f32 v136, v136, v20
    v_mul_f32 v137, v137, v20
    v_mul_f32 v138, v138, v20
    v_mul_f32 v139, v139, v20
    v_mul_f32 v140, v140, v21
    v_mul_f32 v141, v141, v21
    v_mul_f32 v142, v142, v21
    v_mul_f32 v143, v143, v21
    v_accvgpr_read_b32 v16, a136
    v_mul_f32 v16, v16, v22
    v_accvgpr_write_b32 a136, v16
    v_accvgpr_read_b32 v17, a137
    v_mul_f32 v17, v17, v22
    v_accvgpr_write_b32 a137, v17
    v_accvgpr_read_b32 v18, a138
    v_mul_f32 v18, v18, v22
    v_accvgpr_write_b32 a138, v18
    v_accvgpr_read_b32 v19, a139
    v_mul_f32 v19, v19, v22
    v_accvgpr_write_b32 a139, v19
    v_accvgpr_read_b32 v16, a140
    v_mul_f32 v16, v16, v23
    v_accvgpr_write_b32 a140, v16
    v_accvgpr_read_b32 v17, a141
    v_mul_f32 v17, v17, v23
    v_accvgpr_write_b32 a141, v17
    v_accvgpr_read_b32 v18, a142
    v_mul_f32 v18, v18, v23
    v_accvgpr_write_b32 a142, v18
    v_accvgpr_read_b32 v19, a143
    v_mul_f32 v19, v19, v23
    v_accvgpr_write_b32 a143, v19
    v_mul_f32 v144, v144, v20
    v_mul_f32 v145, v145, v20
    v_mul_f32 v146, v146, v20
    v_mul_f32 v147, v147, v20
    v_mul_f32 v148, v148, v21
    v_mul_f32 v149, v149, v21
    v_mul_f32 v150, v150, v21
    v_mul_f32 v151, v151, v21
    v_accvgpr_read_b32 v16, a144
    v_mul_f32 v16, v16, v22
    v_accvgpr_write_b32 a144, v16
    v_accvgpr_read_b32 v17, a145
    v_mul_f32 v17, v17, v22
    v_accvgpr_write_b32 a145, v17
    v_accvgpr_read_b32 v18, a146
    v_mul_f32 v18, v18, v22
    v_accvgpr_write_b32 a146, v18
    v_accvgpr_read_b32 v19, a147
    v_mul_f32 v19, v19, v22
    v_accvgpr_write_b32 a147, v19
    v_accvgpr_read_b32 v16, a148
    v_mul_f32 v16, v16, v23
    v_accvgpr_write_b32 a148, v16
    v_accvgpr_read_b32 v17, a149
    v_mul_f32 v17, v17, v23
    v_accvgpr_write_b32 a149, v17
    v_accvgpr_read_b32 v18, a150
    v_mul_f32 v18, v18, v23
    v_accvgpr_write_b32 a150, v18
    v_accvgpr_read_b32 v19, a151
    v_mul_f32 v19, v19, v23
    v_accvgpr_write_b32 a151, v19
    v_mul_f32 v152, v152, v20
    v_mul_f32 v153, v153, v20
    v_mul_f32 v154, v154, v20
    v_mul_f32 v155, v155, v20
    v_mul_f32 v156, v156, v21
    v_mul_f32 v157, v157, v21
    v_mul_f32 v158, v158, v21
    v_mul_f32 v159, v159, v21
    v_accvgpr_read_b32 v16, a152
    v_mul_f32 v16, v16, v22
    v_accvgpr_write_b32 a152, v16
    v_accvgpr_read_b32 v17, a153
    v_mul_f32 v17, v17, v22
    v_accvgpr_write_b32 a153, v17
    v_accvgpr_read_b32 v18, a154
    v_mul_f32 v18, v18, v22
    v_accvgpr_write_b32 a154, v18
    v_accvgpr_read_b32 v19, a155
    v_mul_f32 v19, v19, v22
    v_accvgpr_write_b32 a155, v19
    v_accvgpr_read_b32 v16, a156
    v_mul_f32 v16, v16, v23
    v_accvgpr_write_b32 a156, v16
    v_accvgpr_read_b32 v17, a157
    v_mul_f32 v17, v17, v23
    v_accvgpr_write_b32 a157, v17
    v_accvgpr_read_b32 v18, a158
    v_mul_f32 v18, v18, v23
    v_accvgpr_write_b32 a158, v18
    v_accvgpr_read_b32 v19, a159
    v_mul_f32 v19, v19, v23
    v_accvgpr_write_b32 a159, v19
    v_mul_f32 v160, v160, v20
    v_mul_f32 v161, v161, v20
    v_mul_f32 v162, v162, v20
    v_mul_f32 v163, v163, v20
    v_mul_f32 v164, v164, v21
    v_mul_f32 v165, v165, v21
    v_mul_f32 v166, v166, v21
    v_mul_f32 v167, v167, v21
    v_accvgpr_read_b32 v16, a160
    v_mul_f32 v16, v16, v22
    v_accvgpr_write_b32 a160, v16
    v_accvgpr_read_b32 v17, a161
    v_mul_f32 v17, v17, v22
    v_accvgpr_write_b32 a161, v17
    v_accvgpr_read_b32 v18, a162
    v_mul_f32 v18, v18, v22
    v_accvgpr_write_b32 a162, v18
    v_accvgpr_read_b32 v19, a163
    v_mul_f32 v19, v19, v22
    v_accvgpr_write_b32 a163, v19
    v_accvgpr_read_b32 v16, a164
    v_mul_f32 v16, v16, v23
    v_accvgpr_write_b32 a164, v16
    v_accvgpr_read_b32 v17, a165
    v_mul_f32 v17, v17, v23
    v_accvgpr_write_b32 a165, v17
    v_accvgpr_read_b32 v18, a166
    v_mul_f32 v18, v18, v23
    v_accvgpr_write_b32 a166, v18
    v_accvgpr_read_b32 v19, a167
    v_mul_f32 v19, v19, v23
    v_accvgpr_write_b32 a167, v19
    v_mul_f32 v168, v168, v20
    v_mul_f32 v169, v169, v20
    v_mul_f32 v170, v170, v20
    v_mul_f32 v171, v171, v20
    v_mul_f32 v172, v172, v21
    v_mul_f32 v173, v173, v21
    v_mul_f32 v174, v174, v21
    v_mul_f32 v175, v175, v21
    v_accvgpr_read_b32 v16, a168
    v_mul_f32 v16, v16, v22
    v_accvgpr_write_b32 a168, v16
    v_accvgpr_read_b32 v17, a169
    v_mul_f32 v17, v17, v22
    v_accvgpr_write_b32 a169, v17
    v_accvgpr_read_b32 v18, a170
    v_mul_f32 v18, v18, v22
    v_accvgpr_write_b32 a170, v18
    v_accvgpr_read_b32 v19, a171
    v_mul_f32 v19, v19, v22
    v_accvgpr_write_b32 a171, v19
    v_accvgpr_read_b32 v16, a172
    v_mul_f32 v16, v16, v23
    v_accvgpr_write_b32 a172, v16
    v_accvgpr_read_b32 v17, a173
    v_mul_f32 v17, v17, v23
    v_accvgpr_write_b32 a173, v17
    v_accvgpr_read_b32 v18, a174
    v_mul_f32 v18, v18, v23
    v_accvgpr_write_b32 a174, v18
    v_accvgpr_read_b32 v19, a175
    v_mul_f32 v19, v19, v23
    v_accvgpr_write_b32 a175, v19
    v_mul_f32 v176, v176, v20
    v_mul_f32 v177, v177, v20
    v_mul_f32 v178, v178, v20
    v_mul_f32 v179, v179, v20
    v_mul_f32 v180, v180, v21
    v_mul_f32 v181, v181, v21
    v_mul_f32 v182, v182, v21
    v_mul_f32 v183, v183, v21
    v_accvgpr_read_b32 v16, a176
    v_mul_f32 v16, v16, v22
    v_accvgpr_write_b32 a176, v16
    v_accvgpr_read_b32 v17, a177
    v_mul_f32 v17, v17, v22
    v_accvgpr_write_b32 a177, v17
    v_accvgpr_read_b32 v18, a178
    v_mul_f32 v18, v18, v22
    v_accvgpr_write_b32 a178, v18
    v_accvgpr_read_b32 v19, a179
    v_mul_f32 v19, v19, v22
    v_accvgpr_write_b32 a179, v19
    v_accvgpr_read_b32 v16, a180
    v_mul_f32 v16, v16, v23
    v_accvgpr_write_b32 a180, v16
    v_accvgpr_read_b32 v17, a181
    v_mul_f32 v17, v17, v23
    v_accvgpr_write_b32 a181, v17
    v_accvgpr_read_b32 v18, a182
    v_mul_f32 v18, v18, v23
    v_accvgpr_write_b32 a182, v18
    v_accvgpr_read_b32 v19, a183
    v_mul_f32 v19, v19, v23
    v_accvgpr_write_b32 a183, v19
    v_mul_f32 v184, v184, v20
    v_mul_f32 v185, v185, v20
    v_mul_f32 v186, v186, v20
    v_mul_f32 v187, v187, v20
    v_mul_f32 v188, v188, v21
    v_mul_f32 v189, v189, v21
    v_mul_f32 v190, v190, v21
    v_mul_f32 v191, v191, v21
    v_accvgpr_read_b32 v16, a184
    v_mul_f32 v16, v16, v22
    v_accvgpr_write_b32 a184, v16
    v_accvgpr_read_b32 v17, a185
    v_mul_f32 v17, v17, v22
    v_accvgpr_write_b32 a185, v17
    v_accvgpr_read_b32 v18, a186
    v_mul_f32 v18, v18, v22
    v_accvgpr_write_b32 a186, v18
    v_accvgpr_read_b32 v19, a187
    v_mul_f32 v19, v19, v22
    v_accvgpr_write_b32 a187, v19
    v_accvgpr_read_b32 v16, a188
    v_mul_f32 v16, v16, v23
    v_accvgpr_write_b32 a188, v16
    v_accvgpr_read_b32 v17, a189
    v_mul_f32 v17, v17, v23
    v_accvgpr_write_b32 a189, v17
    v_accvgpr_read_b32 v18, a190
    v_mul_f32 v18, v18, v23
    v_accvgpr_write_b32 a190, v18
    v_accvgpr_read_b32 v19, a191
    v_mul_f32 v19, v19, v23
    v_accvgpr_write_b32 a191, v19
    v_mul_f32 v192, v192, v20
    v_mul_f32 v193, v193, v20
    v_mul_f32 v194, v194, v20
    v_mul_f32 v195, v195, v20
    v_mul_f32 v196, v196, v21
    v_mul_f32 v197, v197, v21
    v_mul_f32 v198, v198, v21
    v_mul_f32 v199, v199, v21
    v_accvgpr_read_b32 v16, a192
    v_mul_f32 v16, v16, v22
    v_accvgpr_write_b32 a192, v16
    v_accvgpr_read_b32 v17, a193
    v_mul_f32 v17, v17, v22
    v_accvgpr_write_b32 a193, v17
    v_accvgpr_read_b32 v18, a194
    v_mul_f32 v18, v18, v22
    v_accvgpr_write_b32 a194, v18
    v_accvgpr_read_b32 v19, a195
    v_mul_f32 v19, v19, v22
    v_accvgpr_write_b32 a195, v19
    v_accvgpr_read_b32 v16, a196
    v_mul_f32 v16, v16, v23
    v_accvgpr_write_b32 a196, v16
    v_accvgpr_read_b32 v17, a197
    v_mul_f32 v17, v17, v23
    v_accvgpr_write_b32 a197, v17
    v_accvgpr_read_b32 v18, a198
    v_mul_f32 v18, v18, v23
    v_accvgpr_write_b32 a198, v18
    v_accvgpr_read_b32 v19, a199
    v_mul_f32 v19, v19, v23
    v_accvgpr_write_b32 a199, v19
    v_mul_f32 v200, v200, v20
    v_mul_f32 v201, v201, v20
    v_mul_f32 v202, v202, v20
    v_mul_f32 v203, v203, v20
    v_mul_f32 v204, v204, v21
    v_mul_f32 v205, v205, v21
    v_mul_f32 v206, v206, v21
    v_mul_f32 v207, v207, v21
    v_accvgpr_read_b32 v16, a200
    v_mul_f32 v16, v16, v22
    v_accvgpr_write_b32 a200, v16
    v_accvgpr_read_b32 v17, a201
    v_mul_f32 v17, v17, v22
    v_accvgpr_write_b32 a201, v17
    v_accvgpr_read_b32 v18, a202
    v_mul_f32 v18, v18, v22
    v_accvgpr_write_b32 a202, v18
    v_accvgpr_read_b32 v19, a203
    v_mul_f32 v19, v19, v22
    v_accvgpr_write_b32 a203, v19
    v_accvgpr_read_b32 v16, a204
    v_mul_f32 v16, v16, v23
    v_accvgpr_write_b32 a204, v16
    v_accvgpr_read_b32 v17, a205
    v_mul_f32 v17, v17, v23
    v_accvgpr_write_b32 a205, v17
    v_accvgpr_read_b32 v18, a206
    v_mul_f32 v18, v18, v23
    v_accvgpr_write_b32 a206, v18
    v_accvgpr_read_b32 v19, a207
    v_mul_f32 v19, v19, v23
    v_accvgpr_write_b32 a207, v19
    v_mul_f32 v208, v208, v20
    v_mul_f32 v209, v209, v20
    v_mul_f32 v210, v210, v20
    v_mul_f32 v211, v211, v20
    v_mul_f32 v212, v212, v21
    v_mul_f32 v213, v213, v21
    v_mul_f32 v214, v214, v21
    v_mul_f32 v215, v215, v21
    v_accvgpr_read_b32 v16, a208
    v_mul_f32 v16, v16, v22
    v_accvgpr_write_b32 a208, v16
    v_accvgpr_read_b32 v17, a209
    v_mul_f32 v17, v17, v22
    v_accvgpr_write_b32 a209, v17
    v_accvgpr_read_b32 v18, a210
    v_mul_f32 v18, v18, v22
    v_accvgpr_write_b32 a210, v18
    v_accvgpr_read_b32 v19, a211
    v_mul_f32 v19, v19, v22
    v_accvgpr_write_b32 a211, v19
    v_accvgpr_read_b32 v16, a212
    v_mul_f32 v16, v16, v23
    v_accvgpr_write_b32 a212, v16
    v_accvgpr_read_b32 v17, a213
    v_mul_f32 v17, v17, v23
    v_accvgpr_write_b32 a213, v17
    v_accvgpr_read_b32 v18, a214
    v_mul_f32 v18, v18, v23
    v_accvgpr_write_b32 a214, v18
    v_accvgpr_read_b32 v19, a215
    v_mul_f32 v19, v19, v23
    v_accvgpr_write_b32 a215, v19
    v_mul_f32 v216, v216, v20
    v_mul_f32 v217, v217, v20
    v_mul_f32 v218, v218, v20
    v_mul_f32 v219, v219, v20
    v_mul_f32 v220, v220, v21
    v_mul_f32 v221, v221, v21
    v_mul_f32 v222, v222, v21
    v_mul_f32 v223, v223, v21
    v_accvgpr_read_b32 v16, a216
    v_mul_f32 v16, v16, v22
    v_accvgpr_write_b32 a216, v16
    v_accvgpr_read_b32 v17, a217
    v_mul_f32 v17, v17, v22
    v_accvgpr_write_b32 a217, v17
    v_accvgpr_read_b32 v18, a218
    v_mul_f32 v18, v18, v22
    v_accvgpr_write_b32 a218, v18
    v_accvgpr_read_b32 v19, a219
    v_mul_f32 v19, v19, v22
    v_accvgpr_write_b32 a219, v19
    v_accvgpr_read_b32 v16, a220
    v_mul_f32 v16, v16, v23
    v_accvgpr_write_b32 a220, v16
    v_accvgpr_read_b32 v17, a221
    v_mul_f32 v17, v17, v23
    v_accvgpr_write_b32 a221, v17
    v_accvgpr_read_b32 v18, a222
    v_mul_f32 v18, v18, v23
    v_accvgpr_write_b32 a222, v18
    v_accvgpr_read_b32 v19, a223
    v_mul_f32 v19, v19, v23
    v_accvgpr_write_b32 a223, v19
    v_mul_f32 v224, v224, v20
    v_mul_f32 v225, v225, v20
    v_mul_f32 v226, v226, v20
    v_mul_f32 v227, v227, v20
    v_mul_f32 v228, v228, v21
    v_mul_f32 v229, v229, v21
    v_mul_f32 v230, v230, v21
    v_mul_f32 v231, v231, v21
    v_accvgpr_read_b32 v16, a224
    v_mul_f32 v16, v16, v22
    v_accvgpr_write_b32 a224, v16
    v_accvgpr_read_b32 v17, a225
    v_mul_f32 v17, v17, v22
    v_accvgpr_write_b32 a225, v17
    v_accvgpr_read_b32 v18, a226
    v_mul_f32 v18, v18, v22
    v_accvgpr_write_b32 a226, v18
    v_accvgpr_read_b32 v19, a227
    v_mul_f32 v19, v19, v22
    v_accvgpr_write_b32 a227, v19
    v_accvgpr_read_b32 v16, a228
    v_mul_f32 v16, v16, v23
    v_accvgpr_write_b32 a228, v16
    v_accvgpr_read_b32 v17, a229
    v_mul_f32 v17, v17, v23
    v_accvgpr_write_b32 a229, v17
    v_accvgpr_read_b32 v18, a230
    v_mul_f32 v18, v18, v23
    v_accvgpr_write_b32 a230, v18
    v_accvgpr_read_b32 v19, a231
    v_mul_f32 v19, v19, v23
    v_accvgpr_write_b32 a231, v19
    v_mul_f32 v232, v232, v20
    v_mul_f32 v233, v233, v20
    v_mul_f32 v234, v234, v20
    v_mul_f32 v235, v235, v20
    v_mul_f32 v236, v236, v21
    v_mul_f32 v237, v237, v21
    v_mul_f32 v238, v238, v21
    v_mul_f32 v239, v239, v21
    v_accvgpr_read_b32 v16, a232
    v_mul_f32 v16, v16, v22
    v_accvgpr_write_b32 a232, v16
    v_accvgpr_read_b32 v17, a233
    v_mul_f32 v17, v17, v22
    v_accvgpr_write_b32 a233, v17
    v_accvgpr_read_b32 v18, a234
    v_mul_f32 v18, v18, v22
    v_accvgpr_write_b32 a234, v18
    v_accvgpr_read_b32 v19, a235
    v_mul_f32 v19, v19, v22
    v_accvgpr_write_b32 a235, v19
    v_accvgpr_read_b32 v16, a236
    v_mul_f32 v16, v16, v23
    v_accvgpr_write_b32 a236, v16
    v_accvgpr_read_b32 v17, a237
    v_mul_f32 v17, v17, v23
    v_accvgpr_write_b32 a237, v17
    v_accvgpr_read_b32 v18, a238
    v_mul_f32 v18, v18, v23
    v_accvgpr_write_b32 a238, v18
    v_accvgpr_read_b32 v19, a239
    v_mul_f32 v19, v19, v23
    v_accvgpr_write_b32 a239, v19
    v_mul_f32 v240, v240, v20
    v_mul_f32 v241, v241, v20
    v_mul_f32 v242, v242, v20
    v_mul_f32 v243, v243, v20
    v_mul_f32 v244, v244, v21
    v_mul_f32 v245, v245, v21
    v_mul_f32 v246, v246, v21
    v_mul_f32 v247, v247, v21
    v_accvgpr_read_b32 v16, a240
    v_mul_f32 v16, v16, v22
    v_accvgpr_write_b32 a240, v16
    v_accvgpr_read_b32 v17, a241
    v_mul_f32 v17, v17, v22
    v_accvgpr_write_b32 a241, v17
    v_accvgpr_read_b32 v18, a242
    v_mul_f32 v18, v18, v22
    v_accvgpr_write_b32 a242, v18
    v_accvgpr_read_b32 v19, a243
    v_mul_f32 v19, v19, v22
    v_accvgpr_write_b32 a243, v19
    v_accvgpr_read_b32 v16, a244
    v_mul_f32 v16, v16, v23
    v_accvgpr_write_b32 a244, v16
    v_accvgpr_read_b32 v17, a245
    v_mul_f32 v17, v17, v23
    v_accvgpr_write_b32 a245, v17
    v_accvgpr_read_b32 v18, a246
    v_mul_f32 v18, v18, v23
    v_accvgpr_write_b32 a246, v18
    v_accvgpr_read_b32 v19, a247
    v_mul_f32 v19, v19, v23
    v_accvgpr_write_b32 a247, v19
    v_mul_f32 v248, v248, v20
    v_mul_f32 v249, v249, v20
    v_mul_f32 v250, v250, v20
    v_mul_f32 v251, v251, v20
    v_mul_f32 v252, v252, v21
    v_mul_f32 v253, v253, v21
    v_mul_f32 v254, v254, v21
    v_mul_f32 v255, v255, v21
    v_accvgpr_read_b32 v16, a248
    v_mul_f32 v16, v16, v22
    v_accvgpr_write_b32 a248, v16
    v_accvgpr_read_b32 v17, a249
    v_mul_f32 v17, v17, v22
    v_accvgpr_write_b32 a249, v17
    v_accvgpr_read_b32 v18, a250
    v_mul_f32 v18, v18, v22
    v_accvgpr_write_b32 a250, v18
    v_accvgpr_read_b32 v19, a251
    v_mul_f32 v19, v19, v22
    v_accvgpr_write_b32 a251, v19
    v_accvgpr_read_b32 v16, a252
    v_mul_f32 v16, v16, v23
    v_accvgpr_write_b32 a252, v16
    v_accvgpr_read_b32 v17, a253
    v_mul_f32 v17, v17, v23
    v_accvgpr_write_b32 a253, v17
    v_accvgpr_read_b32 v18, a254
    v_mul_f32 v18, v18, v23
    v_accvgpr_write_b32 a254, v18
    v_accvgpr_read_b32 v19, a255
    v_mul_f32 v19, v19, v23
    v_accvgpr_write_b32 a255, v19
    s_nop 1
    s_setpc_b64 s[72:73]
L_codeend:
.section .rodata,"a"
.p2align 6
.amdhsa_kernel concat_heads__gqa_block_cached__gqa_block_cached__near_ridge_kernel
  .amdhsa_next_free_vgpr 512
  .amdhsa_next_free_sgpr 102
  .amdhsa_accum_offset 256
  .amdhsa_group_segment_fixed_size 0
  .amdhsa_kernarg_size 104
  .amdhsa_user_sgpr_count 2
  .amdhsa_user_sgpr_kernarg_segment_ptr 1
  .amdhsa_system_sgpr_workgroup_id_x 1
.end_amdhsa_kernel
```
